```python
import torch

def _softmax(x, axis=-1):
    return torch.softmax(x, dim=axis)
def _gelu(x):
    return torch.nn.functional.gelu(x, approximate="tanh")
def _silu(x):
    return torch.nn.functional.silu(x)
def _sigmoid(x):
    return torch.sigmoid(x)
def _layernorm(x, axis=-1, eps=1e-5):
    m = x.mean(dim=axis, keepdim=True)
    v = x.var(dim=axis, keepdim=True, unbiased=False)
    return (x - m) / torch.sqrt(v + eps)
def _scatter_add(tgt, idx, src, axis=0):
    return tgt.clone().index_add_(axis, idx, src)
def _segment_sum(src, seg, n):
    out = torch.zeros((n,) + src.shape[1:], dtype=src.dtype)
    return out.index_add_(0, seg, src)
def _pad(x, pw):
    flat = tuple(v for pair in reversed(pw) for v in pair)
    return torch.nn.functional.pad(x, flat)

kernel_name = 'recurrent_scan__sliding_block__dense_activation_squared_relu__prompt'

def setup_inputs():

    _w = (lambda a: (lambda t: t.to(torch.bfloat16) if t.is_floating_point() else t)(torch.as_tensor(a)))
    def _A_setup():
        B, S, D = 1, 2048, 1024
        return {
            "x": _w((lambda *s: torch.randn(*s, dtype=torch.bfloat16) * 0.05)(B, S, D)),
            "wqkv": _w((lambda *s: torch.randn(*s, dtype=torch.bfloat16) * 0.05)(D, 3 * D)),
            "wo": _w((lambda *s: torch.randn(*s, dtype=torch.bfloat16) * 0.05)(D, D)),
        }
    _A_in = _A_setup()

    def _B_setup():
        B, S, D, F = 1, 2048, 1024, 3584
        return {
            "x": _w((lambda *s: torch.randn(*s, dtype=torch.bfloat16) * 0.05)(B, S, D)),
            "w1": _w((lambda *s: torch.randn(*s, dtype=torch.bfloat16) * 0.05)(D, F)),
            "b1": _w((lambda *s: torch.randn(*s, dtype=torch.bfloat16) * 0.4)(F)),
            "w2": _w((lambda *s: torch.randn(*s, dtype=torch.bfloat16) * 0.05)(F, D)),
            "b2": _w((lambda *s: torch.randn(*s, dtype=torch.bfloat16) * 3.2)(D)),
        }
    _B_in = _B_setup()

    return {
        "A_x": _A_in["x"],
        "A_wqkv": _A_in["wqkv"],
        "A_wo": _A_in["wo"],
        "B_x": _B_in["x"],
        "B_w1": _B_in["w1"],
        "B_b1": _B_in["b1"],
        "B_w2": _B_in["w2"],
        "B_b2": _B_in["b2"],
    }

def reference(A_x, A_wqkv, A_wo, B_x, B_w1, B_b1, B_w2, B_b2):
    def _A_ref(x, wqkv, wo):
        B, S, D = x.shape
        H = 32; Dh = D // H; W = 256
        qkv = (lambda x, *d: x.permute(*d))((x @ wqkv).reshape(B, S, 3, H, Dh), 2, 0, 3, 1, 4)
        q, k, v = qkv[0], qkv[1], qkv[2]
        scores = torch.einsum("bhqd,bhkd->bhqk", q, k) * (Dh ** -0.5)
        idx = torch.arange(S)
        mask = (idx[:, None] - idx[None, :] >= 0) & (idx[:, None] - idx[None, :] < W)
        scores = torch.where(mask[None, None], scores, -1e9)
        p = _softmax(scores, axis=-1)
        o = torch.einsum("bhqk,bhkd->bhqd", p, v)
        return (lambda x, *d: x.permute(*d))(o, 0, 2, 1, 3).reshape(B, S, D) @ wo

    def _B_ref(x, w1, b1, w2, b2):
        h = torch.einsum("bsd,df->bsf", x, w1) + b1
        zero = torch.zeros_like(h)
        r = torch.where(h > zero, h, zero)
        h = r * r
        out = torch.einsum("bsf,fd->bsd", h, w2) + b2
        return out

    x = A_x
    xn = _layernorm(x, axis=-1)
    s = _A_ref(xn, A_wqkv, A_wo)
    g = _silu(_B_ref(xn, B_w1, B_b1, B_w2, B_b2))
    return x + s * g
```

```asm
; @launch grid=(256,1,1) block=(256,1,1) lds=163840
.amdgcn_target "amdgcn-amd-amdhsa--gfx950"
.text
.globl recurrent_scan__sliding_block__dense_activation_squared_relu__prompt_kernel
.p2align 8
.type recurrent_scan__sliding_block__dense_activation_squared_relu__prompt_kernel,@function
recurrent_scan__sliding_block__dense_activation_squared_relu__prompt_kernel:
MG_start:
  s_cmp_ge_u32 s2, 256
  s_cbranch_scc1 MG_code_end
  s_load_dwordx2 s[20:21], s[0:1], 0
  s_getpc_b64 s[62:63]
  v_and_b32 v72, 31, v0
  v_lshlrev_b32 v72, 7, v72
  global_load_dword v72, v72, s[62:63]
  s_load_dwordx2 s[48:49], s[0:1], 72
  s_memrealtime s[38:39]
  s_load_dwordx2 s[4:5], s[0:1], 8
  s_load_dwordx2 s[6:7], s[0:1], 32
  s_load_dwordx2 s[8:9], s[0:1], 40
  s_load_dwordx2 s[10:11], s[0:1], 80
  s_load_dwordx2 s[70:71], s[0:1], 48
  s_load_dwordx2 s[80:81], s[0:1], 16
  s_load_dwordx2 s[22:23], s[0:1], 56
  v_lshrrev_b32 v254, 6, v0
  v_and_b32 v253, 63, v0
  v_readfirstlane_b32 s40, v254
  s_bfe_u32 s43, s2, 0x30003
  s_and_b32 s45, s2, 7
  s_lshl_b32 s45, s45, 1
  s_bfe_u32 s44, s2, 0x10006
  s_add_u32 s45, s45, s44
  s_lshl_b32 s46, s43, 2
  s_add_u32 s46, s46, s40
  v_and_b32 v1, 7, v253
  v_mov_b32 v3, v254
  v_lshrrev_b32 v2, 3, v253
  v_lshlrev_b32 v4, 11, v1
  v_lshl_add_u32 v4, v2, 4, v4
  v_lshl_add_u32 v4, v3, 9, v4
  s_lshl_b32 s60, s2, 14
  v_mov_b32 v65, 0
  s_waitcnt lgkmcnt(0)
  s_mov_b32 s24, s20
  s_and_b32 s25, s21, 0xffff
  s_mov_b32 s26, 0x400000
  s_mov_b32 s27, 0x20000
  buffer_load_dwordx4 v[8:11], v4, s[24:27], s60 offen offset:0
  buffer_load_dwordx4 v[12:15], v4, s[24:27], s60 offen offset:128
  buffer_load_dwordx4 v[16:19], v4, s[24:27], s60 offen offset:256
  buffer_load_dwordx4 v[20:23], v4, s[24:27], s60 offen offset:384
  s_mov_b32 s84, s10
  s_and_b32 s85, s11, 0xffff
  s_mov_b32 s86, 0x2d00000
  s_mov_b32 s87, 0x20000
  v_min_u32 v75, 4, v253
  v_lshlrev_b32 v75, 16, v75
  s_lshl_b32 s61, s2, 8
  s_add_u32 s61, s61, 46137344
  buffer_load_dword v75, v75, s[84:87], s61 offen sc1
  s_mov_b32 s92, s48
  s_and_b32 s93, s49, 0xffff
  s_mov_b32 s94, 0x100
  s_mov_b32 s95, 0x20000
  s_or_b32 s61, s2, s40
  s_cbranch_scc1 LP_notok
  s_mul_i32 s39, s39, 0x9e3779b1
  s_add_u32 s38, s38, s39
  s_or_b32 s38, s38, 1
  v_mov_b32 v66, s38
  s_mov_b64 exec, 1
  buffer_store_dword v66, v65, s[92:95], 0 offen sc1
  s_mov_b64 exec, -1
LP_notok:
  s_bitcmp1_b32 s2, 7
  s_cselect_b32 s62, s6, s4
  s_cselect_b32 s63, s7, s5
  s_cselect_b32 s64, 7, 6
  s_cselect_b32 s65, 7, 11
  s_cselect_b32 s66, 3, 2
  s_mul_i32 s67, s45, 448
  s_lshl_b32 s68, s45, 7
  s_bitcmp1_b32 s2, 7
  s_cselect_b32 s67, s67, s68
  s_and_b32 s67, s67, 0xffffff80
  s_lshl_b32 s64, s64, 10
  s_lshl_b32 s68, s64, 10
  s_mov_b32 s28, s62
  s_and_b32 s29, s63, 0xffff
  s_mov_b32 s30, s68
  s_mov_b32 s31, 0x20000
  v_bfe_u32 v67, v253, 2, 3
  v_lshlrev_b32 v67, 5, v67
  v_add_u32 v67, s46, v67
  v_mul_lo_u32 v67, v67, s64
  v_and_b32 v68, 3, v253
  v_min_u32 v68, s66, v68
  v_lshlrev_b32 v68, s65, v68
  v_add_u32 v67, v67, v68
  buffer_load_dword v67, v67, s[28:31], s67 offen
  s_getpc_b64 s[62:63]
LP_pc:
  s_add_u32 s62, s62, MG_start-LP_pc
  s_addc_u32 s63, s63, -1
  s_lshr_b32 s64, s2, 3
  s_lshl_b32 s64, s64, 2
  s_add_u32 s64, s64, s40
  s_lshl_b32 s64, s64, 7
  v_and_b32 v68, 1, v253
  v_lshlrev_b32 v68, 14, v68
  v_add_u32 v68, s64, v68
  global_load_dword v68, v68, s[62:63]
  s_mov_b32 s28, s8
  s_and_b32 s29, s9, 0xffff
  s_mov_b32 s30, 0x1c00
  s_mov_b32 s31, 0x20000
  s_mov_b32 s32, s22
  s_and_b32 s33, s23, 0xffff
  s_mov_b32 s34, 0x800
  s_mov_b32 s35, 0x20000
  v_mov_b32 v69, s64
  buffer_load_dword v70, v69, s[28:31], 0 offen
  s_bfe_u32 s42, s2, 0x20001
  s_lshl_b32 s42, s42, 2
  s_bfe_u32 s41, s2, 0x20003
  s_add_u32 s42, s42, s41
  s_lshr_b32 s44, s2, 7
  s_xor_b32 s44, s44, s2
  s_and_b32 s44, s44, 1
  s_lshl_b32 s44, s44, 2
  s_bfe_u32 s41, s2, 0x20005
  s_add_u32 s44, s44, s41
  s_lshl_b32 s47, s42, 3
  s_add_u32 s47, s47, s44
  s_lshl_b32 s41, s44, 8
  s_and_b32 s44, s2, 128
  s_add_u32 s38, s41, s44
  s_lshr_b32 s41, s42, 1
  s_lshl_b32 s41, s41, 2
  s_and_b32 s44, s42, 1
  s_add_u32 s41, s41, s44
  s_and_b32 s44, s40, 1
  s_lshl_b32 s44, s44, 1
  s_add_u32 s41, s41, s44
  s_lshl_b32 s41, s41, 1
  s_lshr_b32 s44, s40, 1
  s_add_u32 s41, s41, s44
  s_lshl_b32 s41, s41, 16
  s_add_u32 s39, s41, s38
  v_lshrrev_b32 v74, 3, v253
  v_and_b32 v73, 7, v253
  v_xor_b32 v73, v73, v74
  v_lshlrev_b32 v74, 11, v74
  v_lshl_add_u32 v73, v73, 4, v74
  s_lshl_b32 s41, s40, 12
  s_add_u32 m0, s41, 147456
  s_add_u32 s44, s39, 0
  buffer_load_dwordx4 v73, s[24:27], s44 offen lds
  s_add_u32 m0, s41, 148480
  s_add_u32 s44, s39, 16384
  buffer_load_dwordx4 v73, s[24:27], s44 offen lds
  s_add_u32 m0, s41, 149504
  s_add_u32 s44, s39, 32768
  buffer_load_dwordx4 v73, s[24:27], s44 offen lds
  s_add_u32 m0, s41, 150528
  s_add_u32 s44, s39, 49152
  buffer_load_dwordx4 v73, s[24:27], s44 offen lds
  v_and_b32 v73, 31, v253
  v_lshlrev_b32 v73, 2, v73
  buffer_load_dword a56, v73, s[32:35], s38 offen
  s_mov_b32 s22, s62
  s_mov_b32 s23, s63
  v_and_b32 v251, 3, v253
  v_lshlrev_b32 v251, 14, v251
  v_add_u32 v251, s64, v251
  v_min_u32 v251, AT_slow-MG_start, v251
  s_mov_b32 s84, s10
  s_and_b32 s85, s11, 0xffff
  s_mov_b32 s86, 0x2d00000
  s_mov_b32 s87, 0x20000
  v_lshrrev_b32 v5, 5, v253
  v_lshl_add_u32 v5, v3, 3, v5
  v_lshlrev_b32 v5, 12, v5
  v_and_b32 v2, 3, v2
  v_lshl_add_u32 v5, v2, 8, v5
  v_lshl_add_u32 v5, v1, 4, v5
  s_lshr_b32 s16, s2, 5
  s_lshl_b32 s16, s16, 2
  s_bfe_u32 s17, s2, 0x20002
  s_add_u32 s16, s16, s17
  s_lshl_b32 s16, s16, 17
  s_bfe_u32 s17, s2, 0x10004
  s_lshl_b32 s17, s17, 11
  s_add_u32 s16, s16, s17
  s_bfe_u32 s17, s2, 0x10001
  s_lshl_b32 s17, s17, 10
  s_add_u32 s16, s16, s17
  s_and_b32 s17, s2, 1
  s_lshl_b32 s17, s17, 7
  s_add_u32 s16, s16, s17
  s_waitcnt vmcnt(9)
  buffer_load_dword v64, v65, s[92:95], 0 offen sc1
  v_mov_b32 v28, 0x3f803f80
  v_mov_b32 v24, 0
  v_mov_b32 v25, 0
  v_mov_b32 v26, 0
  v_mov_b32 v27, 0
  v_dot2c_f32_bf16 v24, v8, v28
  v_dot2c_f32_bf16 v25, v8, v8
  v_dot2c_f32_bf16 v26, v9, v28
  v_dot2c_f32_bf16 v27, v9, v9
  v_dot2c_f32_bf16 v24, v10, v28
  v_dot2c_f32_bf16 v25, v10, v10
  v_dot2c_f32_bf16 v26, v11, v28
  v_dot2c_f32_bf16 v27, v11, v11
  v_dot2c_f32_bf16 v24, v12, v28
  v_dot2c_f32_bf16 v25, v12, v12
  v_dot2c_f32_bf16 v26, v13, v28
  v_dot2c_f32_bf16 v27, v13, v13
  v_dot2c_f32_bf16 v24, v14, v28
  v_dot2c_f32_bf16 v25, v14, v14
  v_dot2c_f32_bf16 v26, v15, v28
  v_dot2c_f32_bf16 v27, v15, v15
  v_dot2c_f32_bf16 v24, v16, v28
  v_dot2c_f32_bf16 v25, v16, v16
  v_dot2c_f32_bf16 v26, v17, v28
  v_dot2c_f32_bf16 v27, v17, v17
  v_dot2c_f32_bf16 v24, v18, v28
  v_dot2c_f32_bf16 v25, v18, v18
  v_dot2c_f32_bf16 v26, v19, v28
  v_dot2c_f32_bf16 v27, v19, v19
  v_dot2c_f32_bf16 v24, v20, v28
  v_dot2c_f32_bf16 v25, v20, v20
  v_dot2c_f32_bf16 v26, v21, v28
  v_dot2c_f32_bf16 v27, v21, v21
  v_dot2c_f32_bf16 v24, v22, v28
  v_dot2c_f32_bf16 v25, v22, v22
  v_dot2c_f32_bf16 v26, v23, v28
  v_dot2c_f32_bf16 v27, v23, v23
  v_lshlrev_b32 v6, 3, v1
  v_add_u32 v6, 131072, v6
  v_lshl_add_u32 v7, v3, 7, v6
  v_add_f32 v24, v24, v26
  v_add_f32 v25, v25, v27
  s_nop 0
  v_add_f32_dpp v24, v24, v24 row_ror:8 row_mask:0xf bank_mask:0xf
  v_add_f32_dpp v25, v25, v25 row_ror:8 row_mask:0xf bank_mask:0xf
  v_mov_b32 v26, v24
  v_mov_b32 v27, v25
  s_nop 0
  v_permlane16_swap_b32 v24, v26
  v_permlane16_swap_b32 v25, v27
  v_add_f32 v24, v24, v26
  v_add_f32 v25, v25, v27
  v_mov_b32 v26, v24
  v_mov_b32 v27, v25
  s_nop 0
  v_permlane32_swap_b32 v24, v26
  v_permlane32_swap_b32 v25, v27
  v_add_f32 v24, v24, v26
  v_add_f32 v25, v25, v27
  ds_write_b64 v7, v[24:25]
  v_lshlrev_b32 v32, 16, v8
  v_and_b32 v33, 0xffff0000, v8
  v_lshlrev_b32 v34, 16, v9
  v_and_b32 v35, 0xffff0000, v9
  v_lshlrev_b32 v36, 16, v10
  v_and_b32 v37, 0xffff0000, v10
  v_lshlrev_b32 v38, 16, v11
  v_and_b32 v39, 0xffff0000, v11
  v_lshlrev_b32 v40, 16, v12
  v_and_b32 v41, 0xffff0000, v12
  v_lshlrev_b32 v42, 16, v13
  v_and_b32 v43, 0xffff0000, v13
  v_lshlrev_b32 v44, 16, v14
  v_and_b32 v45, 0xffff0000, v14
  v_lshlrev_b32 v46, 16, v15
  v_and_b32 v47, 0xffff0000, v15
  s_waitcnt lgkmcnt(0)
  s_barrier
  ds_read_b64 v[80:81], v6 offset:0
  ds_read_b64 v[82:83], v6 offset:128
  ds_read_b64 v[84:85], v6 offset:256
  ds_read_b64 v[86:87], v6 offset:384
  v_lshlrev_b32 v48, 16, v16
  v_and_b32 v49, 0xffff0000, v16
  v_lshlrev_b32 v50, 16, v17
  v_and_b32 v51, 0xffff0000, v17
  v_lshlrev_b32 v52, 16, v18
  v_and_b32 v53, 0xffff0000, v18
  v_lshlrev_b32 v54, 16, v19
  v_and_b32 v55, 0xffff0000, v19
  v_lshlrev_b32 v56, 16, v20
  v_and_b32 v57, 0xffff0000, v20
  v_lshlrev_b32 v58, 16, v21
  v_and_b32 v59, 0xffff0000, v21
  v_lshlrev_b32 v60, 16, v22
  v_and_b32 v61, 0xffff0000, v22
  v_lshlrev_b32 v62, 16, v23
  v_and_b32 v63, 0xffff0000, v23
  s_waitcnt lgkmcnt(0)
  v_add_f32 v24, v80, v82
  v_add_f32 v25, v81, v83
  v_add_f32 v26, v84, v86
  v_add_f32 v27, v85, v87
  v_add_f32 v24, v24, v26
  v_add_f32 v25, v25, v27
  v_mul_f32 v24, 0x3a800000, v24
  v_mul_f32 v25, 0x3a800000, v25
  v_fma_f32 v25, -v24, v24, v25
  v_max_f32 v25, 0, v25
  v_cvt_pk_bf16_f32 v24, v24, v24
  v_lshlrev_b32 v24, 16, v24
  v_cvt_pk_bf16_f32 v25, v25, v25
  v_lshlrev_b32 v25, 16, v25
  v_add_f32 v25, 0x3727c5ac, v25
  v_cvt_pk_bf16_f32 v25, v25, v25
  v_lshlrev_b32 v25, 16, v25
  v_sqrt_f32 v25, v25
  v_sub_f32 v32, v32, v24
  v_sub_f32 v33, v33, v24
  v_cvt_pk_bf16_f32 v8, v32, v33
  v_sub_f32 v34, v34, v24
  v_sub_f32 v35, v35, v24
  v_cvt_pk_bf16_f32 v9, v34, v35
  v_sub_f32 v36, v36, v24
  v_sub_f32 v37, v37, v24
  v_cvt_pk_bf16_f32 v10, v36, v37
  v_sub_f32 v38, v38, v24
  v_sub_f32 v39, v39, v24
  v_cvt_pk_bf16_f32 v11, v38, v39
  v_sub_f32 v40, v40, v24
  v_sub_f32 v41, v41, v24
  v_cvt_pk_bf16_f32 v12, v40, v41
  v_sub_f32 v42, v42, v24
  v_sub_f32 v43, v43, v24
  v_cvt_pk_bf16_f32 v13, v42, v43
  v_sub_f32 v44, v44, v24
  v_sub_f32 v45, v45, v24
  v_cvt_pk_bf16_f32 v14, v44, v45
  v_sub_f32 v46, v46, v24
  v_sub_f32 v47, v47, v24
  v_cvt_pk_bf16_f32 v15, v46, v47
  v_sub_f32 v48, v48, v24
  v_sub_f32 v49, v49, v24
  v_cvt_pk_bf16_f32 v16, v48, v49
  v_sub_f32 v50, v50, v24
  v_sub_f32 v51, v51, v24
  v_cvt_pk_bf16_f32 v17, v50, v51
  v_sub_f32 v52, v52, v24
  v_sub_f32 v53, v53, v24
  v_cvt_pk_bf16_f32 v18, v52, v53
  v_sub_f32 v54, v54, v24
  v_sub_f32 v55, v55, v24
  v_cvt_pk_bf16_f32 v19, v54, v55
  v_sub_f32 v56, v56, v24
  v_sub_f32 v57, v57, v24
  v_cvt_pk_bf16_f32 v20, v56, v57
  v_sub_f32 v58, v58, v24
  v_sub_f32 v59, v59, v24
  v_cvt_pk_bf16_f32 v21, v58, v59
  v_sub_f32 v60, v60, v24
  v_sub_f32 v61, v61, v24
  v_cvt_pk_bf16_f32 v22, v60, v61
  v_sub_f32 v62, v62, v24
  v_sub_f32 v63, v63, v24
  v_cvt_pk_bf16_f32 v23, v62, v63
  v_cvt_pk_bf16_f32 v25, v25, v25
  v_lshlrev_b32 v25, 16, v25
  v_rcp_f32 v26, v25
  v_lshlrev_b32 v32, 16, v8
  v_and_b32 v33, 0xffff0000, v8
  v_mul_f32 v32, v32, v26
  v_mul_f32 v33, v33, v26
  v_cvt_pk_bf16_f32 v8, v32, v33
  v_lshlrev_b32 v34, 16, v9
  v_and_b32 v35, 0xffff0000, v9
  v_mul_f32 v34, v34, v26
  v_mul_f32 v35, v35, v26
  v_cvt_pk_bf16_f32 v9, v34, v35
  v_lshlrev_b32 v36, 16, v10
  v_and_b32 v37, 0xffff0000, v10
  v_mul_f32 v36, v36, v26
  v_mul_f32 v37, v37, v26
  v_cvt_pk_bf16_f32 v10, v36, v37
  v_lshlrev_b32 v38, 16, v11
  v_and_b32 v39, 0xffff0000, v11
  v_mul_f32 v38, v38, v26
  v_mul_f32 v39, v39, v26
  v_cvt_pk_bf16_f32 v11, v38, v39
  v_lshlrev_b32 v40, 16, v12
  v_and_b32 v41, 0xffff0000, v12
  v_mul_f32 v40, v40, v26
  v_mul_f32 v41, v41, v26
  v_cvt_pk_bf16_f32 v12, v40, v41
  v_lshlrev_b32 v42, 16, v13
  v_and_b32 v43, 0xffff0000, v13
  v_mul_f32 v42, v42, v26
  v_mul_f32 v43, v43, v26
  v_cvt_pk_bf16_f32 v13, v42, v43
  v_lshlrev_b32 v44, 16, v14
  v_and_b32 v45, 0xffff0000, v14
  v_mul_f32 v44, v44, v26
  v_mul_f32 v45, v45, v26
  v_cvt_pk_bf16_f32 v14, v44, v45
  v_lshlrev_b32 v46, 16, v15
  v_and_b32 v47, 0xffff0000, v15
  v_mul_f32 v46, v46, v26
  v_mul_f32 v47, v47, v26
  v_cvt_pk_bf16_f32 v15, v46, v47
  v_lshlrev_b32 v48, 16, v16
  v_and_b32 v49, 0xffff0000, v16
  v_mul_f32 v48, v48, v26
  v_mul_f32 v49, v49, v26
  v_cvt_pk_bf16_f32 v16, v48, v49
  v_lshlrev_b32 v50, 16, v17
  v_and_b32 v51, 0xffff0000, v17
  v_mul_f32 v50, v50, v26
  v_mul_f32 v51, v51, v26
  v_cvt_pk_bf16_f32 v17, v50, v51
  v_lshlrev_b32 v52, 16, v18
  v_and_b32 v53, 0xffff0000, v18
  v_mul_f32 v52, v52, v26
  v_mul_f32 v53, v53, v26
  v_cvt_pk_bf16_f32 v18, v52, v53
  v_lshlrev_b32 v54, 16, v19
  v_and_b32 v55, 0xffff0000, v19
  v_mul_f32 v54, v54, v26
  v_mul_f32 v55, v55, v26
  v_cvt_pk_bf16_f32 v19, v54, v55
  v_lshlrev_b32 v56, 16, v20
  v_and_b32 v57, 0xffff0000, v20
  v_mul_f32 v56, v56, v26
  v_mul_f32 v57, v57, v26
  v_cvt_pk_bf16_f32 v20, v56, v57
  v_lshlrev_b32 v58, 16, v21
  v_and_b32 v59, 0xffff0000, v21
  v_mul_f32 v58, v58, v26
  v_mul_f32 v59, v59, v26
  v_cvt_pk_bf16_f32 v21, v58, v59
  v_lshlrev_b32 v60, 16, v22
  v_and_b32 v61, 0xffff0000, v22
  v_mul_f32 v60, v60, v26
  v_mul_f32 v61, v61, v26
  v_cvt_pk_bf16_f32 v22, v60, v61
  v_lshlrev_b32 v62, 16, v23
  v_and_b32 v63, 0xffff0000, v23
  v_mul_f32 v62, v62, v26
  v_mul_f32 v63, v63, v26
  v_cvt_pk_bf16_f32 v23, v62, v63
  s_add_u32 s17, s16, 0
  buffer_store_dwordx4 v[8:11], v5, s[84:87], s17 offen sc1
  s_add_u32 s17, s16, 8192
  buffer_store_dwordx4 v[12:15], v5, s[84:87], s17 offen sc1
  s_add_u32 s17, s16, 16384
  buffer_store_dwordx4 v[16:19], v5, s[84:87], s17 offen sc1
  s_add_u32 s17, s16, 24576
  buffer_store_dwordx4 v[20:23], v5, s[84:87], s17 offen sc1
  s_bitcmp1_b32 s2, 7
  s_cbranch_scc1 G1_w1
  v_lshrrev_b32 v234, 3, v253
  s_lshr_b32 s60, s40, 1
  v_and_b32 v235, 6, v234
  s_lshl_b32 s60, s60, 5
  v_and_b32 v236, 7, v253
  s_and_b32 s61, s40, 1
  v_xor_b32 v235, v235, v236
  s_lshl_b32 s61, s61, 2
  v_lshrrev_b32 v236, 2, v234
  s_add_u32 s60, s60, s61
  v_and_b32 v234, 3, v234
  s_mov_b32 s61, 6144
  v_lshl_add_u32 v234, v236, 3, v234
  v_add_u32 v234, s60, v234
  v_mul_lo_u32 v234, v234, s61
  v_lshl_add_u32 v230, v235, 4, v234
  v_add_u32 v231, 98304, v230
  v_lshlrev_b32 v233, 4, v253
  s_lshl_b32 s50, s45, 7
  s_add_u32 s51, s50, 4096
  s_mov_b32 s52, 0
  s_mul_i32 s53, s40, 6144
  s_waitcnt lgkmcnt(0)
  s_mov_b32 s12, s4
  s_and_b32 s13, s5, 0xffff
  s_mov_b32 s14, 0x600000
  s_mov_b32 s15, 0x20000
  s_lshl_b32 s61, s46, 17
  s_add_u32 s62, s10, s61
  s_addc_u32 s63, s11, 0
  s_mov_b32 s16, s62
  s_and_b32 s17, s63, 0xffff
  s_mov_b32 s18, 0x20000
  s_mov_b32 s19, 0x20000
  v_lshrrev_b32 v234, 4, v253
  v_bfe_u32 v235, v253, 2, 2
  v_and_b32 v236, 1, v234
  v_lshl_add_u32 v236, v236, 2, v235
  v_and_b32 v237, 6, v236
  v_bfe_u32 v235, v253, 1, 1
  v_or_b32 v237, v237, v235
  v_lshrrev_b32 v234, 1, v234
  v_lshlrev_b32 v234, 10, v234
  v_lshl_add_u32 v234, v236, 7, v234
  v_and_b32 v235, 1, v253
  v_lshl_add_u32 v234, v235, 3, v234
  v_xor_b32 v235, 0, v237
  v_lshl_add_u32 v224, v235, 4, v234
  v_xor_b32 v235, 2, v237
  v_lshl_add_u32 v225, v235, 4, v234
  v_xor_b32 v235, 4, v237
  v_lshl_add_u32 v226, v235, 4, v234
  v_xor_b32 v235, 6, v237
  v_lshl_add_u32 v227, v235, 4, v234
  s_lshl_b32 s60, s45, 18
  s_lshl_b32 s61, s46, 12
  s_add_u32 s60, s60, s61
  s_add_u32 s28, s60, 4194304
  s_add_u32 s29, s60, 4325376
  s_add_u32 s30, s60, 8388608
  s_add_u32 s31, s60, 8519680
  s_add_u32 s32, s60, 12582912
  s_add_u32 s33, s60, 12713984
  s_mov_b32 s58, 0x3e8293ee
  v_and_b32 v244, 3, v253
  s_lshl_b32 s60, s46, 2
  v_add_u32 v244, s60, v244
  s_mov_b32 s61, 6144
  v_mul_lo_u32 v244, v244, s61
  v_bfe_u32 v245, v253, 2, 2
  v_min_u32 v245, 2, v245
  v_lshl_add_u32 v244, v245, 11, v244
  s_lshl_b32 s68, s45, 7
  s_add_u32 s68, s68, 1572864
  s_mov_b32 s72, s70
  s_and_b32 s73, s71, 0xffff
  s_mov_b32 s74, 0x700000
  s_mov_b32 s75, 0x20000
  s_mov_b32 s76, s80
  s_and_b32 s77, s81, 0xffff
  s_mov_b32 s78, 0x200000
  s_mov_b32 s79, 0x20000
  s_lshl_b32 s82, s45, 5
  s_add_u32 s82, s82, s46
  s_lshl_b32 s82, s82, 1
  s_lshl_b32 s57, s82, 9
  s_mul_i32 s82, s82, 1280
  v_and_b32 v240, 15, v253
  v_min_u32 v240, 9, v240
  v_lshlrev_b32 v240, 7, v240
  v_and_b32 v241, 0x180, v240
  s_mov_b32 s88, s45
  s_mov_b32 s89, s43
  s_lshl_b32 s83, s45, 18
  s_lshl_b32 s60, s46, 12
  s_add_u32 s83, s83, s60
  s_cmp_eq_u32 s43, 0
  s_cselect_b32 s83, 0x70000000, s83
  s_lshl_b32 s99, s45, 12
  s_add_u32 s99, s99, 46202880
  s_lshl_b32 s60, s89, 8
  s_add_u32 s99, s99, s60
  s_sub_u32 s99, s99, 256
  s_min_u32 s96, s89, 1
  s_mov_b32 s97, 0
  s_lshl_b32 s94, s40, 11
  v_and_b32 v0, 3, v253
  v_bfe_u32 v1, v253, 2, 1
  v_lshl_add_u32 v0, v1, 4, v0
  v_lshlrev_b32 v0, 8, v0
  s_lshl_b32 s60, s43, 13
  s_lshl_b32 s61, s40, 10
  s_add_u32 s60, s60, s61
  s_add_u32 s36, s60, 46399488
  s_lshl_b32 s37, s2, 8
  s_add_u32 s37, s37, 46399488
  s_waitcnt vmcnt(0)
  v_readfirstlane_b32 s3, v64
  s_nop 1
  s_cmp_eq_u32 s3, 0
  s_cbranch_scc1 G1qkv_tok
G1qkv_tok_ret:
  s_barrier
  s_cmp_lg_u32 s40, 0
  s_cbranch_scc1 G1qkv_nofx
  v_mov_b32 v1, s3
  s_mov_b64 exec, 1
  buffer_store_dword v1, v0, s[84:87], s37 offen sc1
  s_mov_b64 exec, -1
G1qkv_nofx:
  s_add_u32 m0, s53, 0
  s_nop 0
  buffer_load_dwordx4 v230, s[12:15], s50 offen offset:0 lds
  s_add_u32 m0, s53, 1024
  s_nop 0
  buffer_load_dwordx4 v231, s[12:15], s50 offen offset:0 lds
  s_add_u32 m0, s53, 0
  s_nop 0
  buffer_load_dwordx4 v230, s[12:15], s50 offen offset:2048 lds
  s_add_u32 m0, s53, 1024
  s_nop 0
  buffer_load_dwordx4 v231, s[12:15], s50 offen offset:2048 lds
  s_add_u32 m0, s53, 4096
  s_nop 0
  buffer_load_dwordx4 v230, s[12:15], s51 offen offset:0 lds
  s_add_u32 m0, s53, 5120
  s_nop 0
  buffer_load_dwordx4 v231, s[12:15], s51 offen offset:0 lds
  s_add_u32 s50, s50, 393216
  s_add_u32 s51, s51, 393216
  s_add_u32 s53, s53, 24576
  s_add_u32 m0, s53, 0
  s_nop 0
  buffer_load_dwordx4 v230, s[12:15], s50 offen offset:0 lds
  s_add_u32 m0, s53, 1024
  s_nop 0
  buffer_load_dwordx4 v231, s[12:15], s50 offen offset:0 lds
  s_add_u32 m0, s53, 0
  s_nop 0
  buffer_load_dwordx4 v230, s[12:15], s50 offen offset:2048 lds
  s_add_u32 m0, s53, 1024
  s_nop 0
  buffer_load_dwordx4 v231, s[12:15], s50 offen offset:2048 lds
  s_add_u32 m0, s53, 4096
  s_nop 0
  buffer_load_dwordx4 v230, s[12:15], s51 offen offset:0 lds
  s_add_u32 m0, s53, 5120
  s_nop 0
  buffer_load_dwordx4 v231, s[12:15], s51 offen offset:0 lds
  s_add_u32 s50, s50, 393216
  s_add_u32 s51, s51, 393216
  s_add_u32 s53, s53, 24576
  buffer_load_dword v2, v0, s[84:87], s36 offen sc1
  s_waitcnt vmcnt(0)
  v_cmp_ne_u32 vcc, s3, v2
  s_nop 1
  s_and_b64 vcc, vcc, -1
  s_cbranch_scc1 G1qkv_xspin
G1qkv_xgo:
  buffer_load_dwordx4 a[64:67], v233, s[16:19], s52 offen offset:0 sc1
  buffer_load_dwordx4 a[68:71], v233, s[16:19], s52 offen offset:1024 sc1
  buffer_load_dwordx4 a[72:75], v233, s[16:19], s52 offen offset:2048 sc1
  buffer_load_dwordx4 a[76:79], v233, s[16:19], s52 offen offset:3072 sc1
  s_add_u32 s52, s52, 4096
  s_barrier
  ds_read_b64_tr_b16 a[0:1], v224 offset:0
  ds_read_b64_tr_b16 a[2:3], v224 offset:6144
  ds_read_b64_tr_b16 a[4:5], v225 offset:0
  ds_read_b64_tr_b16 a[6:7], v225 offset:6144
  buffer_load_dwordx4 a[80:83], v233, s[16:19], s52 offen offset:0 sc1
  ds_read_b64_tr_b16 a[8:9], v226 offset:0
  ds_read_b64_tr_b16 a[10:11], v226 offset:6144
  buffer_load_dwordx4 a[84:87], v233, s[16:19], s52 offen offset:1024 sc1
  ds_read_b64_tr_b16 a[12:13], v227 offset:0
  ds_read_b64_tr_b16 a[14:15], v227 offset:6144
  buffer_load_dwordx4 a[88:91], v233, s[16:19], s52 offen offset:2048 sc1
  ds_read_b64_tr_b16 a[16:17], v224 offset:2048
  ds_read_b64_tr_b16 a[18:19], v224 offset:8192
  buffer_load_dwordx4 a[92:95], v233, s[16:19], s52 offen offset:3072 sc1
  s_add_u32 s52, s52, 4096
  ds_read_b64_tr_b16 a[20:21], v225 offset:2048
  ds_read_b64_tr_b16 a[22:23], v225 offset:8192
  ds_read_b64_tr_b16 a[24:25], v226 offset:2048
  ds_read_b64_tr_b16 a[26:27], v226 offset:8192
  ds_read_b64_tr_b16 a[28:29], v227 offset:2048
  ds_read_b64_tr_b16 a[30:31], v227 offset:8192
  ds_read_b64_tr_b16 a[32:33], v224 offset:4096
  ds_read_b64_tr_b16 a[34:35], v224 offset:10240
  ds_read_b64_tr_b16 a[36:37], v225 offset:4096
  ds_read_b64_tr_b16 a[38:39], v225 offset:10240
  ds_read_b64_tr_b16 a[40:41], v226 offset:4096
  ds_read_b64_tr_b16 a[42:43], v226 offset:10240
  s_mov_b32 s54, 24576
  s_mov_b32 s56, 6
  s_mov_b32 s66, 0xfffee000
  s_waitcnt lgkmcnt(0)
  s_waitcnt vmcnt(4)
  v_mfma_f32_16x16x32_bf16 v[0:3], a[0:3], a[64:67], 0
  ds_read_b64_tr_b16 a[44:45], v227 offset:4096
  v_mfma_f32_16x16x32_bf16 v[32:35], a[0:3], a[68:71], 0
  ds_read_b64_tr_b16 a[46:47], v227 offset:10240
  v_mfma_f32_16x16x32_bf16 v[64:67], a[0:3], a[72:75], 0
  buffer_load_dwordx4 a[96:99], v233, s[16:19], s52 offen offset:0 sc1
  v_mfma_f32_16x16x32_bf16 v[96:99], a[0:3], a[76:79], 0
  buffer_load_dwordx4 a[100:103], v233, s[16:19], s52 offen offset:1024 sc1
  v_mfma_f32_16x16x32_bf16 v[4:7], a[4:7], a[64:67], 0
  ds_read_b64_tr_b16 a[0:1], v224 offset:12288
  v_mfma_f32_16x16x32_bf16 v[36:39], a[4:7], a[68:71], 0
  ds_read_b64_tr_b16 a[2:3], v224 offset:18432
  v_mfma_f32_16x16x32_bf16 v[68:71], a[4:7], a[72:75], 0
  v_mfma_f32_16x16x32_bf16 v[100:103], a[4:7], a[76:79], 0
  buffer_load_dwordx4 a[104:107], v233, s[16:19], s52 offen offset:2048 sc1
  v_mfma_f32_16x16x32_bf16 v[8:11], a[8:11], a[64:67], 0
  ds_read_b64_tr_b16 a[4:5], v225 offset:12288
  v_mfma_f32_16x16x32_bf16 v[40:43], a[8:11], a[68:71], 0
  ds_read_b64_tr_b16 a[6:7], v225 offset:18432
  v_mfma_f32_16x16x32_bf16 v[72:75], a[8:11], a[72:75], 0
  v_mfma_f32_16x16x32_bf16 v[104:107], a[8:11], a[76:79], 0
  buffer_load_dwordx4 a[108:111], v233, s[16:19], s52 offen offset:3072 sc1
  v_mfma_f32_16x16x32_bf16 v[12:15], a[12:15], a[64:67], 0
  ds_read_b64_tr_b16 a[8:9], v226 offset:12288
  s_add_u32 s52, s52, 4096
  v_mfma_f32_16x16x32_bf16 v[44:47], a[12:15], a[68:71], 0
  ds_read_b64_tr_b16 a[10:11], v226 offset:18432
  s_add_u32 m0, s53, 0
  v_mfma_f32_16x16x32_bf16 v[76:79], a[12:15], a[72:75], 0
  buffer_load_dwordx4 v230, s[12:15], s50 offen offset:0 lds
  v_mfma_f32_16x16x32_bf16 v[108:111], a[12:15], a[76:79], 0
  s_waitcnt lgkmcnt(8)
  v_mfma_f32_16x16x32_bf16 v[16:19], a[16:19], a[64:67], 0
  ds_read_b64_tr_b16 a[12:13], v227 offset:12288
  v_mfma_f32_16x16x32_bf16 v[48:51], a[16:19], a[68:71], 0
  ds_read_b64_tr_b16 a[14:15], v227 offset:18432
  s_add_u32 m0, s53, 1024
  v_mfma_f32_16x16x32_bf16 v[80:83], a[16:19], a[72:75], 0
  buffer_load_dwordx4 v231, s[12:15], s50 offen offset:0 lds
  v_mfma_f32_16x16x32_bf16 v[112:115], a[16:19], a[76:79], 0
  v_mfma_f32_16x16x32_bf16 v[20:23], a[20:23], a[64:67], 0
  ds_read_b64_tr_b16 a[16:17], v224 offset:14336
  v_mfma_f32_16x16x32_bf16 v[52:55], a[20:23], a[68:71], 0
  ds_read_b64_tr_b16 a[18:19], v224 offset:20480
  s_add_u32 m0, s53, 0
  v_mfma_f32_16x16x32_bf16 v[84:87], a[20:23], a[72:75], 0
  buffer_load_dwordx4 v230, s[12:15], s50 offen offset:2048 lds
  v_mfma_f32_16x16x32_bf16 v[116:119], a[20:23], a[76:79], 0
  v_mfma_f32_16x16x32_bf16 v[24:27], a[24:27], a[64:67], 0
  ds_read_b64_tr_b16 a[20:21], v225 offset:14336
  v_mfma_f32_16x16x32_bf16 v[56:59], a[24:27], a[68:71], 0
  ds_read_b64_tr_b16 a[22:23], v225 offset:20480
  v_mfma_f32_16x16x32_bf16 v[88:91], a[24:27], a[72:75], 0
  buffer_load_dwordx4 a[112:115], v233, s[16:19], s52 offen offset:0 sc1
  v_mfma_f32_16x16x32_bf16 v[120:123], a[24:27], a[76:79], 0
  buffer_load_dwordx4 a[116:119], v233, s[16:19], s52 offen offset:1024 sc1
  v_mfma_f32_16x16x32_bf16 v[28:31], a[28:31], a[64:67], 0
  ds_read_b64_tr_b16 a[24:25], v226 offset:14336
  v_mfma_f32_16x16x32_bf16 v[60:63], a[28:31], a[68:71], 0
  ds_read_b64_tr_b16 a[26:27], v226 offset:20480
  v_mfma_f32_16x16x32_bf16 v[92:95], a[28:31], a[72:75], 0
  v_mfma_f32_16x16x32_bf16 v[124:127], a[28:31], a[76:79], 0
  buffer_load_dwordx4 a[120:123], v233, s[16:19], s52 offen offset:2048 sc1
  v_mfma_f32_16x16x32_bf16 v[128:131], a[64:67], a[32:35], 0
  ds_read_b64_tr_b16 a[28:29], v227 offset:14336
  v_mfma_f32_16x16x32_bf16 v[132:135], a[68:71], a[32:35], 0
  ds_read_b64_tr_b16 a[30:31], v227 offset:20480
  v_mfma_f32_16x16x32_bf16 v[136:139], a[72:75], a[32:35], 0
  v_mfma_f32_16x16x32_bf16 v[140:143], a[76:79], a[32:35], 0
  buffer_load_dwordx4 a[124:127], v233, s[16:19], s52 offen offset:3072 sc1
  v_mfma_f32_16x16x32_bf16 v[144:147], a[64:67], a[36:39], 0
  ds_read_b64_tr_b16 a[32:33], v224 offset:16384
  s_add_u32 s52, s52, 4096
  v_mfma_f32_16x16x32_bf16 v[148:151], a[68:71], a[36:39], 0
  ds_read_b64_tr_b16 a[34:35], v224 offset:22528
  s_add_u32 m0, s53, 1024
  v_mfma_f32_16x16x32_bf16 v[152:155], a[72:75], a[36:39], 0
  buffer_load_dwordx4 v231, s[12:15], s50 offen offset:2048 lds
  v_mfma_f32_16x16x32_bf16 v[156:159], a[76:79], a[36:39], 0
  s_waitcnt lgkmcnt(8)
  v_add_u32 v224, 24576, v224
  v_mfma_f32_16x16x32_bf16 v[160:163], a[64:67], a[40:43], 0
  ds_read_b64_tr_b16 a[36:37], v225 offset:16384
  v_mfma_f32_16x16x32_bf16 v[164:167], a[68:71], a[40:43], 0
  ds_read_b64_tr_b16 a[38:39], v225 offset:22528
  s_add_u32 m0, s53, 4096
  v_mfma_f32_16x16x32_bf16 v[168:171], a[72:75], a[40:43], 0
  buffer_load_dwordx4 v230, s[12:15], s51 offen offset:0 lds
  v_mfma_f32_16x16x32_bf16 v[172:175], a[76:79], a[40:43], 0
  v_add_u32 v225, 24576, v225
  v_mfma_f32_16x16x32_bf16 v[176:179], a[64:67], a[44:47], 0
  ds_read_b64_tr_b16 a[40:41], v226 offset:16384
  v_mfma_f32_16x16x32_bf16 v[180:183], a[68:71], a[44:47], 0
  ds_read_b64_tr_b16 a[42:43], v226 offset:22528
  s_add_u32 m0, s53, 5120
  v_mfma_f32_16x16x32_bf16 v[184:187], a[72:75], a[44:47], 0
  buffer_load_dwordx4 v231, s[12:15], s51 offen offset:0 lds
  v_mfma_f32_16x16x32_bf16 v[188:191], a[76:79], a[44:47], 0
  s_add_u32 s50, s50, 393216
  s_add_u32 s51, s51, 393216
  s_add_u32 s53, s53, 24576
  v_add_u32 v226, 24576, v226
.p2align 4
G1qkv_loop:
  s_waitcnt vmcnt(14)
  s_barrier
  v_mfma_f32_16x16x32_bf16 v[0:3], a[0:3], a[80:83], v[0:3]
  ds_read_b64_tr_b16 a[44:45], v227 offset:16384
  v_mfma_f32_16x16x32_bf16 v[32:35], a[0:3], a[84:87], v[32:35]
  ds_read_b64_tr_b16 a[46:47], v227 offset:22528
  v_add_u32 v227, 24576, v227
  v_mfma_f32_16x16x32_bf16 v[64:67], a[0:3], a[88:91], v[64:67]
  buffer_load_dwordx4 a[64:67], v233, s[16:19], s52 offen offset:0 sc1
  v_mfma_f32_16x16x32_bf16 v[96:99], a[0:3], a[92:95], v[96:99]
  buffer_load_dwordx4 a[68:71], v233, s[16:19], s52 offen offset:1024 sc1
  v_mfma_f32_16x16x32_bf16 v[100:103], a[4:7], a[92:95], v[100:103]
  ds_read_b64_tr_b16 a[0:1], v224 offset:0
  v_mfma_f32_16x16x32_bf16 v[68:71], a[4:7], a[88:91], v[68:71]
  ds_read_b64_tr_b16 a[2:3], v224 offset:6144
  v_mfma_f32_16x16x32_bf16 v[36:39], a[4:7], a[84:87], v[36:39]
  v_mfma_f32_16x16x32_bf16 v[4:7], a[4:7], a[80:83], v[4:7]
  buffer_load_dwordx4 a[72:75], v233, s[16:19], s52 offen offset:2048 sc1
  v_mfma_f32_16x16x32_bf16 v[8:11], a[8:11], a[80:83], v[8:11]
  ds_read_b64_tr_b16 a[4:5], v225 offset:0
  v_mfma_f32_16x16x32_bf16 v[40:43], a[8:11], a[84:87], v[40:43]
  ds_read_b64_tr_b16 a[6:7], v225 offset:6144
  v_mfma_f32_16x16x32_bf16 v[72:75], a[8:11], a[88:91], v[72:75]
  v_mfma_f32_16x16x32_bf16 v[104:107], a[8:11], a[92:95], v[104:107]
  buffer_load_dwordx4 a[76:79], v233, s[16:19], s52 offen offset:3072 sc1
  v_mfma_f32_16x16x32_bf16 v[108:111], a[12:15], a[92:95], v[108:111]
  ds_read_b64_tr_b16 a[8:9], v226 offset:0
  s_add_u32 s52, s52, 4096
  v_mfma_f32_16x16x32_bf16 v[76:79], a[12:15], a[88:91], v[76:79]
  ds_read_b64_tr_b16 a[10:11], v226 offset:6144
  s_add_u32 m0, s53, 0
  v_mfma_f32_16x16x32_bf16 v[44:47], a[12:15], a[84:87], v[44:47]
  buffer_load_dwordx4 v230, s[12:15], s50 offen offset:0 lds
  v_mfma_f32_16x16x32_bf16 v[12:15], a[12:15], a[80:83], v[12:15]
  s_waitcnt lgkmcnt(8)
  v_mfma_f32_16x16x32_bf16 v[16:19], a[16:19], a[80:83], v[16:19]
  ds_read_b64_tr_b16 a[12:13], v227 offset:0
  v_mfma_f32_16x16x32_bf16 v[48:51], a[16:19], a[84:87], v[48:51]
  ds_read_b64_tr_b16 a[14:15], v227 offset:6144
  s_add_u32 m0, s53, 1024
  v_mfma_f32_16x16x32_bf16 v[80:83], a[16:19], a[88:91], v[80:83]
  buffer_load_dwordx4 v231, s[12:15], s50 offen offset:0 lds
  v_mfma_f32_16x16x32_bf16 v[112:115], a[16:19], a[92:95], v[112:115]
  v_mfma_f32_16x16x32_bf16 v[116:119], a[20:23], a[92:95], v[116:119]
  ds_read_b64_tr_b16 a[16:17], v224 offset:2048
  v_mfma_f32_16x16x32_bf16 v[84:87], a[20:23], a[88:91], v[84:87]
  ds_read_b64_tr_b16 a[18:19], v224 offset:8192
  s_add_u32 m0, s53, 0
  v_mfma_f32_16x16x32_bf16 v[52:55], a[20:23], a[84:87], v[52:55]
  buffer_load_dwordx4 v230, s[12:15], s50 offen offset:2048 lds
  v_mfma_f32_16x16x32_bf16 v[20:23], a[20:23], a[80:83], v[20:23]
  v_mfma_f32_16x16x32_bf16 v[24:27], a[24:27], a[80:83], v[24:27]
  ds_read_b64_tr_b16 a[20:21], v225 offset:2048
  v_mfma_f32_16x16x32_bf16 v[56:59], a[24:27], a[84:87], v[56:59]
  ds_read_b64_tr_b16 a[22:23], v225 offset:8192
  s_add_u32 m0, s53, 1024
  v_mfma_f32_16x16x32_bf16 v[88:91], a[24:27], a[88:91], v[88:91]
  buffer_load_dwordx4 v231, s[12:15], s50 offen offset:2048 lds
  s_add_u32 m0, s53, 4096
  v_mfma_f32_16x16x32_bf16 v[120:123], a[24:27], a[92:95], v[120:123]
  buffer_load_dwordx4 v230, s[12:15], s51 offen offset:0 lds
  v_mfma_f32_16x16x32_bf16 v[124:127], a[28:31], a[92:95], v[124:127]
  ds_read_b64_tr_b16 a[24:25], v226 offset:2048
  v_mfma_f32_16x16x32_bf16 v[92:95], a[28:31], a[88:91], v[92:95]
  ds_read_b64_tr_b16 a[26:27], v226 offset:8192
  v_mfma_f32_16x16x32_bf16 v[60:63], a[28:31], a[84:87], v[60:63]
  s_add_u32 m0, s53, 5120
  v_mfma_f32_16x16x32_bf16 v[28:31], a[28:31], a[80:83], v[28:31]
  buffer_load_dwordx4 v231, s[12:15], s51 offen offset:0 lds
  v_mfma_f32_16x16x32_bf16 v[128:131], a[80:83], a[32:35], v[128:131]
  ds_read_b64_tr_b16 a[28:29], v227 offset:2048
  s_add_u32 s50, s50, 393216
  v_mfma_f32_16x16x32_bf16 v[132:135], a[84:87], a[32:35], v[132:135]
  ds_read_b64_tr_b16 a[30:31], v227 offset:8192
  s_add_u32 s51, s51, 393216
  v_mfma_f32_16x16x32_bf16 v[136:139], a[88:91], a[32:35], v[136:139]
  s_add_u32 s53, s53, s66
  s_xor_b32 s66, s66, 0xfffe8000
  v_mfma_f32_16x16x32_bf16 v[140:143], a[92:95], a[32:35], v[140:143]
  buffer_load_dword v242, v240, s[72:75], s82 offen
  v_mfma_f32_16x16x32_bf16 v[156:159], a[92:95], a[36:39], v[156:159]
  ds_read_b64_tr_b16 a[32:33], v224 offset:4096
  s_add_u32 s82, s82, 0x140000
  v_mfma_f32_16x16x32_bf16 v[152:155], a[88:91], a[36:39], v[152:155]
  ds_read_b64_tr_b16 a[34:35], v224 offset:10240
  s_waitcnt lgkmcnt(8)
  v_mfma_f32_16x16x32_bf16 v[148:151], a[84:87], a[36:39], v[148:151]
  buffer_load_dword v243, v241, s[76:79], s57 offen
  v_mfma_f32_16x16x32_bf16 v[144:147], a[80:83], a[36:39], v[144:147]
  s_add_u32 s57, s57, 0x80000
  v_mfma_f32_16x16x32_bf16 v[160:163], a[80:83], a[40:43], v[160:163]
  ds_read_b64_tr_b16 a[36:37], v225 offset:4096
  v_mfma_f32_16x16x32_bf16 v[164:167], a[84:87], a[40:43], v[164:167]
  ds_read_b64_tr_b16 a[38:39], v225 offset:10240
  v_mfma_f32_16x16x32_bf16 v[168:171], a[88:91], a[40:43], v[168:171]
  buffer_load_dword v246, v244, s[12:15], s68 offen
  v_mfma_f32_16x16x32_bf16 v[172:175], a[92:95], a[40:43], v[172:175]
  s_add_u32 s68, s68, 786432
  v_mfma_f32_16x16x32_bf16 v[188:191], a[92:95], a[44:47], v[188:191]
  ds_read_b64_tr_b16 a[40:41], v226 offset:4096
  v_mfma_f32_16x16x32_bf16 v[184:187], a[88:91], a[44:47], v[184:187]
  ds_read_b64_tr_b16 a[42:43], v226 offset:10240
  v_mfma_f32_16x16x32_bf16 v[180:183], a[84:87], a[44:47], v[180:183]
  global_load_dword v248, v251, s[22:23]
  v_mfma_f32_16x16x32_bf16 v[176:179], a[80:83], a[44:47], v[176:179]
  s_waitcnt vmcnt(24)
  v_mfma_f32_16x16x32_bf16 v[0:3], a[0:3], a[96:99], v[0:3]
  ds_read_b64_tr_b16 a[44:45], v227 offset:4096
  v_mfma_f32_16x16x32_bf16 v[32:35], a[0:3], a[100:103], v[32:35]
  ds_read_b64_tr_b16 a[46:47], v227 offset:10240
  v_mfma_f32_16x16x32_bf16 v[64:67], a[0:3], a[104:107], v[64:67]
  v_mfma_f32_16x16x32_bf16 v[96:99], a[0:3], a[108:111], v[96:99]
  v_mfma_f32_16x16x32_bf16 v[100:103], a[4:7], a[108:111], v[100:103]
  ds_read_b64_tr_b16 a[0:1], v224 offset:12288
  v_mfma_f32_16x16x32_bf16 v[68:71], a[4:7], a[104:107], v[68:71]
  ds_read_b64_tr_b16 a[2:3], v224 offset:18432
  v_mfma_f32_16x16x32_bf16 v[36:39], a[4:7], a[100:103], v[36:39]
  v_mfma_f32_16x16x32_bf16 v[4:7], a[4:7], a[96:99], v[4:7]
  v_mfma_f32_16x16x32_bf16 v[8:11], a[8:11], a[96:99], v[8:11]
  ds_read_b64_tr_b16 a[4:5], v225 offset:12288
  v_mfma_f32_16x16x32_bf16 v[40:43], a[8:11], a[100:103], v[40:43]
  ds_read_b64_tr_b16 a[6:7], v225 offset:18432
  v_mfma_f32_16x16x32_bf16 v[72:75], a[8:11], a[104:107], v[72:75]
  v_mfma_f32_16x16x32_bf16 v[104:107], a[8:11], a[108:111], v[104:107]
  v_mfma_f32_16x16x32_bf16 v[108:111], a[12:15], a[108:111], v[108:111]
  ds_read_b64_tr_b16 a[8:9], v226 offset:12288
  s_waitcnt lgkmcnt(8)
  v_mfma_f32_16x16x32_bf16 v[76:79], a[12:15], a[104:107], v[76:79]
  ds_read_b64_tr_b16 a[10:11], v226 offset:18432
  v_mfma_f32_16x16x32_bf16 v[44:47], a[12:15], a[100:103], v[44:47]
  v_mfma_f32_16x16x32_bf16 v[12:15], a[12:15], a[96:99], v[12:15]
  v_mfma_f32_16x16x32_bf16 v[16:19], a[16:19], a[96:99], v[16:19]
  ds_read_b64_tr_b16 a[12:13], v227 offset:12288
  v_mfma_f32_16x16x32_bf16 v[48:51], a[16:19], a[100:103], v[48:51]
  ds_read_b64_tr_b16 a[14:15], v227 offset:18432
  v_mfma_f32_16x16x32_bf16 v[80:83], a[16:19], a[104:107], v[80:83]
  v_mfma_f32_16x16x32_bf16 v[112:115], a[16:19], a[108:111], v[112:115]
  v_mfma_f32_16x16x32_bf16 v[116:119], a[20:23], a[108:111], v[116:119]
  ds_read_b64_tr_b16 a[16:17], v224 offset:14336
  v_mfma_f32_16x16x32_bf16 v[84:87], a[20:23], a[104:107], v[84:87]
  ds_read_b64_tr_b16 a[18:19], v224 offset:20480
  v_mfma_f32_16x16x32_bf16 v[52:55], a[20:23], a[100:103], v[52:55]
  v_mfma_f32_16x16x32_bf16 v[20:23], a[20:23], a[96:99], v[20:23]
  v_mfma_f32_16x16x32_bf16 v[24:27], a[24:27], a[96:99], v[24:27]
  ds_read_b64_tr_b16 a[20:21], v225 offset:14336
  v_mfma_f32_16x16x32_bf16 v[56:59], a[24:27], a[100:103], v[56:59]
  ds_read_b64_tr_b16 a[22:23], v225 offset:20480
  v_mfma_f32_16x16x32_bf16 v[88:91], a[24:27], a[104:107], v[88:91]
  v_mfma_f32_16x16x32_bf16 v[120:123], a[24:27], a[108:111], v[120:123]
  v_mfma_f32_16x16x32_bf16 v[124:127], a[28:31], a[108:111], v[124:127]
  ds_read_b64_tr_b16 a[24:25], v226 offset:14336
  v_mfma_f32_16x16x32_bf16 v[92:95], a[28:31], a[104:107], v[92:95]
  ds_read_b64_tr_b16 a[26:27], v226 offset:20480
  v_mfma_f32_16x16x32_bf16 v[60:63], a[28:31], a[100:103], v[60:63]
  v_mfma_f32_16x16x32_bf16 v[28:31], a[28:31], a[96:99], v[28:31]
  v_mfma_f32_16x16x32_bf16 v[128:131], a[96:99], a[32:35], v[128:131]
  ds_read_b64_tr_b16 a[28:29], v227 offset:14336
  v_mfma_f32_16x16x32_bf16 v[132:135], a[100:103], a[32:35], v[132:135]
  ds_read_b64_tr_b16 a[30:31], v227 offset:20480
  v_mfma_f32_16x16x32_bf16 v[136:139], a[104:107], a[32:35], v[136:139]
  v_mfma_f32_16x16x32_bf16 v[140:143], a[108:111], a[32:35], v[140:143]
  v_mfma_f32_16x16x32_bf16 v[156:159], a[108:111], a[36:39], v[156:159]
  ds_read_b64_tr_b16 a[32:33], v224 offset:16384
  s_waitcnt lgkmcnt(8)
  v_mfma_f32_16x16x32_bf16 v[152:155], a[104:107], a[36:39], v[152:155]
  ds_read_b64_tr_b16 a[34:35], v224 offset:22528
  v_add_u32 v224, s54, v224
  v_mfma_f32_16x16x32_bf16 v[148:151], a[100:103], a[36:39], v[148:151]
  v_mfma_f32_16x16x32_bf16 v[144:147], a[96:99], a[36:39], v[144:147]
  v_mfma_f32_16x16x32_bf16 v[160:163], a[96:99], a[40:43], v[160:163]
  ds_read_b64_tr_b16 a[36:37], v225 offset:16384
  v_mfma_f32_16x16x32_bf16 v[164:167], a[100:103], a[40:43], v[164:167]
  ds_read_b64_tr_b16 a[38:39], v225 offset:22528
  v_add_u32 v225, s54, v225
  v_mfma_f32_16x16x32_bf16 v[168:171], a[104:107], a[40:43], v[168:171]
  v_mfma_f32_16x16x32_bf16 v[172:175], a[108:111], a[40:43], v[172:175]
  v_mfma_f32_16x16x32_bf16 v[188:191], a[108:111], a[44:47], v[188:191]
  ds_read_b64_tr_b16 a[40:41], v226 offset:16384
  v_mfma_f32_16x16x32_bf16 v[184:187], a[104:107], a[44:47], v[184:187]
  ds_read_b64_tr_b16 a[42:43], v226 offset:22528
  v_add_u32 v226, s54, v226
  v_mfma_f32_16x16x32_bf16 v[180:183], a[100:103], a[44:47], v[180:183]
  v_mfma_f32_16x16x32_bf16 v[176:179], a[96:99], a[44:47], v[176:179]
  s_waitcnt vmcnt(14)
  s_barrier
  v_mfma_f32_16x16x32_bf16 v[0:3], a[0:3], a[112:115], v[0:3]
  ds_read_b64_tr_b16 a[44:45], v227 offset:16384
  v_mfma_f32_16x16x32_bf16 v[32:35], a[0:3], a[116:119], v[32:35]
  ds_read_b64_tr_b16 a[46:47], v227 offset:22528
  v_add_u32 v227, s54, v227
  v_mfma_f32_16x16x32_bf16 v[64:67], a[0:3], a[120:123], v[64:67]
  buffer_load_dwordx4 a[80:83], v233, s[16:19], s52 offen offset:0 sc1
  v_mfma_f32_16x16x32_bf16 v[96:99], a[0:3], a[124:127], v[96:99]
  s_xor_b32 s54, s54, 0xfffe8000
  v_mfma_f32_16x16x32_bf16 v[100:103], a[4:7], a[124:127], v[100:103]
  ds_read_b64_tr_b16 a[0:1], v224 offset:0
  v_mfma_f32_16x16x32_bf16 v[68:71], a[4:7], a[120:123], v[68:71]
  ds_read_b64_tr_b16 a[2:3], v224 offset:6144
  v_mfma_f32_16x16x32_bf16 v[36:39], a[4:7], a[116:119], v[36:39]
  buffer_load_dwordx4 a[84:87], v233, s[16:19], s52 offen offset:1024 sc1
  v_mfma_f32_16x16x32_bf16 v[4:7], a[4:7], a[112:115], v[4:7]
  v_mfma_f32_16x16x32_bf16 v[8:11], a[8:11], a[112:115], v[8:11]
  ds_read_b64_tr_b16 a[4:5], v225 offset:0
  v_mfma_f32_16x16x32_bf16 v[40:43], a[8:11], a[116:119], v[40:43]
  ds_read_b64_tr_b16 a[6:7], v225 offset:6144
  v_mfma_f32_16x16x32_bf16 v[72:75], a[8:11], a[120:123], v[72:75]
  buffer_load_dwordx4 a[88:91], v233, s[16:19], s52 offen offset:2048 sc1
  v_mfma_f32_16x16x32_bf16 v[104:107], a[8:11], a[124:127], v[104:107]
  v_mfma_f32_16x16x32_bf16 v[108:111], a[12:15], a[124:127], v[108:111]
  ds_read_b64_tr_b16 a[8:9], v226 offset:0
  s_waitcnt lgkmcnt(8)
  v_mfma_f32_16x16x32_bf16 v[76:79], a[12:15], a[120:123], v[76:79]
  ds_read_b64_tr_b16 a[10:11], v226 offset:6144
  v_mfma_f32_16x16x32_bf16 v[44:47], a[12:15], a[116:119], v[44:47]
  buffer_load_dwordx4 a[92:95], v233, s[16:19], s52 offen offset:3072 sc1
  v_mfma_f32_16x16x32_bf16 v[12:15], a[12:15], a[112:115], v[12:15]
  s_add_u32 s52, s52, 4096
  v_mfma_f32_16x16x32_bf16 v[16:19], a[16:19], a[112:115], v[16:19]
  ds_read_b64_tr_b16 a[12:13], v227 offset:0
  v_mfma_f32_16x16x32_bf16 v[48:51], a[16:19], a[116:119], v[48:51]
  ds_read_b64_tr_b16 a[14:15], v227 offset:6144
  v_mfma_f32_16x16x32_bf16 v[80:83], a[16:19], a[120:123], v[80:83]
  buffer_load_dwordx4 a[96:99], v233, s[16:19], s52 offen offset:0 sc1
  v_mfma_f32_16x16x32_bf16 v[112:115], a[16:19], a[124:127], v[112:115]
  v_mfma_f32_16x16x32_bf16 v[116:119], a[20:23], a[124:127], v[116:119]
  ds_read_b64_tr_b16 a[16:17], v224 offset:2048
  v_mfma_f32_16x16x32_bf16 v[84:87], a[20:23], a[120:123], v[84:87]
  ds_read_b64_tr_b16 a[18:19], v224 offset:8192
  v_mfma_f32_16x16x32_bf16 v[52:55], a[20:23], a[116:119], v[52:55]
  buffer_load_dwordx4 a[100:103], v233, s[16:19], s52 offen offset:1024 sc1
  v_mfma_f32_16x16x32_bf16 v[20:23], a[20:23], a[112:115], v[20:23]
  v_mfma_f32_16x16x32_bf16 v[24:27], a[24:27], a[112:115], v[24:27]
  ds_read_b64_tr_b16 a[20:21], v225 offset:2048
  v_mfma_f32_16x16x32_bf16 v[56:59], a[24:27], a[116:119], v[56:59]
  ds_read_b64_tr_b16 a[22:23], v225 offset:8192
  v_mfma_f32_16x16x32_bf16 v[88:91], a[24:27], a[120:123], v[88:91]
  v_mfma_f32_16x16x32_bf16 v[120:123], a[24:27], a[124:127], v[120:123]
  buffer_load_dwordx4 a[104:107], v233, s[16:19], s52 offen offset:2048 sc1
  v_mfma_f32_16x16x32_bf16 v[124:127], a[28:31], a[124:127], v[124:127]
  ds_read_b64_tr_b16 a[24:25], v226 offset:2048
  v_mfma_f32_16x16x32_bf16 v[92:95], a[28:31], a[120:123], v[92:95]
  ds_read_b64_tr_b16 a[26:27], v226 offset:8192
  v_mfma_f32_16x16x32_bf16 v[60:63], a[28:31], a[116:119], v[60:63]
  v_mfma_f32_16x16x32_bf16 v[28:31], a[28:31], a[112:115], v[28:31]
  buffer_load_dwordx4 a[108:111], v233, s[16:19], s52 offen offset:3072 sc1
  v_mfma_f32_16x16x32_bf16 v[128:131], a[112:115], a[32:35], v[128:131]
  ds_read_b64_tr_b16 a[28:29], v227 offset:2048
  s_add_u32 s52, s52, 4096
  v_mfma_f32_16x16x32_bf16 v[132:135], a[116:119], a[32:35], v[132:135]
  ds_read_b64_tr_b16 a[30:31], v227 offset:8192
  v_mfma_f32_16x16x32_bf16 v[136:139], a[120:123], a[32:35], v[136:139]
  s_add_u32 m0, s53, 0
  v_mfma_f32_16x16x32_bf16 v[140:143], a[124:127], a[32:35], v[140:143]
  buffer_load_dwordx4 v230, s[12:15], s50 offen offset:0 lds
  v_mfma_f32_16x16x32_bf16 v[156:159], a[124:127], a[36:39], v[156:159]
  ds_read_b64_tr_b16 a[32:33], v224 offset:4096
  s_waitcnt lgkmcnt(8)
  v_mfma_f32_16x16x32_bf16 v[152:155], a[120:123], a[36:39], v[152:155]
  ds_read_b64_tr_b16 a[34:35], v224 offset:10240
  v_mfma_f32_16x16x32_bf16 v[148:151], a[116:119], a[36:39], v[148:151]
  s_add_u32 m0, s53, 1024
  v_mfma_f32_16x16x32_bf16 v[144:147], a[112:115], a[36:39], v[144:147]
  buffer_load_dwordx4 v231, s[12:15], s50 offen offset:0 lds
  v_mfma_f32_16x16x32_bf16 v[160:163], a[112:115], a[40:43], v[160:163]
  ds_read_b64_tr_b16 a[36:37], v225 offset:4096
  v_mfma_f32_16x16x32_bf16 v[164:167], a[116:119], a[40:43], v[164:167]
  ds_read_b64_tr_b16 a[38:39], v225 offset:10240
  v_mfma_f32_16x16x32_bf16 v[168:171], a[120:123], a[40:43], v[168:171]
  s_add_u32 m0, s53, 0
  v_mfma_f32_16x16x32_bf16 v[172:175], a[124:127], a[40:43], v[172:175]
  buffer_load_dwordx4 v230, s[12:15], s50 offen offset:2048 lds
  v_mfma_f32_16x16x32_bf16 v[188:191], a[124:127], a[44:47], v[188:191]
  ds_read_b64_tr_b16 a[40:41], v226 offset:4096
  v_mfma_f32_16x16x32_bf16 v[184:187], a[120:123], a[44:47], v[184:187]
  ds_read_b64_tr_b16 a[42:43], v226 offset:10240
  v_mfma_f32_16x16x32_bf16 v[180:183], a[116:119], a[44:47], v[180:183]
  v_mfma_f32_16x16x32_bf16 v[176:179], a[112:115], a[44:47], v[176:179]
  s_waitcnt vmcnt(21)
  v_mfma_f32_16x16x32_bf16 v[0:3], a[0:3], a[64:67], v[0:3]
  ds_read_b64_tr_b16 a[44:45], v227 offset:4096
  v_mfma_f32_16x16x32_bf16 v[32:35], a[0:3], a[68:71], v[32:35]
  ds_read_b64_tr_b16 a[46:47], v227 offset:10240
  v_mfma_f32_16x16x32_bf16 v[64:67], a[0:3], a[72:75], v[64:67]
  buffer_load_dwordx4 a[112:115], v233, s[16:19], s52 offen offset:0 sc1
  v_mfma_f32_16x16x32_bf16 v[96:99], a[0:3], a[76:79], v[96:99]
  v_mfma_f32_16x16x32_bf16 v[100:103], a[4:7], a[76:79], v[100:103]
  ds_read_b64_tr_b16 a[0:1], v224 offset:12288
  v_mfma_f32_16x16x32_bf16 v[68:71], a[4:7], a[72:75], v[68:71]
  ds_read_b64_tr_b16 a[2:3], v224 offset:18432
  v_mfma_f32_16x16x32_bf16 v[36:39], a[4:7], a[68:71], v[36:39]
  v_mfma_f32_16x16x32_bf16 v[4:7], a[4:7], a[64:67], v[4:7]
  buffer_load_dwordx4 a[116:119], v233, s[16:19], s52 offen offset:1024 sc1
  v_mfma_f32_16x16x32_bf16 v[8:11], a[8:11], a[64:67], v[8:11]
  ds_read_b64_tr_b16 a[4:5], v225 offset:12288
  v_mfma_f32_16x16x32_bf16 v[40:43], a[8:11], a[68:71], v[40:43]
  ds_read_b64_tr_b16 a[6:7], v225 offset:18432
  v_mfma_f32_16x16x32_bf16 v[72:75], a[8:11], a[72:75], v[72:75]
  v_mfma_f32_16x16x32_bf16 v[104:107], a[8:11], a[76:79], v[104:107]
  v_mfma_f32_16x16x32_bf16 v[108:111], a[12:15], a[76:79], v[108:111]
  ds_read_b64_tr_b16 a[8:9], v226 offset:12288
  s_waitcnt lgkmcnt(8)
  v_mfma_f32_16x16x32_bf16 v[76:79], a[12:15], a[72:75], v[76:79]
  ds_read_b64_tr_b16 a[10:11], v226 offset:18432
  v_mfma_f32_16x16x32_bf16 v[44:47], a[12:15], a[68:71], v[44:47]
  buffer_load_dwordx4 a[120:123], v233, s[16:19], s52 offen offset:2048 sc1
  v_mfma_f32_16x16x32_bf16 v[12:15], a[12:15], a[64:67], v[12:15]
  v_mfma_f32_16x16x32_bf16 v[16:19], a[16:19], a[64:67], v[16:19]
  ds_read_b64_tr_b16 a[12:13], v227 offset:12288
  v_mfma_f32_16x16x32_bf16 v[48:51], a[16:19], a[68:71], v[48:51]
  ds_read_b64_tr_b16 a[14:15], v227 offset:18432
  v_mfma_f32_16x16x32_bf16 v[80:83], a[16:19], a[72:75], v[80:83]
  v_mfma_f32_16x16x32_bf16 v[112:115], a[16:19], a[76:79], v[112:115]
  v_mfma_f32_16x16x32_bf16 v[116:119], a[20:23], a[76:79], v[116:119]
  ds_read_b64_tr_b16 a[16:17], v224 offset:14336
  v_mfma_f32_16x16x32_bf16 v[84:87], a[20:23], a[72:75], v[84:87]
  ds_read_b64_tr_b16 a[18:19], v224 offset:20480
  v_mfma_f32_16x16x32_bf16 v[52:55], a[20:23], a[68:71], v[52:55]
  buffer_load_dwordx4 a[124:127], v233, s[16:19], s52 offen offset:3072 sc1
  v_mfma_f32_16x16x32_bf16 v[20:23], a[20:23], a[64:67], v[20:23]
  s_add_u32 s52, s52, 4096
  v_mfma_f32_16x16x32_bf16 v[24:27], a[24:27], a[64:67], v[24:27]
  ds_read_b64_tr_b16 a[20:21], v225 offset:14336
  v_mfma_f32_16x16x32_bf16 v[56:59], a[24:27], a[68:71], v[56:59]
  ds_read_b64_tr_b16 a[22:23], v225 offset:20480
  v_mfma_f32_16x16x32_bf16 v[88:91], a[24:27], a[72:75], v[88:91]
  s_add_u32 m0, s53, 1024
  v_mfma_f32_16x16x32_bf16 v[120:123], a[24:27], a[76:79], v[120:123]
  buffer_load_dwordx4 v231, s[12:15], s50 offen offset:2048 lds
  v_mfma_f32_16x16x32_bf16 v[124:127], a[28:31], a[76:79], v[124:127]
  ds_read_b64_tr_b16 a[24:25], v226 offset:14336
  v_mfma_f32_16x16x32_bf16 v[92:95], a[28:31], a[72:75], v[92:95]
  ds_read_b64_tr_b16 a[26:27], v226 offset:20480
  v_mfma_f32_16x16x32_bf16 v[60:63], a[28:31], a[68:71], v[60:63]
  v_mfma_f32_16x16x32_bf16 v[28:31], a[28:31], a[64:67], v[28:31]
  v_mfma_f32_16x16x32_bf16 v[128:131], a[64:67], a[32:35], v[128:131]
  ds_read_b64_tr_b16 a[28:29], v227 offset:14336
  v_mfma_f32_16x16x32_bf16 v[132:135], a[68:71], a[32:35], v[132:135]
  ds_read_b64_tr_b16 a[30:31], v227 offset:20480
  v_mfma_f32_16x16x32_bf16 v[136:139], a[72:75], a[32:35], v[136:139]
  s_add_u32 m0, s53, 4096
  v_mfma_f32_16x16x32_bf16 v[140:143], a[76:79], a[32:35], v[140:143]
  buffer_load_dwordx4 v230, s[12:15], s51 offen offset:0 lds
  v_mfma_f32_16x16x32_bf16 v[156:159], a[76:79], a[36:39], v[156:159]
  ds_read_b64_tr_b16 a[32:33], v224 offset:16384
  s_waitcnt lgkmcnt(8)
  v_mfma_f32_16x16x32_bf16 v[152:155], a[72:75], a[36:39], v[152:155]
  ds_read_b64_tr_b16 a[34:35], v224 offset:22528
  v_add_u32 v224, 24576, v224
  v_mfma_f32_16x16x32_bf16 v[148:151], a[68:71], a[36:39], v[148:151]
  v_mfma_f32_16x16x32_bf16 v[144:147], a[64:67], a[36:39], v[144:147]
  v_mfma_f32_16x16x32_bf16 v[160:163], a[64:67], a[40:43], v[160:163]
  ds_read_b64_tr_b16 a[36:37], v225 offset:16384
  v_mfma_f32_16x16x32_bf16 v[164:167], a[68:71], a[40:43], v[164:167]
  ds_read_b64_tr_b16 a[38:39], v225 offset:22528
  s_add_u32 m0, s53, 5120
  v_mfma_f32_16x16x32_bf16 v[168:171], a[72:75], a[40:43], v[168:171]
  buffer_load_dwordx4 v231, s[12:15], s51 offen offset:0 lds
  v_mfma_f32_16x16x32_bf16 v[172:175], a[76:79], a[40:43], v[172:175]
  s_add_u32 s50, s50, 393216
  s_add_u32 s51, s51, 393216
  v_mfma_f32_16x16x32_bf16 v[188:191], a[76:79], a[44:47], v[188:191]
  ds_read_b64_tr_b16 a[40:41], v226 offset:16384
  s_add_u32 s53, s53, 24576
  v_mfma_f32_16x16x32_bf16 v[184:187], a[72:75], a[44:47], v[184:187]
  ds_read_b64_tr_b16 a[42:43], v226 offset:22528
  v_add_u32 v225, 24576, v225
  v_mfma_f32_16x16x32_bf16 v[180:183], a[68:71], a[44:47], v[180:183]
  v_add_u32 v226, 24576, v226
  v_mfma_f32_16x16x32_bf16 v[176:179], a[64:67], a[44:47], v[176:179]
  s_sub_u32 s56, s56, 1
  s_cmp_lg_u32 s56, 0
  s_cbranch_scc1 G1qkv_loop
G1qkv_tail:
  s_waitcnt vmcnt(14)
  s_barrier
  v_mfma_f32_16x16x32_bf16 v[0:3], a[0:3], a[80:83], v[0:3]
  ds_read_b64_tr_b16 a[44:45], v227 offset:16384
  v_mfma_f32_16x16x32_bf16 v[32:35], a[0:3], a[84:87], v[32:35]
  ds_read_b64_tr_b16 a[46:47], v227 offset:22528
  v_add_u32 v227, 24576, v227
  v_mfma_f32_16x16x32_bf16 v[64:67], a[0:3], a[88:91], v[64:67]
  buffer_load_dwordx4 a[64:67], v233, s[16:19], s52 offen offset:0 sc1
  v_mfma_f32_16x16x32_bf16 v[96:99], a[0:3], a[92:95], v[96:99]
  v_mfma_f32_16x16x32_bf16 v[100:103], a[4:7], a[92:95], v[100:103]
  ds_read_b64_tr_b16 a[0:1], v224 offset:0
  v_mfma_f32_16x16x32_bf16 v[68:71], a[4:7], a[88:91], v[68:71]
  ds_read_b64_tr_b16 a[2:3], v224 offset:6144
  v_mfma_f32_16x16x32_bf16 v[36:39], a[4:7], a[84:87], v[36:39]
  buffer_load_dwordx4 a[68:71], v233, s[16:19], s52 offen offset:1024 sc1
  v_mfma_f32_16x16x32_bf16 v[4:7], a[4:7], a[80:83], v[4:7]
  v_mfma_f32_16x16x32_bf16 v[8:11], a[8:11], a[80:83], v[8:11]
  ds_read_b64_tr_b16 a[4:5], v225 offset:0
  v_mfma_f32_16x16x32_bf16 v[40:43], a[8:11], a[84:87], v[40:43]
  ds_read_b64_tr_b16 a[6:7], v225 offset:6144
  v_mfma_f32_16x16x32_bf16 v[72:75], a[8:11], a[88:91], v[72:75]
  buffer_load_dwordx4 a[72:75], v233, s[16:19], s52 offen offset:2048 sc1
  v_mfma_f32_16x16x32_bf16 v[104:107], a[8:11], a[92:95], v[104:107]
  v_mfma_f32_16x16x32_bf16 v[108:111], a[12:15], a[92:95], v[108:111]
  ds_read_b64_tr_b16 a[8:9], v226 offset:0
  s_waitcnt lgkmcnt(8)
  v_mfma_f32_16x16x32_bf16 v[76:79], a[12:15], a[88:91], v[76:79]
  ds_read_b64_tr_b16 a[10:11], v226 offset:6144
  v_mfma_f32_16x16x32_bf16 v[44:47], a[12:15], a[84:87], v[44:47]
  v_mfma_f32_16x16x32_bf16 v[12:15], a[12:15], a[80:83], v[12:15]
  buffer_load_dwordx4 a[76:79], v233, s[16:19], s52 offen offset:3072 sc1
  v_mfma_f32_16x16x32_bf16 v[16:19], a[16:19], a[80:83], v[16:19]
  ds_read_b64_tr_b16 a[12:13], v227 offset:0
  s_add_u32 s52, s52, 4096
  v_mfma_f32_16x16x32_bf16 v[48:51], a[16:19], a[84:87], v[48:51]
  ds_read_b64_tr_b16 a[14:15], v227 offset:6144
  v_mfma_f32_16x16x32_bf16 v[80:83], a[16:19], a[88:91], v[80:83]
  s_add_u32 m0, s53, 0
  v_mfma_f32_16x16x32_bf16 v[112:115], a[16:19], a[92:95], v[112:115]
  buffer_load_dwordx4 v230, s[12:15], s50 offen offset:0 lds
  v_mfma_f32_16x16x32_bf16 v[116:119], a[20:23], a[92:95], v[116:119]
  ds_read_b64_tr_b16 a[16:17], v224 offset:2048
  v_mfma_f32_16x16x32_bf16 v[84:87], a[20:23], a[88:91], v[84:87]
  ds_read_b64_tr_b16 a[18:19], v224 offset:8192
  v_mfma_f32_16x16x32_bf16 v[52:55], a[20:23], a[84:87], v[52:55]
  v_mfma_f32_16x16x32_bf16 v[20:23], a[20:23], a[80:83], v[20:23]
  v_mfma_f32_16x16x32_bf16 v[24:27], a[24:27], a[80:83], v[24:27]
  ds_read_b64_tr_b16 a[20:21], v225 offset:2048
  v_mfma_f32_16x16x32_bf16 v[56:59], a[24:27], a[84:87], v[56:59]
  ds_read_b64_tr_b16 a[22:23], v225 offset:8192
  s_add_u32 m0, s53, 1024
  v_mfma_f32_16x16x32_bf16 v[88:91], a[24:27], a[88:91], v[88:91]
  buffer_load_dwordx4 v231, s[12:15], s50 offen offset:0 lds
  v_mfma_f32_16x16x32_bf16 v[120:123], a[24:27], a[92:95], v[120:123]
  v_mfma_f32_16x16x32_bf16 v[124:127], a[28:31], a[92:95], v[124:127]
  ds_read_b64_tr_b16 a[24:25], v226 offset:2048
  v_mfma_f32_16x16x32_bf16 v[92:95], a[28:31], a[88:91], v[92:95]
  ds_read_b64_tr_b16 a[26:27], v226 offset:8192
  s_add_u32 m0, s53, 0
  v_mfma_f32_16x16x32_bf16 v[60:63], a[28:31], a[84:87], v[60:63]
  buffer_load_dwordx4 v230, s[12:15], s50 offen offset:2048 lds
  v_mfma_f32_16x16x32_bf16 v[28:31], a[28:31], a[80:83], v[28:31]
  v_mfma_f32_16x16x32_bf16 v[128:131], a[80:83], a[32:35], v[128:131]
  ds_read_b64_tr_b16 a[28:29], v227 offset:2048
  v_mfma_f32_16x16x32_bf16 v[132:135], a[84:87], a[32:35], v[132:135]
  ds_read_b64_tr_b16 a[30:31], v227 offset:8192
  s_add_u32 m0, s53, 1024
  v_mfma_f32_16x16x32_bf16 v[136:139], a[88:91], a[32:35], v[136:139]
  buffer_load_dwordx4 v231, s[12:15], s50 offen offset:2048 lds
  v_mfma_f32_16x16x32_bf16 v[140:143], a[92:95], a[32:35], v[140:143]
  v_mfma_f32_16x16x32_bf16 v[156:159], a[92:95], a[36:39], v[156:159]
  ds_read_b64_tr_b16 a[32:33], v224 offset:4096
  s_waitcnt lgkmcnt(8)
  v_mfma_f32_16x16x32_bf16 v[152:155], a[88:91], a[36:39], v[152:155]
  ds_read_b64_tr_b16 a[34:35], v224 offset:10240
  v_mfma_f32_16x16x32_bf16 v[148:151], a[84:87], a[36:39], v[148:151]
  s_add_u32 m0, s53, 4096
  v_mfma_f32_16x16x32_bf16 v[144:147], a[80:83], a[36:39], v[144:147]
  buffer_load_dwordx4 v230, s[12:15], s51 offen offset:0 lds
  v_mfma_f32_16x16x32_bf16 v[160:163], a[80:83], a[40:43], v[160:163]
  ds_read_b64_tr_b16 a[36:37], v225 offset:4096
  v_mfma_f32_16x16x32_bf16 v[164:167], a[84:87], a[40:43], v[164:167]
  ds_read_b64_tr_b16 a[38:39], v225 offset:10240
  v_mfma_f32_16x16x32_bf16 v[168:171], a[88:91], a[40:43], v[168:171]
  s_add_u32 m0, s53, 5120
  v_mfma_f32_16x16x32_bf16 v[172:175], a[92:95], a[40:43], v[172:175]
  buffer_load_dwordx4 v231, s[12:15], s51 offen offset:0 lds
  v_mfma_f32_16x16x32_bf16 v[188:191], a[92:95], a[44:47], v[188:191]
  ds_read_b64_tr_b16 a[40:41], v226 offset:4096
  v_mfma_f32_16x16x32_bf16 v[184:187], a[88:91], a[44:47], v[184:187]
  ds_read_b64_tr_b16 a[42:43], v226 offset:10240
  v_mfma_f32_16x16x32_bf16 v[180:183], a[84:87], a[44:47], v[180:183]
  v_mfma_f32_16x16x32_bf16 v[176:179], a[80:83], a[44:47], v[176:179]
  s_waitcnt vmcnt(20)
  v_mfma_f32_16x16x32_bf16 v[0:3], a[0:3], a[96:99], v[0:3]
  ds_read_b64_tr_b16 a[44:45], v227 offset:4096
  v_mfma_f32_16x16x32_bf16 v[32:35], a[0:3], a[100:103], v[32:35]
  ds_read_b64_tr_b16 a[46:47], v227 offset:10240
  v_mfma_f32_16x16x32_bf16 v[64:67], a[0:3], a[104:107], v[64:67]
  buffer_load_dwordx4 a[80:83], v233, s[16:19], s52 offen offset:0 sc1
  v_mfma_f32_16x16x32_bf16 v[96:99], a[0:3], a[108:111], v[96:99]
  v_mfma_f32_16x16x32_bf16 v[100:103], a[4:7], a[108:111], v[100:103]
  ds_read_b64_tr_b16 a[0:1], v224 offset:12288
  v_mfma_f32_16x16x32_bf16 v[68:71], a[4:7], a[104:107], v[68:71]
  ds_read_b64_tr_b16 a[2:3], v224 offset:18432
  v_mfma_f32_16x16x32_bf16 v[36:39], a[4:7], a[100:103], v[36:39]
  buffer_load_dwordx4 a[84:87], v233, s[16:19], s52 offen offset:1024 sc1
  v_mfma_f32_16x16x32_bf16 v[4:7], a[4:7], a[96:99], v[4:7]
  v_mfma_f32_16x16x32_bf16 v[8:11], a[8:11], a[96:99], v[8:11]
  ds_read_b64_tr_b16 a[4:5], v225 offset:12288
  v_mfma_f32_16x16x32_bf16 v[40:43], a[8:11], a[100:103], v[40:43]
  ds_read_b64_tr_b16 a[6:7], v225 offset:18432
  v_mfma_f32_16x16x32_bf16 v[72:75], a[8:11], a[104:107], v[72:75]
  buffer_load_dwordx4 a[88:91], v233, s[16:19], s52 offen offset:2048 sc1
  v_mfma_f32_16x16x32_bf16 v[104:107], a[8:11], a[108:111], v[104:107]
  v_mfma_f32_16x16x32_bf16 v[108:111], a[12:15], a[108:111], v[108:111]
  ds_read_b64_tr_b16 a[8:9], v226 offset:12288
  s_waitcnt lgkmcnt(8)
  v_mfma_f32_16x16x32_bf16 v[76:79], a[12:15], a[104:107], v[76:79]
  ds_read_b64_tr_b16 a[10:11], v226 offset:18432
  v_mfma_f32_16x16x32_bf16 v[44:47], a[12:15], a[100:103], v[44:47]
  buffer_load_dwordx4 a[92:95], v233, s[16:19], s52 offen offset:3072 sc1
  v_mfma_f32_16x16x32_bf16 v[12:15], a[12:15], a[96:99], v[12:15]
  s_add_u32 s52, s52, 4096
  v_mfma_f32_16x16x32_bf16 v[16:19], a[16:19], a[96:99], v[16:19]
  ds_read_b64_tr_b16 a[12:13], v227 offset:12288
  v_mfma_f32_16x16x32_bf16 v[48:51], a[16:19], a[100:103], v[48:51]
  ds_read_b64_tr_b16 a[14:15], v227 offset:18432
  v_mfma_f32_16x16x32_bf16 v[80:83], a[16:19], a[104:107], v[80:83]
  buffer_load_dwordx4 a[192:195], v233, s[16:19], s52 offen offset:0 sc1
  v_mfma_f32_16x16x32_bf16 v[112:115], a[16:19], a[108:111], v[112:115]
  v_mfma_f32_16x16x32_bf16 v[116:119], a[20:23], a[108:111], v[116:119]
  ds_read_b64_tr_b16 a[16:17], v224 offset:14336
  v_mfma_f32_16x16x32_bf16 v[84:87], a[20:23], a[104:107], v[84:87]
  ds_read_b64_tr_b16 a[18:19], v224 offset:20480
  v_mfma_f32_16x16x32_bf16 v[52:55], a[20:23], a[100:103], v[52:55]
  buffer_load_dwordx4 a[196:199], v233, s[16:19], s52 offen offset:1024 sc1
  v_mfma_f32_16x16x32_bf16 v[20:23], a[20:23], a[96:99], v[20:23]
  v_mfma_f32_16x16x32_bf16 v[24:27], a[24:27], a[96:99], v[24:27]
  ds_read_b64_tr_b16 a[20:21], v225 offset:14336
  v_mfma_f32_16x16x32_bf16 v[56:59], a[24:27], a[100:103], v[56:59]
  ds_read_b64_tr_b16 a[22:23], v225 offset:20480
  v_mfma_f32_16x16x32_bf16 v[88:91], a[24:27], a[104:107], v[88:91]
  buffer_load_dwordx4 a[200:203], v233, s[16:19], s52 offen offset:2048 sc1
  v_mfma_f32_16x16x32_bf16 v[120:123], a[24:27], a[108:111], v[120:123]
  v_mfma_f32_16x16x32_bf16 v[124:127], a[28:31], a[108:111], v[124:127]
  ds_read_b64_tr_b16 a[24:25], v226 offset:14336
  v_mfma_f32_16x16x32_bf16 v[92:95], a[28:31], a[104:107], v[92:95]
  ds_read_b64_tr_b16 a[26:27], v226 offset:20480
  v_mfma_f32_16x16x32_bf16 v[60:63], a[28:31], a[100:103], v[60:63]
  buffer_load_dwordx4 a[204:207], v233, s[16:19], s52 offen offset:3072 sc1
  v_mfma_f32_16x16x32_bf16 v[28:31], a[28:31], a[96:99], v[28:31]
  s_add_u32 s52, s52, 4096
  v_mfma_f32_16x16x32_bf16 v[128:131], a[96:99], a[32:35], v[128:131]
  ds_read_b64_tr_b16 a[28:29], v227 offset:14336
  v_mfma_f32_16x16x32_bf16 v[132:135], a[100:103], a[32:35], v[132:135]
  ds_read_b64_tr_b16 a[30:31], v227 offset:20480
  v_mfma_f32_16x16x32_bf16 v[136:139], a[104:107], a[32:35], v[136:139]
  buffer_load_dwordx4 a[208:211], v233, s[16:19], s52 offen offset:0 sc1
  v_mfma_f32_16x16x32_bf16 v[140:143], a[108:111], a[32:35], v[140:143]
  v_mfma_f32_16x16x32_bf16 v[156:159], a[108:111], a[36:39], v[156:159]
  ds_read_b64_tr_b16 a[32:33], v224 offset:16384
  s_waitcnt lgkmcnt(8)
  v_mfma_f32_16x16x32_bf16 v[152:155], a[104:107], a[36:39], v[152:155]
  ds_read_b64_tr_b16 a[34:35], v224 offset:22528
  v_add_u32 v224, s54, v224
  v_mfma_f32_16x16x32_bf16 v[148:151], a[100:103], a[36:39], v[148:151]
  buffer_load_dwordx4 a[212:215], v233, s[16:19], s52 offen offset:1024 sc1
  v_mfma_f32_16x16x32_bf16 v[144:147], a[96:99], a[36:39], v[144:147]
  v_mfma_f32_16x16x32_bf16 v[160:163], a[96:99], a[40:43], v[160:163]
  ds_read_b64_tr_b16 a[36:37], v225 offset:16384
  v_mfma_f32_16x16x32_bf16 v[164:167], a[100:103], a[40:43], v[164:167]
  ds_read_b64_tr_b16 a[38:39], v225 offset:22528
  v_add_u32 v225, s54, v225
  v_mfma_f32_16x16x32_bf16 v[168:171], a[104:107], a[40:43], v[168:171]
  buffer_load_dwordx4 a[216:219], v233, s[16:19], s52 offen offset:2048 sc1
  v_mfma_f32_16x16x32_bf16 v[172:175], a[108:111], a[40:43], v[172:175]
  v_mfma_f32_16x16x32_bf16 v[188:191], a[108:111], a[44:47], v[188:191]
  ds_read_b64_tr_b16 a[40:41], v226 offset:16384
  v_mfma_f32_16x16x32_bf16 v[184:187], a[104:107], a[44:47], v[184:187]
  ds_read_b64_tr_b16 a[42:43], v226 offset:22528
  v_add_u32 v226, s54, v226
  v_mfma_f32_16x16x32_bf16 v[180:183], a[100:103], a[44:47], v[180:183]
  buffer_load_dwordx4 a[220:223], v233, s[16:19], s52 offen offset:3072 sc1
  v_mfma_f32_16x16x32_bf16 v[176:179], a[96:99], a[44:47], v[176:179]
  s_add_u32 s52, s52, 4096
  s_waitcnt vmcnt(12)
  s_barrier
  s_mov_b32 s18, s28
  ds_read_b64_tr_b16 a[44:45], v227 offset:16384
  ds_read_b64_tr_b16 a[46:47], v227 offset:22528
  v_add_u32 v227, s54, v227
  v_add_u32 v236, s94, v233
  v_add_u32 v237, 81920, v236
  ds_read_b64_tr_b16 a[128:129], v224 offset:2048
  ds_read_b64_tr_b16 a[130:131], v224 offset:8192
  ds_read_b64_tr_b16 a[132:133], v225 offset:2048
  ds_read_b64_tr_b16 a[134:135], v225 offset:8192
  ds_read_b64_tr_b16 a[136:137], v224 offset:14336
  ds_read_b64_tr_b16 a[138:139], v224 offset:20480
  ds_read_b64_tr_b16 a[140:141], v225 offset:14336
  ds_read_b64_tr_b16 a[142:143], v225 offset:20480
  s_waitcnt lgkmcnt(10)
  v_mfma_f32_16x16x32_bf16 v[112:115], a[16:19], a[124:127], v[112:115]
  ds_read_b64_tr_b16 a[144:145], v224 offset:26624
  ds_read_b64_tr_b16 a[146:147], v224 offset:32768
  v_mfma_f32_16x16x32_bf16 v[80:83], a[16:19], a[120:123], v[80:83]
  ds_read_b64_tr_b16 a[148:149], v225 offset:26624
  ds_read_b64_tr_b16 a[150:151], v225 offset:32768
  v_mfma_f32_16x16x32_bf16 v[48:51], a[16:19], a[116:119], v[48:51]
  ds_read_b64_tr_b16 a[152:153], v224 offset:38912
  ds_read_b64_tr_b16 a[154:155], v224 offset:45056
  v_mfma_f32_16x16x32_bf16 v[16:19], a[16:19], a[112:115], v[16:19]
  ds_read_b64_tr_b16 a[156:157], v225 offset:38912
  ds_read_b64_tr_b16 a[158:159], v225 offset:45056
  v_mfma_f32_16x16x32_bf16 v[20:23], a[20:23], a[112:115], v[20:23]
  ds_read_b64_tr_b16 a[160:161], v224 offset:4096
  ds_read_b64_tr_b16 a[162:163], v224 offset:10240
  v_mfma_f32_16x16x32_bf16 v[52:55], a[20:23], a[116:119], v[52:55]
  ds_read_b64_tr_b16 a[164:165], v225 offset:4096
  ds_read_b64_tr_b16 a[166:167], v225 offset:10240
  v_mfma_f32_16x16x32_bf16 v[84:87], a[20:23], a[120:123], v[84:87]
  ds_read_b64_tr_b16 a[168:169], v224 offset:16384
  ds_read_b64_tr_b16 a[170:171], v224 offset:22528
  v_mfma_f32_16x16x32_bf16 v[116:119], a[20:23], a[124:127], v[116:119]
  ds_read_b64_tr_b16 a[172:173], v225 offset:16384
  ds_read_b64_tr_b16 a[174:175], v225 offset:22528
  s_waitcnt lgkmcnt(8)
  v_mfma_f32_16x16x32_bf16 v[112:115], a[128:131], a[76:79], v[112:115]
  ds_read_b64_tr_b16 a[176:177], v224 offset:28672
  ds_read_b64_tr_b16 a[178:179], v224 offset:34816
  v_mfma_f32_16x16x32_bf16 v[80:83], a[128:131], a[72:75], v[80:83]
  ds_read_b64_tr_b16 a[180:181], v225 offset:28672
  ds_read_b64_tr_b16 a[182:183], v225 offset:34816
  v_mfma_f32_16x16x32_bf16 v[48:51], a[128:131], a[68:71], v[48:51]
  ds_read_b64_tr_b16 a[184:185], v224 offset:40960
  ds_read_b64_tr_b16 a[186:187], v224 offset:47104
  v_mfma_f32_16x16x32_bf16 v[16:19], a[128:131], a[64:67], v[16:19]
  ds_read_b64_tr_b16 a[188:189], v225 offset:40960
  ds_read_b64_tr_b16 a[190:191], v225 offset:47104
  s_waitcnt vmcnt(0)
  v_mfma_f32_16x16x32_bf16 v[20:23], a[132:135], a[64:67], v[20:23]
  v_mfma_f32_16x16x32_bf16 v[52:55], a[132:135], a[68:71], v[52:55]
  v_mfma_f32_16x16x32_bf16 v[84:87], a[132:135], a[72:75], v[84:87]
  v_mfma_f32_16x16x32_bf16 v[116:119], a[132:135], a[76:79], v[116:119]
  v_mfma_f32_16x16x32_bf16 v[112:115], a[136:139], a[92:95], v[112:115]
  v_mfma_f32_16x16x32_bf16 v[80:83], a[136:139], a[88:91], v[80:83]
  v_mfma_f32_16x16x32_bf16 v[48:51], a[136:139], a[84:87], v[48:51]
  v_mfma_f32_16x16x32_bf16 v[16:19], a[136:139], a[80:83], v[16:19]
  v_mfma_f32_16x16x32_bf16 v[20:23], a[140:143], a[80:83], v[20:23]
  v_mfma_f32_16x16x32_bf16 v[52:55], a[140:143], a[84:87], v[52:55]
  v_mfma_f32_16x16x32_bf16 v[84:87], a[140:143], a[88:91], v[84:87]
  v_mfma_f32_16x16x32_bf16 v[116:119], a[140:143], a[92:95], v[116:119]
  v_mfma_f32_16x16x32_bf16 v[112:115], a[144:147], a[204:207], v[112:115]
  v_mfma_f32_16x16x32_bf16 v[80:83], a[144:147], a[200:203], v[80:83]
  v_mfma_f32_16x16x32_bf16 v[48:51], a[144:147], a[196:199], v[48:51]
  v_mfma_f32_16x16x32_bf16 v[16:19], a[144:147], a[192:195], v[16:19]
  v_mfma_f32_16x16x32_bf16 v[20:23], a[148:151], a[192:195], v[20:23]
  v_mfma_f32_16x16x32_bf16 v[52:55], a[148:151], a[196:199], v[52:55]
  v_mfma_f32_16x16x32_bf16 v[84:87], a[148:151], a[200:203], v[84:87]
  v_mfma_f32_16x16x32_bf16 v[116:119], a[148:151], a[204:207], v[116:119]
  v_mfma_f32_16x16x32_bf16 v[112:115], a[152:155], a[220:223], v[112:115]
  v_mfma_f32_16x16x32_bf16 v[80:83], a[152:155], a[216:219], v[80:83]
  v_mfma_f32_16x16x32_bf16 v[48:51], a[152:155], a[212:215], v[48:51]
  v_mfma_f32_16x16x32_bf16 v[16:19], a[152:155], a[208:211], v[16:19]
  v_mfma_f32_16x16x32_bf16 v[20:23], a[156:159], a[208:211], v[20:23]
  v_mfma_f32_16x16x32_bf16 v[52:55], a[156:159], a[212:215], v[52:55]
  v_mfma_f32_16x16x32_bf16 v[84:87], a[156:159], a[216:219], v[84:87]
  v_mfma_f32_16x16x32_bf16 v[116:119], a[156:159], a[220:223], v[116:119]
  v_mfma_f32_16x16x32_bf16 v[140:143], a[124:127], a[32:35], v[140:143]
  ds_read_b64_tr_b16 a[128:129], v226 offset:2048
  ds_read_b64_tr_b16 a[130:131], v226 offset:8192
  v_mfma_f32_16x16x32_bf16 v[136:139], a[120:123], a[32:35], v[136:139]
  ds_read_b64_tr_b16 a[132:133], v227 offset:2048
  ds_read_b64_tr_b16 a[134:135], v227 offset:8192
  v_mfma_f32_16x16x32_bf16 v[132:135], a[116:119], a[32:35], v[132:135]
  ds_read_b64_tr_b16 a[136:137], v226 offset:14336
  ds_read_b64_tr_b16 a[138:139], v226 offset:20480
  v_mfma_f32_16x16x32_bf16 v[128:131], a[112:115], a[32:35], v[128:131]
  ds_read_b64_tr_b16 a[140:141], v227 offset:14336
  ds_read_b64_tr_b16 a[142:143], v227 offset:20480
  v_mfma_f32_16x16x32_bf16 v[144:147], a[112:115], a[36:39], v[144:147]
  ds_read_b64_tr_b16 a[144:145], v226 offset:26624
  v_mfma_f32_16x16x32_bf16 v[148:151], a[116:119], a[36:39], v[148:151]
  ds_read_b64_tr_b16 a[146:147], v226 offset:32768
  v_cvt_pk_bf16_f32 v16, v16, v17
  v_mfma_f32_16x16x32_bf16 v[152:155], a[120:123], a[36:39], v[152:155]
  ds_read_b64_tr_b16 a[148:149], v227 offset:26624
  v_mfma_f32_16x16x32_bf16 v[156:159], a[124:127], a[36:39], v[156:159]
  ds_read_b64_tr_b16 a[150:151], v227 offset:32768
  v_cvt_pk_bf16_f32 v17, v18, v19
  s_waitcnt lgkmcnt(12)
  v_mfma_f32_16x16x32_bf16 v[140:143], a[76:79], a[160:163], v[140:143]
  ds_read_b64_tr_b16 a[152:153], v226 offset:38912
  v_mfma_f32_16x16x32_bf16 v[136:139], a[72:75], a[160:163], v[136:139]
  ds_read_b64_tr_b16 a[154:155], v226 offset:45056
  v_cvt_pk_bf16_f32 v18, v20, v21
  v_mfma_f32_16x16x32_bf16 v[132:135], a[68:71], a[160:163], v[132:135]
  ds_read_b64_tr_b16 a[156:157], v227 offset:38912
  v_mfma_f32_16x16x32_bf16 v[128:131], a[64:67], a[160:163], v[128:131]
  ds_read_b64_tr_b16 a[158:159], v227 offset:45056
  v_cvt_pk_bf16_f32 v19, v22, v23
  v_mfma_f32_16x16x32_bf16 v[144:147], a[64:67], a[164:167], v[144:147]
  buffer_store_dwordx4 v[16:19], v233, s[84:87], s30 offen offset:0 sc1
  v_mfma_f32_16x16x32_bf16 v[148:151], a[68:71], a[164:167], v[148:151]
  v_mfma_f32_16x16x32_bf16 v[152:155], a[72:75], a[164:167], v[152:155]
  v_cvt_pk_bf16_f32 v48, v48, v49
  v_mfma_f32_16x16x32_bf16 v[156:159], a[76:79], a[164:167], v[156:159]
  v_mfma_f32_16x16x32_bf16 v[140:143], a[92:95], a[168:171], v[140:143]
  v_cvt_pk_bf16_f32 v49, v50, v51
  v_mfma_f32_16x16x32_bf16 v[136:139], a[88:91], a[168:171], v[136:139]
  v_mfma_f32_16x16x32_bf16 v[132:135], a[84:87], a[168:171], v[132:135]
  v_cvt_pk_bf16_f32 v50, v52, v53
  v_mfma_f32_16x16x32_bf16 v[128:131], a[80:83], a[168:171], v[128:131]
  v_mfma_f32_16x16x32_bf16 v[144:147], a[80:83], a[172:175], v[144:147]
  v_cvt_pk_bf16_f32 v51, v54, v55
  v_mfma_f32_16x16x32_bf16 v[148:151], a[84:87], a[172:175], v[148:151]
  buffer_store_dwordx4 v[48:51], v233, s[84:87], s30 offen offset:1024 sc1
  v_mfma_f32_16x16x32_bf16 v[152:155], a[88:91], a[172:175], v[152:155]
  v_mfma_f32_16x16x32_bf16 v[156:159], a[92:95], a[172:175], v[156:159]
  v_cvt_pk_bf16_f32 v80, v80, v81
  v_mfma_f32_16x16x32_bf16 v[140:143], a[204:207], a[176:179], v[140:143]
  v_mfma_f32_16x16x32_bf16 v[136:139], a[200:203], a[176:179], v[136:139]
  v_cvt_pk_bf16_f32 v81, v82, v83
  v_mfma_f32_16x16x32_bf16 v[132:135], a[196:199], a[176:179], v[132:135]
  v_mfma_f32_16x16x32_bf16 v[128:131], a[192:195], a[176:179], v[128:131]
  v_cvt_pk_bf16_f32 v82, v84, v85
  v_mfma_f32_16x16x32_bf16 v[144:147], a[192:195], a[180:183], v[144:147]
  v_mfma_f32_16x16x32_bf16 v[148:151], a[196:199], a[180:183], v[148:151]
  v_cvt_pk_bf16_f32 v83, v86, v87
  v_mfma_f32_16x16x32_bf16 v[152:155], a[200:203], a[180:183], v[152:155]
  buffer_store_dwordx4 v[80:83], v233, s[84:87], s30 offen offset:2048 sc1
  v_mfma_f32_16x16x32_bf16 v[156:159], a[204:207], a[180:183], v[156:159]
  v_mfma_f32_16x16x32_bf16 v[140:143], a[220:223], a[184:187], v[140:143]
  v_cvt_pk_bf16_f32 v112, v112, v113
  v_mfma_f32_16x16x32_bf16 v[136:139], a[216:219], a[184:187], v[136:139]
  v_mfma_f32_16x16x32_bf16 v[132:135], a[212:215], a[184:187], v[132:135]
  v_cvt_pk_bf16_f32 v113, v114, v115
  v_mfma_f32_16x16x32_bf16 v[128:131], a[208:211], a[184:187], v[128:131]
  v_mfma_f32_16x16x32_bf16 v[144:147], a[208:211], a[188:191], v[144:147]
  v_cvt_pk_bf16_f32 v114, v116, v117
  v_mfma_f32_16x16x32_bf16 v[148:151], a[212:215], a[188:191], v[148:151]
  v_mfma_f32_16x16x32_bf16 v[152:155], a[216:219], a[188:191], v[152:155]
  v_cvt_pk_bf16_f32 v115, v118, v119
  v_mfma_f32_16x16x32_bf16 v[156:159], a[220:223], a[188:191], v[156:159]
  buffer_store_dwordx4 v[112:115], v233, s[84:87], s30 offen offset:3072 sc1
  v_mfma_f32_16x16x32_bf16 v[120:123], a[24:27], a[124:127], v[120:123]
  ds_read_b64_tr_b16 a[160:161], v226 offset:4096
  ds_read_b64_tr_b16 a[162:163], v226 offset:10240
  v_mfma_f32_16x16x32_bf16 v[88:91], a[24:27], a[120:123], v[88:91]
  ds_read_b64_tr_b16 a[164:165], v227 offset:4096
  ds_read_b64_tr_b16 a[166:167], v227 offset:10240
  v_mfma_f32_16x16x32_bf16 v[56:59], a[24:27], a[116:119], v[56:59]
  ds_read_b64_tr_b16 a[168:169], v226 offset:16384
  ds_read_b64_tr_b16 a[170:171], v226 offset:22528
  v_mfma_f32_16x16x32_bf16 v[24:27], a[24:27], a[112:115], v[24:27]
  ds_read_b64_tr_b16 a[172:173], v227 offset:16384
  ds_read_b64_tr_b16 a[174:175], v227 offset:22528
  v_mfma_f32_16x16x32_bf16 v[28:31], a[28:31], a[112:115], v[28:31]
  ds_read_b64_tr_b16 a[176:177], v226 offset:28672
  v_mfma_f32_16x16x32_bf16 v[60:63], a[28:31], a[116:119], v[60:63]
  ds_read_b64_tr_b16 a[178:179], v226 offset:34816
  v_cvt_pk_bf16_f32 v128, v128, v129
  v_mfma_f32_16x16x32_bf16 v[92:95], a[28:31], a[120:123], v[92:95]
  ds_read_b64_tr_b16 a[180:181], v227 offset:28672
  v_mfma_f32_16x16x32_bf16 v[124:127], a[28:31], a[124:127], v[124:127]
  ds_read_b64_tr_b16 a[182:183], v227 offset:34816
  v_cvt_pk_bf16_f32 v129, v130, v131
  s_waitcnt lgkmcnt(12)
  v_mfma_f32_16x16x32_bf16 v[120:123], a[128:131], a[76:79], v[120:123]
  ds_read_b64_tr_b16 a[184:185], v226 offset:40960
  v_mfma_f32_16x16x32_bf16 v[88:91], a[128:131], a[72:75], v[88:91]
  ds_read_b64_tr_b16 a[186:187], v226 offset:47104
  v_cvt_pk_bf16_f32 v130, v132, v133
  v_mfma_f32_16x16x32_bf16 v[56:59], a[128:131], a[68:71], v[56:59]
  ds_read_b64_tr_b16 a[188:189], v227 offset:40960
  v_mfma_f32_16x16x32_bf16 v[24:27], a[128:131], a[64:67], v[24:27]
  ds_read_b64_tr_b16 a[190:191], v227 offset:47104
  v_cvt_pk_bf16_f32 v131, v134, v135
  v_mfma_f32_16x16x32_bf16 v[28:31], a[132:135], a[64:67], v[28:31]
  buffer_store_dwordx4 v[128:131], v233, s[84:87], s32 offen offset:0 sc1
  v_mfma_f32_16x16x32_bf16 v[60:63], a[132:135], a[68:71], v[60:63]
  v_mfma_f32_16x16x32_bf16 v[92:95], a[132:135], a[72:75], v[92:95]
  v_cvt_pk_bf16_f32 v136, v136, v137
  v_mfma_f32_16x16x32_bf16 v[124:127], a[132:135], a[76:79], v[124:127]
  v_mfma_f32_16x16x32_bf16 v[120:123], a[136:139], a[92:95], v[120:123]
  v_cvt_pk_bf16_f32 v137, v138, v139
  v_mfma_f32_16x16x32_bf16 v[88:91], a[136:139], a[88:91], v[88:91]
  v_mfma_f32_16x16x32_bf16 v[56:59], a[136:139], a[84:87], v[56:59]
  v_cvt_pk_bf16_f32 v138, v140, v141
  v_mfma_f32_16x16x32_bf16 v[24:27], a[136:139], a[80:83], v[24:27]
  v_mfma_f32_16x16x32_bf16 v[28:31], a[140:143], a[80:83], v[28:31]
  v_cvt_pk_bf16_f32 v139, v142, v143
  v_mfma_f32_16x16x32_bf16 v[60:63], a[140:143], a[84:87], v[60:63]
  buffer_store_dwordx4 v[136:139], v233, s[84:87], s32 offen offset:2048 sc1
  v_mfma_f32_16x16x32_bf16 v[92:95], a[140:143], a[88:91], v[92:95]
  v_mfma_f32_16x16x32_bf16 v[124:127], a[140:143], a[92:95], v[124:127]
  v_cvt_pk_bf16_f32 v144, v144, v145
  v_mfma_f32_16x16x32_bf16 v[120:123], a[144:147], a[204:207], v[120:123]
  v_mfma_f32_16x16x32_bf16 v[88:91], a[144:147], a[200:203], v[88:91]
  v_cvt_pk_bf16_f32 v145, v146, v147
  v_mfma_f32_16x16x32_bf16 v[56:59], a[144:147], a[196:199], v[56:59]
  v_mfma_f32_16x16x32_bf16 v[24:27], a[144:147], a[192:195], v[24:27]
  v_cvt_pk_bf16_f32 v146, v148, v149
  v_mfma_f32_16x16x32_bf16 v[28:31], a[148:151], a[192:195], v[28:31]
  v_mfma_f32_16x16x32_bf16 v[60:63], a[148:151], a[196:199], v[60:63]
  v_cvt_pk_bf16_f32 v147, v150, v151
  v_mfma_f32_16x16x32_bf16 v[92:95], a[148:151], a[200:203], v[92:95]
  buffer_store_dwordx4 v[144:147], v233, s[84:87], s32 offen offset:1024 sc1
  v_mfma_f32_16x16x32_bf16 v[124:127], a[148:151], a[204:207], v[124:127]
  v_mfma_f32_16x16x32_bf16 v[120:123], a[152:155], a[220:223], v[120:123]
  v_cvt_pk_bf16_f32 v152, v152, v153
  v_mfma_f32_16x16x32_bf16 v[88:91], a[152:155], a[216:219], v[88:91]
  v_mfma_f32_16x16x32_bf16 v[56:59], a[152:155], a[212:215], v[56:59]
  v_cvt_pk_bf16_f32 v153, v154, v155
  v_mfma_f32_16x16x32_bf16 v[24:27], a[152:155], a[208:211], v[24:27]
  v_mfma_f32_16x16x32_bf16 v[28:31], a[156:159], a[208:211], v[28:31]
  v_cvt_pk_bf16_f32 v154, v156, v157
  v_mfma_f32_16x16x32_bf16 v[60:63], a[156:159], a[212:215], v[60:63]
  v_mfma_f32_16x16x32_bf16 v[92:95], a[156:159], a[216:219], v[92:95]
  v_cvt_pk_bf16_f32 v155, v158, v159
  v_mfma_f32_16x16x32_bf16 v[124:127], a[156:159], a[220:223], v[124:127]
  buffer_store_dwordx4 v[152:155], v233, s[84:87], s32 offen offset:3072 sc1
  v_mfma_f32_16x16x32_bf16 v[172:175], a[124:127], a[40:43], v[172:175]
  ds_read_b64_tr_b16 a[128:129], v224 offset:0
  ds_read_b64_tr_b16 a[130:131], v224 offset:6144
  v_mfma_f32_16x16x32_bf16 v[168:171], a[120:123], a[40:43], v[168:171]
  ds_read_b64_tr_b16 a[132:133], v225 offset:0
  ds_read_b64_tr_b16 a[134:135], v225 offset:6144
  v_mfma_f32_16x16x32_bf16 v[164:167], a[116:119], a[40:43], v[164:167]
  ds_read_b64_tr_b16 a[136:137], v224 offset:12288
  ds_read_b64_tr_b16 a[138:139], v224 offset:18432
  v_mfma_f32_16x16x32_bf16 v[160:163], a[112:115], a[40:43], v[160:163]
  ds_read_b64_tr_b16 a[140:141], v225 offset:12288
  ds_read_b64_tr_b16 a[142:143], v225 offset:18432
  v_mfma_f32_16x16x32_bf16 v[176:179], a[112:115], a[44:47], v[176:179]
  ds_read_b64_tr_b16 a[144:145], v224 offset:24576
  v_mfma_f32_16x16x32_bf16 v[180:183], a[116:119], a[44:47], v[180:183]
  ds_read_b64_tr_b16 a[146:147], v224 offset:30720
  v_cvt_pk_bf16_f32 v24, v24, v25
  v_mfma_f32_16x16x32_bf16 v[184:187], a[120:123], a[44:47], v[184:187]
  ds_read_b64_tr_b16 a[148:149], v225 offset:24576
  v_mfma_f32_16x16x32_bf16 v[188:191], a[124:127], a[44:47], v[188:191]
  ds_read_b64_tr_b16 a[150:151], v225 offset:30720
  v_cvt_pk_bf16_f32 v25, v26, v27
  s_waitcnt lgkmcnt(12)
  v_mfma_f32_16x16x32_bf16 v[172:175], a[76:79], a[160:163], v[172:175]
  ds_read_b64_tr_b16 a[152:153], v224 offset:36864
  v_mfma_f32_16x16x32_bf16 v[168:171], a[72:75], a[160:163], v[168:171]
  ds_read_b64_tr_b16 a[154:155], v224 offset:43008
  v_cvt_pk_bf16_f32 v26, v28, v29
  v_mfma_f32_16x16x32_bf16 v[164:167], a[68:71], a[160:163], v[164:167]
  ds_read_b64_tr_b16 a[156:157], v225 offset:36864
  v_mfma_f32_16x16x32_bf16 v[160:163], a[64:67], a[160:163], v[160:163]
  ds_read_b64_tr_b16 a[158:159], v225 offset:43008
  v_cvt_pk_bf16_f32 v27, v30, v31
  v_mfma_f32_16x16x32_bf16 v[176:179], a[64:67], a[164:167], v[176:179]
  buffer_store_dwordx4 v[24:27], v233, s[84:87], s31 offen offset:0 sc1
  v_mfma_f32_16x16x32_bf16 v[180:183], a[68:71], a[164:167], v[180:183]
  v_mfma_f32_16x16x32_bf16 v[184:187], a[72:75], a[164:167], v[184:187]
  v_cvt_pk_bf16_f32 v56, v56, v57
  v_mfma_f32_16x16x32_bf16 v[188:191], a[76:79], a[164:167], v[188:191]
  v_mfma_f32_16x16x32_bf16 v[172:175], a[92:95], a[168:171], v[172:175]
  v_cvt_pk_bf16_f32 v57, v58, v59
  v_mfma_f32_16x16x32_bf16 v[168:171], a[88:91], a[168:171], v[168:171]
  v_mfma_f32_16x16x32_bf16 v[164:167], a[84:87], a[168:171], v[164:167]
  v_cvt_pk_bf16_f32 v58, v60, v61
  v_mfma_f32_16x16x32_bf16 v[160:163], a[80:83], a[168:171], v[160:163]
  v_mfma_f32_16x16x32_bf16 v[176:179], a[80:83], a[172:175], v[176:179]
  v_cvt_pk_bf16_f32 v59, v62, v63
  v_mfma_f32_16x16x32_bf16 v[180:183], a[84:87], a[172:175], v[180:183]
  buffer_store_dwordx4 v[56:59], v233, s[84:87], s31 offen offset:1024 sc1
  v_mfma_f32_16x16x32_bf16 v[184:187], a[88:91], a[172:175], v[184:187]
  v_mfma_f32_16x16x32_bf16 v[188:191], a[92:95], a[172:175], v[188:191]
  v_cvt_pk_bf16_f32 v88, v88, v89
  v_mfma_f32_16x16x32_bf16 v[172:175], a[204:207], a[176:179], v[172:175]
  v_mfma_f32_16x16x32_bf16 v[168:171], a[200:203], a[176:179], v[168:171]
  v_cvt_pk_bf16_f32 v89, v90, v91
  v_mfma_f32_16x16x32_bf16 v[164:167], a[196:199], a[176:179], v[164:167]
  v_mfma_f32_16x16x32_bf16 v[160:163], a[192:195], a[176:179], v[160:163]
  v_cvt_pk_bf16_f32 v90, v92, v93
  v_mfma_f32_16x16x32_bf16 v[176:179], a[192:195], a[180:183], v[176:179]
  v_mfma_f32_16x16x32_bf16 v[180:183], a[196:199], a[180:183], v[180:183]
  v_cvt_pk_bf16_f32 v91, v94, v95
  v_mfma_f32_16x16x32_bf16 v[184:187], a[200:203], a[180:183], v[184:187]
  buffer_store_dwordx4 v[88:91], v233, s[84:87], s31 offen offset:2048 sc1
  v_mfma_f32_16x16x32_bf16 v[188:191], a[204:207], a[180:183], v[188:191]
  v_mfma_f32_16x16x32_bf16 v[172:175], a[220:223], a[184:187], v[172:175]
  v_cvt_pk_bf16_f32 v120, v120, v121
  v_mfma_f32_16x16x32_bf16 v[168:171], a[216:219], a[184:187], v[168:171]
  v_mfma_f32_16x16x32_bf16 v[164:167], a[212:215], a[184:187], v[164:167]
  v_cvt_pk_bf16_f32 v121, v122, v123
  v_mfma_f32_16x16x32_bf16 v[160:163], a[208:211], a[184:187], v[160:163]
  v_mfma_f32_16x16x32_bf16 v[176:179], a[208:211], a[188:191], v[176:179]
  v_cvt_pk_bf16_f32 v122, v124, v125
  v_mfma_f32_16x16x32_bf16 v[180:183], a[212:215], a[188:191], v[180:183]
  v_mfma_f32_16x16x32_bf16 v[184:187], a[216:219], a[188:191], v[184:187]
  v_cvt_pk_bf16_f32 v123, v126, v127
  v_mfma_f32_16x16x32_bf16 v[188:191], a[220:223], a[188:191], v[188:191]
  buffer_store_dwordx4 v[120:123], v233, s[84:87], s31 offen offset:3072 sc1
  v_mfma_f32_16x16x32_bf16 v[96:99], a[0:3], a[124:127], v[96:99]
  ds_read_b64_tr_b16 a[160:161], v226 offset:0
  ds_read_b64_tr_b16 a[162:163], v226 offset:6144
  v_mfma_f32_16x16x32_bf16 v[64:67], a[0:3], a[120:123], v[64:67]
  ds_read_b64_tr_b16 a[164:165], v227 offset:0
  ds_read_b64_tr_b16 a[166:167], v227 offset:6144
  v_mfma_f32_16x16x32_bf16 v[32:35], a[0:3], a[116:119], v[32:35]
  ds_read_b64_tr_b16 a[168:169], v226 offset:12288
  ds_read_b64_tr_b16 a[170:171], v226 offset:18432
  v_mfma_f32_16x16x32_bf16 v[0:3], a[0:3], a[112:115], v[0:3]
  ds_read_b64_tr_b16 a[172:173], v227 offset:12288
  ds_read_b64_tr_b16 a[174:175], v227 offset:18432
  v_mfma_f32_16x16x32_bf16 v[4:7], a[4:7], a[112:115], v[4:7]
  ds_read_b64_tr_b16 a[176:177], v226 offset:24576
  v_mfma_f32_16x16x32_bf16 v[36:39], a[4:7], a[116:119], v[36:39]
  ds_read_b64_tr_b16 a[178:179], v226 offset:30720
  v_cvt_pk_bf16_f32 v160, v160, v161
  v_mfma_f32_16x16x32_bf16 v[68:71], a[4:7], a[120:123], v[68:71]
  ds_read_b64_tr_b16 a[180:181], v227 offset:24576
  v_mfma_f32_16x16x32_bf16 v[100:103], a[4:7], a[124:127], v[100:103]
  ds_read_b64_tr_b16 a[182:183], v227 offset:30720
  v_cvt_pk_bf16_f32 v161, v162, v163
  s_waitcnt lgkmcnt(12)
  v_mfma_f32_16x16x32_bf16 v[96:99], a[128:131], a[76:79], v[96:99]
  ds_read_b64_tr_b16 a[184:185], v226 offset:36864
  v_mfma_f32_16x16x32_bf16 v[64:67], a[128:131], a[72:75], v[64:67]
  ds_read_b64_tr_b16 a[186:187], v226 offset:43008
  v_cvt_pk_bf16_f32 v162, v164, v165
  v_mfma_f32_16x16x32_bf16 v[32:35], a[128:131], a[68:71], v[32:35]
  ds_read_b64_tr_b16 a[188:189], v227 offset:36864
  v_mfma_f32_16x16x32_bf16 v[0:3], a[128:131], a[64:67], v[0:3]
  ds_read_b64_tr_b16 a[190:191], v227 offset:43008
  v_cvt_pk_bf16_f32 v163, v166, v167
  v_mfma_f32_16x16x32_bf16 v[4:7], a[132:135], a[64:67], v[4:7]
  buffer_store_dwordx4 v[160:163], v233, s[84:87], s33 offen offset:0 sc1
  v_mfma_f32_16x16x32_bf16 v[36:39], a[132:135], a[68:71], v[36:39]
  v_mfma_f32_16x16x32_bf16 v[68:71], a[132:135], a[72:75], v[68:71]
  v_cvt_pk_bf16_f32 v168, v168, v169
  v_mfma_f32_16x16x32_bf16 v[100:103], a[132:135], a[76:79], v[100:103]
  v_mfma_f32_16x16x32_bf16 v[96:99], a[136:139], a[92:95], v[96:99]
  v_cvt_pk_bf16_f32 v169, v170, v171
  ds_write_b128 v237, v[24:27] offset:16384
  v_mfma_f32_16x16x32_bf16 v[64:67], a[136:139], a[88:91], v[64:67]
  v_mfma_f32_16x16x32_bf16 v[32:35], a[136:139], a[84:87], v[32:35]
  v_cvt_pk_bf16_f32 v170, v172, v173
  v_mfma_f32_16x16x32_bf16 v[0:3], a[136:139], a[80:83], v[0:3]
  v_mfma_f32_16x16x32_bf16 v[4:7], a[140:143], a[80:83], v[4:7]
  v_cvt_pk_bf16_f32 v171, v174, v175
  ds_write_b128 v237, v[56:59] offset:17408
  v_mfma_f32_16x16x32_bf16 v[36:39], a[140:143], a[84:87], v[36:39]
  buffer_store_dwordx4 v[168:171], v233, s[84:87], s33 offen offset:2048 sc1
  v_mfma_f32_16x16x32_bf16 v[68:71], a[140:143], a[88:91], v[68:71]
  v_mfma_f32_16x16x32_bf16 v[100:103], a[140:143], a[92:95], v[100:103]
  v_cvt_pk_bf16_f32 v176, v176, v177
  v_mfma_f32_16x16x32_bf16 v[96:99], a[144:147], a[204:207], v[96:99]
  ds_write_b128 v237, v[88:91] offset:24576
  v_mfma_f32_16x16x32_bf16 v[64:67], a[144:147], a[200:203], v[64:67]
  v_cvt_pk_bf16_f32 v177, v178, v179
  v_mfma_f32_16x16x32_bf16 v[32:35], a[144:147], a[196:199], v[32:35]
  v_mfma_f32_16x16x32_bf16 v[0:3], a[144:147], a[192:195], v[0:3]
  v_cvt_pk_bf16_f32 v178, v180, v181
  v_mfma_f32_16x16x32_bf16 v[4:7], a[148:151], a[192:195], v[4:7]
  ds_write_b128 v237, v[120:123] offset:25600
  v_mfma_f32_16x16x32_bf16 v[36:39], a[148:151], a[196:199], v[36:39]
  v_cvt_pk_bf16_f32 v179, v182, v183
  v_mfma_f32_16x16x32_bf16 v[68:71], a[148:151], a[200:203], v[68:71]
  buffer_store_dwordx4 v[176:179], v233, s[84:87], s33 offen offset:1024 sc1
  v_mfma_f32_16x16x32_bf16 v[100:103], a[148:151], a[204:207], v[100:103]
  v_mfma_f32_16x16x32_bf16 v[96:99], a[152:155], a[220:223], v[96:99]
  v_cvt_pk_bf16_f32 v184, v184, v185
  v_mfma_f32_16x16x32_bf16 v[64:67], a[152:155], a[216:219], v[64:67]
  v_mfma_f32_16x16x32_bf16 v[32:35], a[152:155], a[212:215], v[32:35]
  v_cvt_pk_bf16_f32 v185, v186, v187
  v_mfma_f32_16x16x32_bf16 v[0:3], a[152:155], a[208:211], v[0:3]
  v_mfma_f32_16x16x32_bf16 v[4:7], a[156:159], a[208:211], v[4:7]
  v_cvt_pk_bf16_f32 v186, v188, v189
  v_mfma_f32_16x16x32_bf16 v[36:39], a[156:159], a[212:215], v[36:39]
  v_mfma_f32_16x16x32_bf16 v[68:71], a[156:159], a[216:219], v[68:71]
  v_cvt_pk_bf16_f32 v187, v190, v191
  v_mfma_f32_16x16x32_bf16 v[100:103], a[156:159], a[220:223], v[100:103]
  buffer_store_dwordx4 v[184:187], v233, s[84:87], s33 offen offset:3072 sc1
  s_waitcnt vmcnt(8)
  s_barrier
  s_cmp_lg_u32 s40, 0
  s_cbranch_scc1 G1qkv_nofq
  v_mov_b32 v234, s3
  v_mov_b32 v235, 0
  s_mov_b64 exec, 1
  buffer_store_dword v234, v235, s[84:87], s99 offen offset:256 sc1
  s_mov_b64 exec, -1
G1qkv_nofq:
  v_mfma_f32_16x16x32_bf16 v[104:107], a[8:11], a[124:127], v[104:107]
  s_nop 0
  v_mfma_f32_16x16x32_bf16 v[72:75], a[8:11], a[120:123], v[72:75]
  s_nop 0
  v_mfma_f32_16x16x32_bf16 v[40:43], a[8:11], a[116:119], v[40:43]
  s_nop 0
  v_mfma_f32_16x16x32_bf16 v[8:11], a[8:11], a[112:115], v[8:11]
  s_nop 0
  v_mfma_f32_16x16x32_bf16 v[12:15], a[12:15], a[112:115], v[12:15]
  v_mul_f32 v0, s58, v0
  v_mfma_f32_16x16x32_bf16 v[44:47], a[12:15], a[116:119], v[44:47]
  v_mul_f32 v1, s58, v1
  v_mfma_f32_16x16x32_bf16 v[76:79], a[12:15], a[120:123], v[76:79]
  v_mul_f32 v2, s58, v2
  v_mul_f32 v3, s58, v3
  v_mfma_f32_16x16x32_bf16 v[108:111], a[12:15], a[124:127], v[108:111]
  v_mul_f32 v4, s58, v4
  s_waitcnt lgkmcnt(0)
  v_mfma_f32_16x16x32_bf16 v[104:107], a[160:163], a[76:79], v[104:107]
  v_mul_f32 v5, s58, v5
  v_mfma_f32_16x16x32_bf16 v[72:75], a[160:163], a[72:75], v[72:75]
  v_mul_f32 v6, s58, v6
  v_mul_f32 v7, s58, v7
  ds_write_b128 v237, v[160:163] offset:49152
  v_mfma_f32_16x16x32_bf16 v[40:43], a[160:163], a[68:71], v[40:43]
  v_cvt_pk_bf16_f32 v0, v0, v1
  v_mfma_f32_16x16x32_bf16 v[8:11], a[160:163], a[64:67], v[8:11]
  v_cvt_pk_bf16_f32 v1, v2, v3
  v_mfma_f32_16x16x32_bf16 v[12:15], a[164:167], a[64:67], v[12:15]
  v_cvt_pk_bf16_f32 v2, v4, v5
  v_cvt_pk_bf16_f32 v3, v6, v7
  v_mfma_f32_16x16x32_bf16 v[44:47], a[164:167], a[68:71], v[44:47]
  v_mul_f32 v32, s58, v32
  ds_write_b128 v237, v[176:179] offset:50176
  v_mfma_f32_16x16x32_bf16 v[76:79], a[164:167], a[72:75], v[76:79]
  v_mul_f32 v33, s58, v33
  v_mfma_f32_16x16x32_bf16 v[108:111], a[164:167], a[76:79], v[108:111]
  v_mul_f32 v34, s58, v34
  v_mul_f32 v35, s58, v35
  v_mfma_f32_16x16x32_bf16 v[104:107], a[168:171], a[92:95], v[104:107]
  v_mul_f32 v36, s58, v36
  v_mfma_f32_16x16x32_bf16 v[72:75], a[168:171], a[88:91], v[72:75]
  v_mul_f32 v37, s58, v37
  ds_write_b128 v237, v[168:171] offset:57344
  v_mfma_f32_16x16x32_bf16 v[40:43], a[168:171], a[84:87], v[40:43]
  v_mul_f32 v38, s58, v38
  v_mul_f32 v39, s58, v39
  v_mfma_f32_16x16x32_bf16 v[8:11], a[168:171], a[80:83], v[8:11]
  v_cvt_pk_bf16_f32 v32, v32, v33
  v_mfma_f32_16x16x32_bf16 v[12:15], a[172:175], a[80:83], v[12:15]
  v_cvt_pk_bf16_f32 v33, v34, v35
  v_mfma_f32_16x16x32_bf16 v[44:47], a[172:175], a[84:87], v[44:47]
  v_cvt_pk_bf16_f32 v34, v36, v37
  v_cvt_pk_bf16_f32 v35, v38, v39
  ds_write_b128 v237, v[184:187] offset:58368
  v_mfma_f32_16x16x32_bf16 v[76:79], a[172:175], a[88:91], v[76:79]
  v_mul_f32 v64, s58, v64
  v_mfma_f32_16x16x32_bf16 v[108:111], a[172:175], a[92:95], v[108:111]
  v_mul_f32 v65, s58, v65
  v_mfma_f32_16x16x32_bf16 v[104:107], a[176:179], a[204:207], v[104:107]
  v_mul_f32 v66, s58, v66
  v_mul_f32 v67, s58, v67
  v_mfma_f32_16x16x32_bf16 v[72:75], a[176:179], a[200:203], v[72:75]
  v_mul_f32 v68, s58, v68
  ds_write_b128 v236, v[16:19] offset:16384
  v_mfma_f32_16x16x32_bf16 v[40:43], a[176:179], a[196:199], v[40:43]
  v_mul_f32 v69, s58, v69
  v_mfma_f32_16x16x32_bf16 v[8:11], a[176:179], a[192:195], v[8:11]
  v_mul_f32 v70, s58, v70
  v_mul_f32 v71, s58, v71
  v_mfma_f32_16x16x32_bf16 v[12:15], a[180:183], a[192:195], v[12:15]
  v_cvt_pk_bf16_f32 v64, v64, v65
  v_mfma_f32_16x16x32_bf16 v[44:47], a[180:183], a[196:199], v[44:47]
  v_cvt_pk_bf16_f32 v65, v66, v67
  ds_write_b128 v236, v[48:51] offset:17408
  v_mfma_f32_16x16x32_bf16 v[76:79], a[180:183], a[200:203], v[76:79]
  v_cvt_pk_bf16_f32 v66, v68, v69
  v_cvt_pk_bf16_f32 v67, v70, v71
  v_mfma_f32_16x16x32_bf16 v[108:111], a[180:183], a[204:207], v[108:111]
  v_mul_f32 v96, s58, v96
  v_mfma_f32_16x16x32_bf16 v[104:107], a[184:187], a[220:223], v[104:107]
  v_mul_f32 v97, s58, v97
  v_mfma_f32_16x16x32_bf16 v[72:75], a[184:187], a[216:219], v[72:75]
  v_mul_f32 v98, s58, v98
  v_mul_f32 v99, s58, v99
  ds_write_b128 v236, v[80:83] offset:24576
  v_mfma_f32_16x16x32_bf16 v[40:43], a[184:187], a[212:215], v[40:43]
  v_mul_f32 v100, s58, v100
  v_mfma_f32_16x16x32_bf16 v[8:11], a[184:187], a[208:211], v[8:11]
  v_mul_f32 v101, s58, v101
  v_mfma_f32_16x16x32_bf16 v[12:15], a[188:191], a[208:211], v[12:15]
  v_mul_f32 v102, s58, v102
  v_mul_f32 v103, s58, v103
  v_mfma_f32_16x16x32_bf16 v[44:47], a[188:191], a[212:215], v[44:47]
  v_cvt_pk_bf16_f32 v96, v96, v97
  ds_write_b128 v236, v[112:115] offset:25600
  v_mfma_f32_16x16x32_bf16 v[76:79], a[188:191], a[216:219], v[76:79]
  v_cvt_pk_bf16_f32 v97, v98, v99
  v_mfma_f32_16x16x32_bf16 v[108:111], a[188:191], a[220:223], v[108:111]
  v_cvt_pk_bf16_f32 v98, v100, v101
  v_cvt_pk_bf16_f32 v99, v102, v103
  s_load_dwordx2 s[4:5], s[0:1], 48
  s_load_dwordx2 s[6:7], s[0:1], 16
  s_load_dwordx2 s[16:17], s[0:1], 64
  s_barrier
  ds_write_b128 v236, v[128:131] offset:49152
  ds_write_b128 v236, v[144:147] offset:50176
  s_nop 3
  v_mul_f32 v8, s58, v8
  v_mul_f32 v9, s58, v9
  v_mul_f32 v10, s58, v10
  v_mul_f32 v11, s58, v11
  ds_write_b128 v236, v[136:139] offset:57344
  v_mul_f32 v12, s58, v12
  v_mul_f32 v13, s58, v13
  v_mul_f32 v14, s58, v14
  v_mul_f32 v15, s58, v15
  ds_write_b128 v236, v[152:155] offset:58368
  v_cvt_pk_bf16_f32 v8, v8, v9
  v_cvt_pk_bf16_f32 v9, v10, v11
  v_cvt_pk_bf16_f32 v10, v12, v13
  v_cvt_pk_bf16_f32 v11, v14, v15
  v_mul_f32 v40, s58, v40
  v_mul_f32 v41, s58, v41
  v_mul_f32 v42, s58, v42
  v_mul_f32 v43, s58, v43
  v_mul_f32 v44, s58, v44
  v_mul_f32 v45, s58, v45
  v_mul_f32 v46, s58, v46
  v_mul_f32 v47, s58, v47
  v_cvt_pk_bf16_f32 v40, v40, v41
  v_cvt_pk_bf16_f32 v41, v42, v43
  v_cvt_pk_bf16_f32 v42, v44, v45
  v_cvt_pk_bf16_f32 v43, v46, v47
  v_mul_f32 v72, s58, v72
  v_mul_f32 v73, s58, v73
  v_mul_f32 v74, s58, v74
  v_mul_f32 v75, s58, v75
  v_mul_f32 v76, s58, v76
  v_mul_f32 v77, s58, v77
  v_mul_f32 v78, s58, v78
  v_mul_f32 v79, s58, v79
  v_cvt_pk_bf16_f32 v72, v72, v73
  v_cvt_pk_bf16_f32 v73, v74, v75
  v_cvt_pk_bf16_f32 v74, v76, v77
  v_cvt_pk_bf16_f32 v75, v78, v79
  v_mul_f32 v104, s58, v104
  v_mul_f32 v105, s58, v105
  v_mul_f32 v106, s58, v106
  v_mul_f32 v107, s58, v107
  v_mul_f32 v108, s58, v108
  v_mul_f32 v109, s58, v109
  v_mul_f32 v110, s58, v110
  v_mul_f32 v111, s58, v111
  v_cvt_pk_bf16_f32 v104, v104, v105
  v_cvt_pk_bf16_f32 v105, v106, v107
  v_cvt_pk_bf16_f32 v106, v108, v109
  v_cvt_pk_bf16_f32 v107, v110, v111
  v_accvgpr_write_b32 a64, v0
  v_accvgpr_write_b32 a65, v1
  v_accvgpr_write_b32 a66, v2
  v_accvgpr_write_b32 a67, v3
  v_accvgpr_write_b32 a68, v32
  v_accvgpr_write_b32 a69, v33
  v_accvgpr_write_b32 a70, v34
  v_accvgpr_write_b32 a71, v35
  v_accvgpr_write_b32 a72, v64
  v_accvgpr_write_b32 a73, v65
  v_accvgpr_write_b32 a74, v66
  v_accvgpr_write_b32 a75, v67
  v_accvgpr_write_b32 a76, v96
  v_accvgpr_write_b32 a77, v97
  v_accvgpr_write_b32 a78, v98
  v_accvgpr_write_b32 a79, v99
  v_accvgpr_write_b32 a80, v8
  v_accvgpr_write_b32 a81, v9
  v_accvgpr_write_b32 a82, v10
  v_accvgpr_write_b32 a83, v11
  v_accvgpr_write_b32 a84, v40
  v_accvgpr_write_b32 a85, v41
  v_accvgpr_write_b32 a86, v42
  v_accvgpr_write_b32 a87, v43
  v_accvgpr_write_b32 a88, v72
  v_accvgpr_write_b32 a89, v73
  v_accvgpr_write_b32 a90, v74
  v_accvgpr_write_b32 a91, v75
  v_accvgpr_write_b32 a92, v104
  v_accvgpr_write_b32 a93, v105
  v_accvgpr_write_b32 a94, v106
  v_accvgpr_write_b32 a95, v107
  s_branch MG_att
G1qkv_tail_end:
G1qkv_xspin:
  s_mov_b32 s98, 0
G1qkv_xspin_l:
  s_sleep 2
  buffer_load_dword v2, v0, s[84:87], s36 offen sc1
  s_add_u32 s98, s98, 1
  s_cmp_gt_u32 s98, 400000
  s_cbranch_scc1 G1qkv_xgo
  s_waitcnt vmcnt(0)
  v_cmp_ne_u32 vcc, s3, v2
  s_nop 1
  s_and_b64 vcc, vcc, -1
  s_cbranch_scc1 G1qkv_xspin_l
  s_branch G1qkv_xgo
G1qkv_tok:
  s_mov_b32 s98, 0
  s_mov_b32 s60, s48
  s_and_b32 s61, s49, 0xffff
  s_mov_b32 s62, 0x100
  s_mov_b32 s63, 0x20000
G1qkv_tok_l:
  s_sleep 2
  buffer_load_dword v64, v65, s[60:63], 0 offen sc1
  s_add_u32 s98, s98, 1
  s_cmp_gt_u32 s98, 400000
  s_cbranch_scc1 G1qkv_tok_ret
  s_waitcnt vmcnt(0)
  v_readfirstlane_b32 s3, v64
  s_nop 1
  s_cmp_eq_u32 s3, 0
  s_cbranch_scc1 G1qkv_tok_l
  s_branch G1qkv_tok_ret
G1_w1:
  v_lshrrev_b32 v234, 3, v253
  s_lshr_b32 s60, s40, 1
  v_and_b32 v235, 6, v234
  s_lshl_b32 s60, s60, 5
  v_and_b32 v236, 7, v253
  s_and_b32 s61, s40, 1
  v_xor_b32 v235, v235, v236
  s_lshl_b32 s61, s61, 2
  v_lshrrev_b32 v236, 2, v234
  s_add_u32 s60, s60, s61
  v_and_b32 v234, 3, v234
  s_mov_b32 s61, 7168
  v_lshl_add_u32 v234, v236, 3, v234
  v_add_u32 v234, s60, v234
  v_mul_lo_u32 v234, v234, s61
  v_lshl_add_u32 v230, v235, 4, v234
  s_and_b32 s62, s45, 1
  s_lshl_b32 s63, s62, 6
  s_xor_b32 s62, s62, 1
  s_mul_i32 s62, s62, 384
  v_add_u32 v230, s63, v230
  v_lshrrev_b32 v234, 4, v253
  v_and_b32 v235, 1, v234
  v_lshlrev_b32 v235, 1, v235
  v_and_b32 v236, 3, v253
  v_xor_b32 v235, v235, v236
  v_bfe_u32 v236, v253, 2, 2
  v_lshl_add_u32 v234, v234, 3, v236
  v_add_u32 v234, s60, v234
  v_mul_lo_u32 v234, v234, s61
  v_lshl_add_u32 v232, v235, 4, v234
  v_add_u32 v232, s62, v232
  v_add_u32 v231, 114688, v230
  v_lshlrev_b32 v233, 4, v253
  s_mul_i32 s50, s45, 448
  s_add_u32 s64, s50, s63
  s_add_u32 s65, s50, s62
  s_mov_b32 s52, 0
  s_mul_i32 s53, s40, 7168
  s_sub_u32 s65, s65, 384
  v_mov_b32 v235, s64
  v_mov_b32 v236, s65
  v_cmp_gt_u32 vcc, 48, v253
  s_nop 1
  v_cndmask_b32 v235, v236, v235, vcc
  v_lshl_add_u32 v237, v253, 3, v235
  s_waitcnt lgkmcnt(0)
  s_mov_b32 s24, s8
  s_and_b32 s25, s9, 0xffff
  s_mov_b32 s26, 0x1c00
  s_mov_b32 s27, 0x20000
  v_mov_b32 v239, v237
  s_mov_b32 s12, s6
  s_and_b32 s13, s7, 0xffff
  s_mov_b32 s14, 0x700000
  s_mov_b32 s15, 0x20000
  s_lshl_b32 s61, s46, 17
  s_add_u32 s62, s10, s61
  s_addc_u32 s63, s11, 0
  s_mov_b32 s16, s62
  s_and_b32 s17, s63, 0xffff
  s_mov_b32 s18, 0x20000
  s_mov_b32 s19, 0x20000
  v_lshrrev_b32 v234, 4, v253
  v_bfe_u32 v235, v253, 2, 2
  v_and_b32 v236, 1, v234
  v_lshl_add_u32 v236, v236, 2, v235
  v_and_b32 v237, 6, v236
  v_bfe_u32 v235, v253, 1, 1
  v_or_b32 v237, v237, v235
  v_lshrrev_b32 v234, 1, v234
  v_lshlrev_b32 v234, 10, v234
  v_lshl_add_u32 v234, v236, 7, v234
  v_and_b32 v235, 1, v253
  v_lshl_add_u32 v234, v235, 3, v234
  v_xor_b32 v235, 0, v237
  v_lshl_add_u32 v224, v235, 4, v234
  v_xor_b32 v235, 2, v237
  v_lshl_add_u32 v225, v235, 4, v234
  v_xor_b32 v235, 4, v237
  v_lshl_add_u32 v226, v235, 4, v234
  v_xor_b32 v235, 6, v237
  v_lshl_add_u32 v227, v235, 4, v234
  v_lshrrev_b32 v234, 2, v253
  v_lshlrev_b32 v234, 6, v234
  v_and_b32 v235, 1, v253
  v_lshl_add_u32 v234, v235, 3, v234
  v_add_u32 v234, 6144, v234
  v_bfe_u32 v235, v253, 4, 1
  v_lshlrev_b32 v235, 1, v235
  v_bfe_u32 v236, v253, 1, 1
  v_or_b32 v235, v235, v236
  v_xor_b32 v236, 0, v235
  v_lshl_add_u32 v228, v236, 4, v234
  v_xor_b32 v236, 2, v235
  v_lshl_add_u32 v229, v236, 4, v234
  s_mul_i32 s60, s46, 589824
  s_add_u32 s60, s60, 16777216
  s_add_u32 s61, s45, 0
  s_and_b32 s61, s61, 15
  s_lshl_b32 s61, s61, 14
  s_add_u32 s61, s61, s60
  s_add_u32 s28, s61, 196608
  s_lshr_b32 s61, s45, 1
  s_and_b32 s62, s45, 1
  s_lshl_b32 s63, s61, 2
  s_add_u32 s64, s63, s62
  s_add_u32 s64, s64, 2
  s_lshl_b32 s64, s64, 12
  s_add_u32 s34, s60, s64
  s_cmp_ge_u32 s61, 8
  s_cselect_b32 s64, 96, 32
  s_lshl_b32 s61, s61, 1
  s_add_u32 s64, s64, s61
  s_cmp_eq_u32 s62, 0
  s_cselect_b32 s64, s63, s64
  s_lshl_b32 s64, s64, 12
  s_add_u32 s32, s60, s64
  s_add_u32 s33, s32, 4096
  v_and_b32 v244, 3, v253
  s_lshl_b32 s60, s46, 2
  v_add_u32 v244, s60, v244
  s_mov_b32 s61, 7168
  v_mul_lo_u32 v244, v244, s61
  v_bfe_u32 v245, v253, 2, 2
  v_lshl_add_u32 v244, v245, 7, v244
  s_mul_i32 s68, s45, 448
  s_and_b32 s68, s68, 0xffffff80
  s_add_u32 s68, s68, 1835008
  s_mov_b32 s72, s70
  s_and_b32 s73, s71, 0xffff
  s_mov_b32 s74, 0x700000
  s_mov_b32 s75, 0x20000
  s_mov_b32 s76, s80
  s_and_b32 s77, s81, 0xffff
  s_mov_b32 s78, 0x200000
  s_mov_b32 s79, 0x20000
  s_lshl_b32 s82, s45, 5
  s_add_u32 s82, s82, s46
  s_lshl_b32 s82, s82, 1
  s_add_u32 s82, s82, 1
  s_lshl_b32 s57, s82, 9
  s_mul_i32 s82, s82, 1280
  v_and_b32 v240, 15, v253
  v_min_u32 v240, 9, v240
  v_lshlrev_b32 v240, 7, v240
  v_and_b32 v241, 0x180, v240
  s_mov_b32 s88, s45
  s_mov_b32 s89, s43
  s_bfe_u32 s60, s2, 0x20001
  s_lshl_b32 s60, s60, 1
  s_bfe_u32 s61, s2, 0x10004
  s_add_u32 s60, s60, s61
  s_lshl_b32 s60, s60, 12
  s_add_u32 s99, s60, 46268416
  s_lshl_b32 s60, s89, 12
  s_lshl_b32 s61, s45, 8
  s_add_u32 s60, s60, s61
  s_add_u32 s83, s60, 46268416
  v_and_b32 v245, 15, v253
  v_lshlrev_b32 v245, 8, v245
  v_and_b32 v0, 3, v253
  v_bfe_u32 v1, v253, 2, 1
  v_lshl_add_u32 v0, v1, 4, v0
  v_lshlrev_b32 v0, 8, v0
  s_lshl_b32 s60, s43, 13
  s_lshl_b32 s61, s40, 10
  s_add_u32 s60, s60, s61
  s_add_u32 s36, s60, 46399488
  s_lshl_b32 s37, s2, 8
  s_add_u32 s37, s37, 46399488
  buffer_load_dwordx2 v[238:239], v239, s[24:27], 0 offen
  s_waitcnt vmcnt(1)
  v_readfirstlane_b32 s3, v64
  s_nop 1
  s_cmp_eq_u32 s3, 0
  s_cbranch_scc1 G1w1_tok
G1w1_tok_ret:
  s_barrier
  s_cmp_lg_u32 s40, 0
  s_cbranch_scc1 G1w1_nofx
  v_mov_b32 v1, s3
  s_mov_b64 exec, 1
  buffer_store_dword v1, v0, s[84:87], s37 offen sc1
  s_mov_b64 exec, -1
G1w1_nofx:
  s_add_u32 m0, s53, 0
  s_nop 0
  buffer_load_dwordx4 v230, s[12:15], s50 offen offset:0 lds
  s_add_u32 m0, s53, 1024
  s_nop 0
  buffer_load_dwordx4 v231, s[12:15], s50 offen offset:0 lds
  s_add_u32 m0, s53, 1920
  s_nop 0
  buffer_load_dwordx4 v230, s[12:15], s50 offen offset:128 lds
  s_add_u32 m0, s53, 2944
  s_nop 0
  buffer_load_dwordx4 v231, s[12:15], s50 offen offset:128 lds
  s_add_u32 m0, s53, 3840
  s_nop 0
  buffer_load_dwordx4 v230, s[12:15], s50 offen offset:256 lds
  s_add_u32 m0, s53, 4864
  s_nop 0
  buffer_load_dwordx4 v231, s[12:15], s50 offen offset:256 lds
  s_add_u32 m0, s53, 6144
  s_nop 0
  buffer_load_dwordx4 v232, s[12:15], s50 offen offset:0 lds
  s_add_u32 s50, s50, 458752
  s_add_u32 s53, s53, 28672
  s_add_u32 m0, s53, 0
  s_nop 0
  buffer_load_dwordx4 v230, s[12:15], s50 offen offset:0 lds
  s_add_u32 m0, s53, 1024
  s_nop 0
  buffer_load_dwordx4 v231, s[12:15], s50 offen offset:0 lds
  s_add_u32 m0, s53, 1920
  s_nop 0
  buffer_load_dwordx4 v230, s[12:15], s50 offen offset:128 lds
  s_add_u32 m0, s53, 2944
  s_nop 0
  buffer_load_dwordx4 v231, s[12:15], s50 offen offset:128 lds
  s_add_u32 m0, s53, 3840
  s_nop 0
  buffer_load_dwordx4 v230, s[12:15], s50 offen offset:256 lds
  s_add_u32 m0, s53, 4864
  s_nop 0
  buffer_load_dwordx4 v231, s[12:15], s50 offen offset:256 lds
  s_add_u32 m0, s53, 6144
  s_nop 0
  buffer_load_dwordx4 v232, s[12:15], s50 offen offset:0 lds
  s_add_u32 s50, s50, 458752
  s_add_u32 s53, s53, 28672
  buffer_load_dword v2, v0, s[84:87], s36 offen sc1
  v_lshrrev_b32 v234, 4, v253
  v_lshlrev_b32 v234, 2, v234
  s_waitcnt vmcnt(15)
  ds_bpermute_b32 v26, v234, v238 offset:0
  ds_bpermute_b32 v27, v234, v239 offset:0
  ds_bpermute_b32 v30, v234, v238 offset:16
  ds_bpermute_b32 v31, v234, v239 offset:16
  ds_bpermute_b32 v58, v234, v238 offset:32
  ds_bpermute_b32 v59, v234, v239 offset:32
  ds_bpermute_b32 v62, v234, v238 offset:48
  ds_bpermute_b32 v63, v234, v239 offset:48
  ds_bpermute_b32 v90, v234, v238 offset:64
  ds_bpermute_b32 v91, v234, v239 offset:64
  ds_bpermute_b32 v94, v234, v238 offset:80
  ds_bpermute_b32 v95, v234, v239 offset:80
  ds_bpermute_b32 v122, v234, v238 offset:96
  ds_bpermute_b32 v123, v234, v239 offset:96
  s_waitcnt lgkmcnt(0)
  ds_bpermute_b32 v126, v234, v238 offset:112
  ds_bpermute_b32 v127, v234, v239 offset:112
  ds_bpermute_b32 v154, v234, v238 offset:128
  ds_bpermute_b32 v155, v234, v239 offset:128
  ds_bpermute_b32 v158, v234, v238 offset:144
  ds_bpermute_b32 v159, v234, v239 offset:144
  ds_bpermute_b32 v186, v234, v238 offset:160
  ds_bpermute_b32 v187, v234, v239 offset:160
  ds_bpermute_b32 v190, v234, v238 offset:176
  ds_bpermute_b32 v191, v234, v239 offset:176
  ds_bpermute_b32 v218, v234, v238 offset:192
  ds_bpermute_b32 v219, v234, v239 offset:192
  ds_bpermute_b32 v222, v234, v238 offset:208
  ds_bpermute_b32 v223, v234, v239 offset:208
  s_waitcnt lgkmcnt(0)
  v_lshlrev_b32 v24, 16, v26
  v_and_b32 v25, 0xffff0000, v26
  v_lshlrev_b32 v26, 16, v27
  v_and_b32 v27, 0xffff0000, v27
  v_lshlrev_b32 v28, 16, v30
  v_and_b32 v29, 0xffff0000, v30
  v_lshlrev_b32 v30, 16, v31
  v_and_b32 v31, 0xffff0000, v31
  v_lshlrev_b32 v56, 16, v58
  v_and_b32 v57, 0xffff0000, v58
  v_lshlrev_b32 v58, 16, v59
  v_and_b32 v59, 0xffff0000, v59
  v_lshlrev_b32 v60, 16, v62
  v_and_b32 v61, 0xffff0000, v62
  v_lshlrev_b32 v62, 16, v63
  v_and_b32 v63, 0xffff0000, v63
  v_lshlrev_b32 v88, 16, v90
  v_and_b32 v89, 0xffff0000, v90
  v_lshlrev_b32 v90, 16, v91
  v_and_b32 v91, 0xffff0000, v91
  v_lshlrev_b32 v92, 16, v94
  v_and_b32 v93, 0xffff0000, v94
  v_lshlrev_b32 v94, 16, v95
  v_and_b32 v95, 0xffff0000, v95
  v_lshlrev_b32 v120, 16, v122
  v_and_b32 v121, 0xffff0000, v122
  v_lshlrev_b32 v122, 16, v123
  v_and_b32 v123, 0xffff0000, v123
  v_lshlrev_b32 v124, 16, v126
  v_and_b32 v125, 0xffff0000, v126
  v_lshlrev_b32 v126, 16, v127
  v_and_b32 v127, 0xffff0000, v127
  v_lshlrev_b32 v152, 16, v154
  v_and_b32 v153, 0xffff0000, v154
  v_lshlrev_b32 v154, 16, v155
  v_and_b32 v155, 0xffff0000, v155
  v_lshlrev_b32 v156, 16, v158
  v_and_b32 v157, 0xffff0000, v158
  v_lshlrev_b32 v158, 16, v159
  v_and_b32 v159, 0xffff0000, v159
  v_lshlrev_b32 v184, 16, v186
  v_and_b32 v185, 0xffff0000, v186
  v_lshlrev_b32 v186, 16, v187
  v_and_b32 v187, 0xffff0000, v187
  v_lshlrev_b32 v188, 16, v190
  v_and_b32 v189, 0xffff0000, v190
  v_lshlrev_b32 v190, 16, v191
  v_and_b32 v191, 0xffff0000, v191
  v_lshlrev_b32 v216, 16, v218
  v_and_b32 v217, 0xffff0000, v218
  v_lshlrev_b32 v218, 16, v219
  v_and_b32 v219, 0xffff0000, v219
  v_lshlrev_b32 v220, 16, v222
  v_and_b32 v221, 0xffff0000, v222
  v_lshlrev_b32 v222, 16, v223
  v_and_b32 v223, 0xffff0000, v223
  s_waitcnt vmcnt(0)
  v_cmp_ne_u32 vcc, s3, v2
  s_nop 1
  s_and_b64 vcc, vcc, -1
  s_cbranch_scc1 G1w1_xspin
G1w1_xgo:
  buffer_load_dwordx4 a[64:67], v233, s[16:19], s52 offen offset:0 sc1
  buffer_load_dwordx4 a[68:71], v233, s[16:19], s52 offen offset:1024 sc1
  buffer_load_dwordx4 a[72:75], v233, s[16:19], s52 offen offset:2048 sc1
  buffer_load_dwordx4 a[76:79], v233, s[16:19], s52 offen offset:3072 sc1
  s_add_u32 s52, s52, 4096
  s_barrier
  ds_read_b64_tr_b16 a[0:1], v224 offset:0
  ds_read_b64_tr_b16 a[2:3], v224 offset:7168
  ds_read_b64_tr_b16 a[4:5], v225 offset:0
  ds_read_b64_tr_b16 a[6:7], v225 offset:7168
  buffer_load_dwordx4 a[80:83], v233, s[16:19], s52 offen offset:0 sc1
  ds_read_b64_tr_b16 a[8:9], v226 offset:0
  ds_read_b64_tr_b16 a[10:11], v226 offset:7168
  buffer_load_dwordx4 a[84:87], v233, s[16:19], s52 offen offset:1024 sc1
  ds_read_b64_tr_b16 a[12:13], v227 offset:0
  ds_read_b64_tr_b16 a[14:15], v227 offset:7168
  buffer_load_dwordx4 a[88:91], v233, s[16:19], s52 offen offset:2048 sc1
  ds_read_b64_tr_b16 a[16:17], v224 offset:2048
  ds_read_b64_tr_b16 a[18:19], v224 offset:9216
  buffer_load_dwordx4 a[92:95], v233, s[16:19], s52 offen offset:3072 sc1
  s_add_u32 s52, s52, 4096
  ds_read_b64_tr_b16 a[20:21], v225 offset:2048
  ds_read_b64_tr_b16 a[22:23], v225 offset:9216
  ds_read_b64_tr_b16 a[24:25], v226 offset:2048
  ds_read_b64_tr_b16 a[26:27], v226 offset:9216
  ds_read_b64_tr_b16 a[28:29], v227 offset:2048
  ds_read_b64_tr_b16 a[30:31], v227 offset:9216
  ds_read_b64_tr_b16 a[32:33], v224 offset:4096
  ds_read_b64_tr_b16 a[34:35], v224 offset:11264
  ds_read_b64_tr_b16 a[36:37], v225 offset:4096
  ds_read_b64_tr_b16 a[38:39], v225 offset:11264
  ds_read_b64_tr_b16 a[40:41], v226 offset:4096
  ds_read_b64_tr_b16 a[42:43], v226 offset:11264
  ds_read_b64_tr_b16 a[44:45], v227 offset:4096
  ds_read_b64_tr_b16 a[46:47], v227 offset:11264
  ds_read_b64_tr_b16 a[48:49], v228 offset:0
  ds_read_b64_tr_b16 a[50:51], v228 offset:7168
  s_mov_b32 s54, 28672
  s_mov_b32 s56, 6
  s_mov_b32 s66, 0xfffeb000
  s_waitcnt lgkmcnt(0)
  s_waitcnt vmcnt(4)
  v_mfma_f32_16x16x32_bf16 v[0:3], a[0:3], a[64:67], v[24:27]
  ds_read_b64_tr_b16 a[52:53], v229 offset:0
  v_mfma_f32_16x16x32_bf16 v[8:11], a[0:3], a[68:71], v[24:27]
  ds_read_b64_tr_b16 a[54:55], v229 offset:7168
  v_mfma_f32_16x16x32_bf16 v[16:19], a[0:3], a[72:75], v[24:27]
  buffer_load_dwordx4 a[96:99], v233, s[16:19], s52 offen offset:0 sc1
  v_mfma_f32_16x16x32_bf16 v[24:27], a[0:3], a[76:79], v[24:27]
  buffer_load_dwordx4 a[100:103], v233, s[16:19], s52 offen offset:1024 sc1
  v_mfma_f32_16x16x32_bf16 v[4:7], a[4:7], a[64:67], v[28:31]
  ds_read_b64_tr_b16 a[0:1], v224 offset:14336
  v_mfma_f32_16x16x32_bf16 v[12:15], a[4:7], a[68:71], v[28:31]
  ds_read_b64_tr_b16 a[2:3], v224 offset:21504
  v_mfma_f32_16x16x32_bf16 v[20:23], a[4:7], a[72:75], v[28:31]
  v_mfma_f32_16x16x32_bf16 v[28:31], a[4:7], a[76:79], v[28:31]
  buffer_load_dwordx4 a[104:107], v233, s[16:19], s52 offen offset:2048 sc1
  v_mfma_f32_16x16x32_bf16 v[32:35], a[8:11], a[64:67], v[56:59]
  ds_read_b64_tr_b16 a[4:5], v225 offset:14336
  v_mfma_f32_16x16x32_bf16 v[40:43], a[8:11], a[68:71], v[56:59]
  ds_read_b64_tr_b16 a[6:7], v225 offset:21504
  v_mfma_f32_16x16x32_bf16 v[48:51], a[8:11], a[72:75], v[56:59]
  v_mfma_f32_16x16x32_bf16 v[56:59], a[8:11], a[76:79], v[56:59]
  buffer_load_dwordx4 a[108:111], v233, s[16:19], s52 offen offset:3072 sc1
  v_mfma_f32_16x16x32_bf16 v[36:39], a[12:15], a[64:67], v[60:63]
  ds_read_b64_tr_b16 a[8:9], v226 offset:14336
  s_add_u32 s52, s52, 4096
  v_mfma_f32_16x16x32_bf16 v[44:47], a[12:15], a[68:71], v[60:63]
  ds_read_b64_tr_b16 a[10:11], v226 offset:21504
  s_waitcnt lgkmcnt(8)
  v_mfma_f32_16x16x32_bf16 v[52:55], a[12:15], a[72:75], v[60:63]
  s_add_u32 m0, s53, 0
  v_mfma_f32_16x16x32_bf16 v[60:63], a[12:15], a[76:79], v[60:63]
  buffer_load_dwordx4 v230, s[12:15], s50 offen offset:0 lds
  v_mfma_f32_16x16x32_bf16 v[64:67], a[16:19], a[64:67], v[88:91]
  ds_read_b64_tr_b16 a[12:13], v227 offset:14336
  v_mfma_f32_16x16x32_bf16 v[72:75], a[16:19], a[68:71], v[88:91]
  ds_read_b64_tr_b16 a[14:15], v227 offset:21504
  v_mfma_f32_16x16x32_bf16 v[80:83], a[16:19], a[72:75], v[88:91]
  s_add_u32 m0, s53, 1024
  v_mfma_f32_16x16x32_bf16 v[88:91], a[16:19], a[76:79], v[88:91]
  buffer_load_dwordx4 v231, s[12:15], s50 offen offset:0 lds
  v_mfma_f32_16x16x32_bf16 v[68:71], a[20:23], a[64:67], v[92:95]
  ds_read_b64_tr_b16 a[16:17], v224 offset:16384
  v_mfma_f32_16x16x32_bf16 v[76:79], a[20:23], a[68:71], v[92:95]
  ds_read_b64_tr_b16 a[18:19], v224 offset:23552
  v_mfma_f32_16x16x32_bf16 v[84:87], a[20:23], a[72:75], v[92:95]
  s_add_u32 m0, s53, 1920
  v_mfma_f32_16x16x32_bf16 v[92:95], a[20:23], a[76:79], v[92:95]
  buffer_load_dwordx4 v230, s[12:15], s50 offen offset:128 lds
  v_mfma_f32_16x16x32_bf16 v[96:99], a[24:27], a[64:67], v[120:123]
  ds_read_b64_tr_b16 a[20:21], v225 offset:16384
  v_mfma_f32_16x16x32_bf16 v[104:107], a[24:27], a[68:71], v[120:123]
  ds_read_b64_tr_b16 a[22:23], v225 offset:23552
  v_mfma_f32_16x16x32_bf16 v[112:115], a[24:27], a[72:75], v[120:123]
  s_add_u32 m0, s53, 2944
  v_mfma_f32_16x16x32_bf16 v[120:123], a[24:27], a[76:79], v[120:123]
  buffer_load_dwordx4 v231, s[12:15], s50 offen offset:128 lds
  v_mfma_f32_16x16x32_bf16 v[100:103], a[28:31], a[64:67], v[124:127]
  ds_read_b64_tr_b16 a[24:25], v226 offset:16384
  v_mfma_f32_16x16x32_bf16 v[108:111], a[28:31], a[68:71], v[124:127]
  ds_read_b64_tr_b16 a[26:27], v226 offset:23552
  v_mfma_f32_16x16x32_bf16 v[116:119], a[28:31], a[72:75], v[124:127]
  buffer_load_dwordx4 a[112:115], v233, s[16:19], s52 offen offset:0 sc1
  v_mfma_f32_16x16x32_bf16 v[124:127], a[28:31], a[76:79], v[124:127]
  v_mfma_f32_16x16x32_bf16 v[128:131], a[32:35], a[64:67], v[152:155]
  ds_read_b64_tr_b16 a[28:29], v227 offset:16384
  v_mfma_f32_16x16x32_bf16 v[136:139], a[32:35], a[68:71], v[152:155]
  ds_read_b64_tr_b16 a[30:31], v227 offset:23552
  v_mfma_f32_16x16x32_bf16 v[144:147], a[32:35], a[72:75], v[152:155]
  buffer_load_dwordx4 a[116:119], v233, s[16:19], s52 offen offset:1024 sc1
  v_mfma_f32_16x16x32_bf16 v[152:155], a[32:35], a[76:79], v[152:155]
  v_mfma_f32_16x16x32_bf16 v[132:135], a[36:39], a[64:67], v[156:159]
  ds_read_b64_tr_b16 a[32:33], v224 offset:18432
  v_mfma_f32_16x16x32_bf16 v[140:143], a[36:39], a[68:71], v[156:159]
  ds_read_b64_tr_b16 a[34:35], v224 offset:25600
  v_add_u32 v224, 28672, v224
  v_mfma_f32_16x16x32_bf16 v[148:151], a[36:39], a[72:75], v[156:159]
  buffer_load_dwordx4 a[120:123], v233, s[16:19], s52 offen offset:2048 sc1
  v_mfma_f32_16x16x32_bf16 v[156:159], a[36:39], a[76:79], v[156:159]
  v_mfma_f32_16x16x32_bf16 v[160:163], a[40:43], a[64:67], v[184:187]
  ds_read_b64_tr_b16 a[36:37], v225 offset:18432
  s_waitcnt lgkmcnt(8)
  v_mfma_f32_16x16x32_bf16 v[168:171], a[40:43], a[68:71], v[184:187]
  ds_read_b64_tr_b16 a[38:39], v225 offset:25600
  v_add_u32 v225, 28672, v225
  v_mfma_f32_16x16x32_bf16 v[176:179], a[40:43], a[72:75], v[184:187]
  buffer_load_dwordx4 a[124:127], v233, s[16:19], s52 offen offset:3072 sc1
  v_mfma_f32_16x16x32_bf16 v[184:187], a[40:43], a[76:79], v[184:187]
  s_add_u32 s52, s52, 4096
  v_mfma_f32_16x16x32_bf16 v[164:167], a[44:47], a[64:67], v[188:191]
  ds_read_b64_tr_b16 a[40:41], v226 offset:18432
  v_mfma_f32_16x16x32_bf16 v[172:175], a[44:47], a[68:71], v[188:191]
  ds_read_b64_tr_b16 a[42:43], v226 offset:25600
  s_add_u32 m0, s53, 3840
  v_mfma_f32_16x16x32_bf16 v[180:183], a[44:47], a[72:75], v[188:191]
  buffer_load_dwordx4 v230, s[12:15], s50 offen offset:256 lds
  v_mfma_f32_16x16x32_bf16 v[188:191], a[44:47], a[76:79], v[188:191]
  v_add_u32 v226, 28672, v226
  v_mfma_f32_16x16x32_bf16 v[192:195], a[48:51], a[64:67], v[216:219]
  ds_read_b64_tr_b16 a[44:45], v227 offset:18432
  v_mfma_f32_16x16x32_bf16 v[200:203], a[48:51], a[68:71], v[216:219]
  ds_read_b64_tr_b16 a[46:47], v227 offset:25600
  s_add_u32 m0, s53, 4864
  v_mfma_f32_16x16x32_bf16 v[208:211], a[48:51], a[72:75], v[216:219]
  buffer_load_dwordx4 v231, s[12:15], s50 offen offset:256 lds
  v_mfma_f32_16x16x32_bf16 v[216:219], a[48:51], a[76:79], v[216:219]
  v_add_u32 v227, 28672, v227
  v_mfma_f32_16x16x32_bf16 v[196:199], a[52:55], a[64:67], v[220:223]
  ds_read_b64_tr_b16 a[48:49], v228 offset:14336
  v_mfma_f32_16x16x32_bf16 v[204:207], a[52:55], a[68:71], v[220:223]
  ds_read_b64_tr_b16 a[50:51], v228 offset:21504
  s_add_u32 m0, s53, 6144
  v_mfma_f32_16x16x32_bf16 v[212:215], a[52:55], a[72:75], v[220:223]
  buffer_load_dwordx4 v232, s[12:15], s50 offen offset:0 lds
  v_mfma_f32_16x16x32_bf16 v[220:223], a[52:55], a[76:79], v[220:223]
  s_add_u32 s50, s50, 458752
  s_add_u32 s53, s53, 28672
.p2align 4
G1w1_loop:
  s_waitcnt vmcnt(15)
  s_barrier
  v_mfma_f32_16x16x32_bf16 v[0:3], a[0:3], a[80:83], v[0:3]
  ds_read_b64_tr_b16 a[52:53], v229 offset:14336
  v_mfma_f32_16x16x32_bf16 v[8:11], a[0:3], a[84:87], v[8:11]
  ds_read_b64_tr_b16 a[54:55], v229 offset:21504
  v_add_u32 v228, 28672, v228
  v_mfma_f32_16x16x32_bf16 v[16:19], a[0:3], a[88:91], v[16:19]
  buffer_load_dwordx4 a[64:67], v233, s[16:19], s52 offen offset:0 sc1
  v_mfma_f32_16x16x32_bf16 v[24:27], a[0:3], a[92:95], v[24:27]
  buffer_load_dwordx4 a[68:71], v233, s[16:19], s52 offen offset:1024 sc1
  v_mfma_f32_16x16x32_bf16 v[28:31], a[4:7], a[92:95], v[28:31]
  ds_read_b64_tr_b16 a[0:1], v224 offset:0
  v_add_u32 v229, 28672, v229
  v_mfma_f32_16x16x32_bf16 v[20:23], a[4:7], a[88:91], v[20:23]
  ds_read_b64_tr_b16 a[2:3], v224 offset:7168
  v_mfma_f32_16x16x32_bf16 v[12:15], a[4:7], a[84:87], v[12:15]
  v_mfma_f32_16x16x32_bf16 v[4:7], a[4:7], a[80:83], v[4:7]
  buffer_load_dwordx4 a[72:75], v233, s[16:19], s52 offen offset:2048 sc1
  v_mfma_f32_16x16x32_bf16 v[32:35], a[8:11], a[80:83], v[32:35]
  ds_read_b64_tr_b16 a[4:5], v225 offset:0
  v_mfma_f32_16x16x32_bf16 v[40:43], a[8:11], a[84:87], v[40:43]
  ds_read_b64_tr_b16 a[6:7], v225 offset:7168
  v_mfma_f32_16x16x32_bf16 v[48:51], a[8:11], a[88:91], v[48:51]
  v_mfma_f32_16x16x32_bf16 v[56:59], a[8:11], a[92:95], v[56:59]
  buffer_load_dwordx4 a[76:79], v233, s[16:19], s52 offen offset:3072 sc1
  v_mfma_f32_16x16x32_bf16 v[60:63], a[12:15], a[92:95], v[60:63]
  ds_read_b64_tr_b16 a[8:9], v226 offset:0
  s_add_u32 s52, s52, 4096
  v_mfma_f32_16x16x32_bf16 v[52:55], a[12:15], a[88:91], v[52:55]
  ds_read_b64_tr_b16 a[10:11], v226 offset:7168
  s_waitcnt lgkmcnt(8)
  v_mfma_f32_16x16x32_bf16 v[44:47], a[12:15], a[84:87], v[44:47]
  s_add_u32 m0, s53, 0
  v_mfma_f32_16x16x32_bf16 v[36:39], a[12:15], a[80:83], v[36:39]
  buffer_load_dwordx4 v230, s[12:15], s50 offen offset:0 lds
  v_mfma_f32_16x16x32_bf16 v[64:67], a[16:19], a[80:83], v[64:67]
  ds_read_b64_tr_b16 a[12:13], v227 offset:0
  v_mfma_f32_16x16x32_bf16 v[72:75], a[16:19], a[84:87], v[72:75]
  ds_read_b64_tr_b16 a[14:15], v227 offset:7168
  v_mfma_f32_16x16x32_bf16 v[80:83], a[16:19], a[88:91], v[80:83]
  s_add_u32 m0, s53, 1024
  v_mfma_f32_16x16x32_bf16 v[88:91], a[16:19], a[92:95], v[88:91]
  buffer_load_dwordx4 v231, s[12:15], s50 offen offset:0 lds
  v_mfma_f32_16x16x32_bf16 v[92:95], a[20:23], a[92:95], v[92:95]
  ds_read_b64_tr_b16 a[16:17], v224 offset:2048
  v_mfma_f32_16x16x32_bf16 v[84:87], a[20:23], a[88:91], v[84:87]
  ds_read_b64_tr_b16 a[18:19], v224 offset:9216
  v_mfma_f32_16x16x32_bf16 v[76:79], a[20:23], a[84:87], v[76:79]
  s_add_u32 m0, s53, 1920
  v_mfma_f32_16x16x32_bf16 v[68:71], a[20:23], a[80:83], v[68:71]
  buffer_load_dwordx4 v230, s[12:15], s50 offen offset:128 lds
  v_mfma_f32_16x16x32_bf16 v[96:99], a[24:27], a[80:83], v[96:99]
  ds_read_b64_tr_b16 a[20:21], v225 offset:2048
  v_mfma_f32_16x16x32_bf16 v[104:107], a[24:27], a[84:87], v[104:107]
  ds_read_b64_tr_b16 a[22:23], v225 offset:9216
  v_mfma_f32_16x16x32_bf16 v[112:115], a[24:27], a[88:91], v[112:115]
  s_add_u32 m0, s53, 2944
  v_mfma_f32_16x16x32_bf16 v[120:123], a[24:27], a[92:95], v[120:123]
  buffer_load_dwordx4 v231, s[12:15], s50 offen offset:128 lds
  v_mfma_f32_16x16x32_bf16 v[124:127], a[28:31], a[92:95], v[124:127]
  ds_read_b64_tr_b16 a[24:25], v226 offset:2048
  v_mfma_f32_16x16x32_bf16 v[116:119], a[28:31], a[88:91], v[116:119]
  ds_read_b64_tr_b16 a[26:27], v226 offset:9216
  s_add_u32 m0, s53, 3840
  v_mfma_f32_16x16x32_bf16 v[108:111], a[28:31], a[84:87], v[108:111]
  buffer_load_dwordx4 v230, s[12:15], s50 offen offset:256 lds
  v_mfma_f32_16x16x32_bf16 v[100:103], a[28:31], a[80:83], v[100:103]
  v_mfma_f32_16x16x32_bf16 v[128:131], a[32:35], a[80:83], v[128:131]
  ds_read_b64_tr_b16 a[28:29], v227 offset:2048
  v_mfma_f32_16x16x32_bf16 v[136:139], a[32:35], a[84:87], v[136:139]
  ds_read_b64_tr_b16 a[30:31], v227 offset:9216
  s_add_u32 m0, s53, 4864
  v_mfma_f32_16x16x32_bf16 v[144:147], a[32:35], a[88:91], v[144:147]
  buffer_load_dwordx4 v231, s[12:15], s50 offen offset:256 lds
  v_mfma_f32_16x16x32_bf16 v[152:155], a[32:35], a[92:95], v[152:155]
  v_mfma_f32_16x16x32_bf16 v[156:159], a[36:39], a[92:95], v[156:159]
  ds_read_b64_tr_b16 a[32:33], v224 offset:4096
  v_mfma_f32_16x16x32_bf16 v[148:151], a[36:39], a[88:91], v[148:151]
  ds_read_b64_tr_b16 a[34:35], v224 offset:11264
  s_add_u32 m0, s53, 6144
  v_mfma_f32_16x16x32_bf16 v[140:143], a[36:39], a[84:87], v[140:143]
  buffer_load_dwordx4 v232, s[12:15], s50 offen offset:0 lds
  v_mfma_f32_16x16x32_bf16 v[132:135], a[36:39], a[80:83], v[132:135]
  s_add_u32 s50, s50, 458752
  s_add_u32 s53, s53, s66
  v_mfma_f32_16x16x32_bf16 v[160:163], a[40:43], a[80:83], v[160:163]
  ds_read_b64_tr_b16 a[36:37], v225 offset:4096
  s_xor_b32 s66, s66, 0xfffec000
  v_mfma_f32_16x16x32_bf16 v[168:171], a[40:43], a[84:87], v[168:171]
  ds_read_b64_tr_b16 a[38:39], v225 offset:11264
  s_waitcnt lgkmcnt(8)
  v_mfma_f32_16x16x32_bf16 v[176:179], a[40:43], a[88:91], v[176:179]
  buffer_load_dword v242, v240, s[72:75], s82 offen
  v_mfma_f32_16x16x32_bf16 v[184:187], a[40:43], a[92:95], v[184:187]
  s_add_u32 s82, s82, 0x140000
  v_mfma_f32_16x16x32_bf16 v[188:191], a[44:47], a[92:95], v[188:191]
  ds_read_b64_tr_b16 a[40:41], v226 offset:4096
  v_mfma_f32_16x16x32_bf16 v[180:183], a[44:47], a[88:91], v[180:183]
  ds_read_b64_tr_b16 a[42:43], v226 offset:11264
  v_mfma_f32_16x16x32_bf16 v[172:175], a[44:47], a[84:87], v[172:175]
  buffer_load_dword v243, v241, s[76:79], s57 offen
  v_mfma_f32_16x16x32_bf16 v[164:167], a[44:47], a[80:83], v[164:167]
  s_add_u32 s57, s57, 0x80000
  v_mfma_f32_16x16x32_bf16 v[192:195], a[48:51], a[80:83], v[192:195]
  ds_read_b64_tr_b16 a[44:45], v227 offset:4096
  v_mfma_f32_16x16x32_bf16 v[200:203], a[48:51], a[84:87], v[200:203]
  ds_read_b64_tr_b16 a[46:47], v227 offset:11264
  v_mfma_f32_16x16x32_bf16 v[208:211], a[48:51], a[88:91], v[208:211]
  buffer_load_dword v246, v244, s[12:15], s68 offen
  v_mfma_f32_16x16x32_bf16 v[216:219], a[48:51], a[92:95], v[216:219]
  s_add_u32 s68, s68, 917504
  v_mfma_f32_16x16x32_bf16 v[220:223], a[52:55], a[92:95], v[220:223]
  ds_read_b64_tr_b16 a[48:49], v228 offset:0
  v_mfma_f32_16x16x32_bf16 v[212:215], a[52:55], a[88:91], v[212:215]
  ds_read_b64_tr_b16 a[50:51], v228 offset:7168
  v_mfma_f32_16x16x32_bf16 v[204:207], a[52:55], a[84:87], v[204:207]
  global_load_dword v248, v251, s[22:23]
  v_mfma_f32_16x16x32_bf16 v[196:199], a[52:55], a[80:83], v[196:199]
  s_waitcnt vmcnt(26)
  v_mfma_f32_16x16x32_bf16 v[0:3], a[0:3], a[96:99], v[0:3]
  ds_read_b64_tr_b16 a[52:53], v229 offset:0
  v_mfma_f32_16x16x32_bf16 v[8:11], a[0:3], a[100:103], v[8:11]
  ds_read_b64_tr_b16 a[54:55], v229 offset:7168
  v_mfma_f32_16x16x32_bf16 v[16:19], a[0:3], a[104:107], v[16:19]
  v_mfma_f32_16x16x32_bf16 v[24:27], a[0:3], a[108:111], v[24:27]
  v_mfma_f32_16x16x32_bf16 v[28:31], a[4:7], a[108:111], v[28:31]
  ds_read_b64_tr_b16 a[0:1], v224 offset:14336
  v_mfma_f32_16x16x32_bf16 v[20:23], a[4:7], a[104:107], v[20:23]
  ds_read_b64_tr_b16 a[2:3], v224 offset:21504
  v_mfma_f32_16x16x32_bf16 v[12:15], a[4:7], a[100:103], v[12:15]
  v_mfma_f32_16x16x32_bf16 v[4:7], a[4:7], a[96:99], v[4:7]
  v_mfma_f32_16x16x32_bf16 v[32:35], a[8:11], a[96:99], v[32:35]
  ds_read_b64_tr_b16 a[4:5], v225 offset:14336
  v_mfma_f32_16x16x32_bf16 v[40:43], a[8:11], a[100:103], v[40:43]
  ds_read_b64_tr_b16 a[6:7], v225 offset:21504
  v_mfma_f32_16x16x32_bf16 v[48:51], a[8:11], a[104:107], v[48:51]
  v_mfma_f32_16x16x32_bf16 v[56:59], a[8:11], a[108:111], v[56:59]
  v_mfma_f32_16x16x32_bf16 v[60:63], a[12:15], a[108:111], v[60:63]
  ds_read_b64_tr_b16 a[8:9], v226 offset:14336
  s_waitcnt lgkmcnt(8)
  v_mfma_f32_16x16x32_bf16 v[52:55], a[12:15], a[104:107], v[52:55]
  ds_read_b64_tr_b16 a[10:11], v226 offset:21504
  v_mfma_f32_16x16x32_bf16 v[44:47], a[12:15], a[100:103], v[44:47]
  v_mfma_f32_16x16x32_bf16 v[36:39], a[12:15], a[96:99], v[36:39]
  v_mfma_f32_16x16x32_bf16 v[64:67], a[16:19], a[96:99], v[64:67]
  ds_read_b64_tr_b16 a[12:13], v227 offset:14336
  v_mfma_f32_16x16x32_bf16 v[72:75], a[16:19], a[100:103], v[72:75]
  ds_read_b64_tr_b16 a[14:15], v227 offset:21504
  v_mfma_f32_16x16x32_bf16 v[80:83], a[16:19], a[104:107], v[80:83]
  v_mfma_f32_16x16x32_bf16 v[88:91], a[16:19], a[108:111], v[88:91]
  v_mfma_f32_16x16x32_bf16 v[92:95], a[20:23], a[108:111], v[92:95]
  ds_read_b64_tr_b16 a[16:17], v224 offset:16384
  v_mfma_f32_16x16x32_bf16 v[84:87], a[20:23], a[104:107], v[84:87]
  ds_read_b64_tr_b16 a[18:19], v224 offset:23552
  v_mfma_f32_16x16x32_bf16 v[76:79], a[20:23], a[100:103], v[76:79]
  v_mfma_f32_16x16x32_bf16 v[68:71], a[20:23], a[96:99], v[68:71]
  v_mfma_f32_16x16x32_bf16 v[96:99], a[24:27], a[96:99], v[96:99]
  ds_read_b64_tr_b16 a[20:21], v225 offset:16384
  v_mfma_f32_16x16x32_bf16 v[104:107], a[24:27], a[100:103], v[104:107]
  ds_read_b64_tr_b16 a[22:23], v225 offset:23552
  v_mfma_f32_16x16x32_bf16 v[112:115], a[24:27], a[104:107], v[112:115]
  v_mfma_f32_16x16x32_bf16 v[120:123], a[24:27], a[108:111], v[120:123]
  v_mfma_f32_16x16x32_bf16 v[124:127], a[28:31], a[108:111], v[124:127]
  ds_read_b64_tr_b16 a[24:25], v226 offset:16384
  v_mfma_f32_16x16x32_bf16 v[116:119], a[28:31], a[104:107], v[116:119]
  ds_read_b64_tr_b16 a[26:27], v226 offset:23552
  v_mfma_f32_16x16x32_bf16 v[108:111], a[28:31], a[100:103], v[108:111]
  v_mfma_f32_16x16x32_bf16 v[100:103], a[28:31], a[96:99], v[100:103]
  v_mfma_f32_16x16x32_bf16 v[128:131], a[32:35], a[96:99], v[128:131]
  ds_read_b64_tr_b16 a[28:29], v227 offset:16384
  v_mfma_f32_16x16x32_bf16 v[136:139], a[32:35], a[100:103], v[136:139]
  ds_read_b64_tr_b16 a[30:31], v227 offset:23552
  v_mfma_f32_16x16x32_bf16 v[144:147], a[32:35], a[104:107], v[144:147]
  v_mfma_f32_16x16x32_bf16 v[152:155], a[32:35], a[108:111], v[152:155]
  v_mfma_f32_16x16x32_bf16 v[156:159], a[36:39], a[108:111], v[156:159]
  ds_read_b64_tr_b16 a[32:33], v224 offset:18432
  v_mfma_f32_16x16x32_bf16 v[148:151], a[36:39], a[104:107], v[148:151]
  ds_read_b64_tr_b16 a[34:35], v224 offset:25600
  v_add_u32 v224, s54, v224
  v_mfma_f32_16x16x32_bf16 v[140:143], a[36:39], a[100:103], v[140:143]
  v_mfma_f32_16x16x32_bf16 v[132:135], a[36:39], a[96:99], v[132:135]
  v_mfma_f32_16x16x32_bf16 v[160:163], a[40:43], a[96:99], v[160:163]
  ds_read_b64_tr_b16 a[36:37], v225 offset:18432
  s_waitcnt lgkmcnt(8)
  v_mfma_f32_16x16x32_bf16 v[168:171], a[40:43], a[100:103], v[168:171]
  ds_read_b64_tr_b16 a[38:39], v225 offset:25600
  v_add_u32 v225, s54, v225
  v_mfma_f32_16x16x32_bf16 v[176:179], a[40:43], a[104:107], v[176:179]
  v_mfma_f32_16x16x32_bf16 v[184:187], a[40:43], a[108:111], v[184:187]
  v_mfma_f32_16x16x32_bf16 v[188:191], a[44:47], a[108:111], v[188:191]
  ds_read_b64_tr_b16 a[40:41], v226 offset:18432
  v_mfma_f32_16x16x32_bf16 v[180:183], a[44:47], a[104:107], v[180:183]
  ds_read_b64_tr_b16 a[42:43], v226 offset:25600
  v_add_u32 v226, s54, v226
  v_mfma_f32_16x16x32_bf16 v[172:175], a[44:47], a[100:103], v[172:175]
  v_mfma_f32_16x16x32_bf16 v[164:167], a[44:47], a[96:99], v[164:167]
  v_mfma_f32_16x16x32_bf16 v[192:195], a[48:51], a[96:99], v[192:195]
  ds_read_b64_tr_b16 a[44:45], v227 offset:18432
  v_mfma_f32_16x16x32_bf16 v[200:203], a[48:51], a[100:103], v[200:203]
  ds_read_b64_tr_b16 a[46:47], v227 offset:25600
  v_add_u32 v227, s54, v227
  v_mfma_f32_16x16x32_bf16 v[208:211], a[48:51], a[104:107], v[208:211]
  v_mfma_f32_16x16x32_bf16 v[216:219], a[48:51], a[108:111], v[216:219]
  v_mfma_f32_16x16x32_bf16 v[220:223], a[52:55], a[108:111], v[220:223]
  ds_read_b64_tr_b16 a[48:49], v228 offset:14336
  v_mfma_f32_16x16x32_bf16 v[212:215], a[52:55], a[104:107], v[212:215]
  ds_read_b64_tr_b16 a[50:51], v228 offset:21504
  v_mfma_f32_16x16x32_bf16 v[204:207], a[52:55], a[100:103], v[204:207]
  v_mfma_f32_16x16x32_bf16 v[196:199], a[52:55], a[96:99], v[196:199]
  s_waitcnt vmcnt(15)
  s_barrier
  v_mfma_f32_16x16x32_bf16 v[0:3], a[0:3], a[112:115], v[0:3]
  ds_read_b64_tr_b16 a[52:53], v229 offset:14336
  v_mfma_f32_16x16x32_bf16 v[8:11], a[0:3], a[116:119], v[8:11]
  ds_read_b64_tr_b16 a[54:55], v229 offset:21504
  v_add_u32 v228, s54, v228
  v_mfma_f32_16x16x32_bf16 v[16:19], a[0:3], a[120:123], v[16:19]
  buffer_load_dwordx4 a[80:83], v233, s[16:19], s52 offen offset:0 sc1
  v_mfma_f32_16x16x32_bf16 v[24:27], a[0:3], a[124:127], v[24:27]
  v_add_u32 v229, s54, v229
  v_mfma_f32_16x16x32_bf16 v[28:31], a[4:7], a[124:127], v[28:31]
  ds_read_b64_tr_b16 a[0:1], v224 offset:0
  s_xor_b32 s54, s54, 0xfffec000
  v_mfma_f32_16x16x32_bf16 v[20:23], a[4:7], a[120:123], v[20:23]
  ds_read_b64_tr_b16 a[2:3], v224 offset:7168
  v_mfma_f32_16x16x32_bf16 v[12:15], a[4:7], a[116:119], v[12:15]
  buffer_load_dwordx4 a[84:87], v233, s[16:19], s52 offen offset:1024 sc1
  v_mfma_f32_16x16x32_bf16 v[4:7], a[4:7], a[112:115], v[4:7]
  v_mfma_f32_16x16x32_bf16 v[32:35], a[8:11], a[112:115], v[32:35]
  ds_read_b64_tr_b16 a[4:5], v225 offset:0
  v_mfma_f32_16x16x32_bf16 v[40:43], a[8:11], a[116:119], v[40:43]
  ds_read_b64_tr_b16 a[6:7], v225 offset:7168
  v_mfma_f32_16x16x32_bf16 v[48:51], a[8:11], a[120:123], v[48:51]
  v_mfma_f32_16x16x32_bf16 v[56:59], a[8:11], a[124:127], v[56:59]
  buffer_load_dwordx4 a[88:91], v233, s[16:19], s52 offen offset:2048 sc1
  v_mfma_f32_16x16x32_bf16 v[60:63], a[12:15], a[124:127], v[60:63]
  ds_read_b64_tr_b16 a[8:9], v226 offset:0
  s_waitcnt lgkmcnt(8)
  v_mfma_f32_16x16x32_bf16 v[52:55], a[12:15], a[120:123], v[52:55]
  ds_read_b64_tr_b16 a[10:11], v226 offset:7168
  v_mfma_f32_16x16x32_bf16 v[44:47], a[12:15], a[116:119], v[44:47]
  v_mfma_f32_16x16x32_bf16 v[36:39], a[12:15], a[112:115], v[36:39]
  buffer_load_dwordx4 a[92:95], v233, s[16:19], s52 offen offset:3072 sc1
  v_mfma_f32_16x16x32_bf16 v[64:67], a[16:19], a[112:115], v[64:67]
  ds_read_b64_tr_b16 a[12:13], v227 offset:0
  s_add_u32 s52, s52, 4096
  v_mfma_f32_16x16x32_bf16 v[72:75], a[16:19], a[116:119], v[72:75]
  ds_read_b64_tr_b16 a[14:15], v227 offset:7168
  v_mfma_f32_16x16x32_bf16 v[80:83], a[16:19], a[120:123], v[80:83]
  v_mfma_f32_16x16x32_bf16 v[88:91], a[16:19], a[124:127], v[88:91]
  v_mfma_f32_16x16x32_bf16 v[92:95], a[20:23], a[124:127], v[92:95]
  ds_read_b64_tr_b16 a[16:17], v224 offset:2048
  v_mfma_f32_16x16x32_bf16 v[84:87], a[20:23], a[120:123], v[84:87]
  ds_read_b64_tr_b16 a[18:19], v224 offset:9216
  v_mfma_f32_16x16x32_bf16 v[76:79], a[20:23], a[116:119], v[76:79]
  buffer_load_dwordx4 a[96:99], v233, s[16:19], s52 offen offset:0 sc1
  v_mfma_f32_16x16x32_bf16 v[68:71], a[20:23], a[112:115], v[68:71]
  v_mfma_f32_16x16x32_bf16 v[96:99], a[24:27], a[112:115], v[96:99]
  ds_read_b64_tr_b16 a[20:21], v225 offset:2048
  v_mfma_f32_16x16x32_bf16 v[104:107], a[24:27], a[116:119], v[104:107]
  ds_read_b64_tr_b16 a[22:23], v225 offset:9216
  v_mfma_f32_16x16x32_bf16 v[112:115], a[24:27], a[120:123], v[112:115]
  buffer_load_dwordx4 a[100:103], v233, s[16:19], s52 offen offset:1024 sc1
  v_mfma_f32_16x16x32_bf16 v[120:123], a[24:27], a[124:127], v[120:123]
  v_mfma_f32_16x16x32_bf16 v[124:127], a[28:31], a[124:127], v[124:127]
  ds_read_b64_tr_b16 a[24:25], v226 offset:2048
  v_mfma_f32_16x16x32_bf16 v[116:119], a[28:31], a[120:123], v[116:119]
  ds_read_b64_tr_b16 a[26:27], v226 offset:9216
  v_mfma_f32_16x16x32_bf16 v[108:111], a[28:31], a[116:119], v[108:111]
  v_mfma_f32_16x16x32_bf16 v[100:103], a[28:31], a[112:115], v[100:103]
  buffer_load_dwordx4 a[104:107], v233, s[16:19], s52 offen offset:2048 sc1
  v_mfma_f32_16x16x32_bf16 v[128:131], a[32:35], a[112:115], v[128:131]
  ds_read_b64_tr_b16 a[28:29], v227 offset:2048
  v_mfma_f32_16x16x32_bf16 v[136:139], a[32:35], a[116:119], v[136:139]
  ds_read_b64_tr_b16 a[30:31], v227 offset:9216
  v_mfma_f32_16x16x32_bf16 v[144:147], a[32:35], a[120:123], v[144:147]
  v_mfma_f32_16x16x32_bf16 v[152:155], a[32:35], a[124:127], v[152:155]
  buffer_load_dwordx4 a[108:111], v233, s[16:19], s52 offen offset:3072 sc1
  v_mfma_f32_16x16x32_bf16 v[156:159], a[36:39], a[124:127], v[156:159]
  ds_read_b64_tr_b16 a[32:33], v224 offset:4096
  s_add_u32 s52, s52, 4096
  v_mfma_f32_16x16x32_bf16 v[148:151], a[36:39], a[120:123], v[148:151]
  ds_read_b64_tr_b16 a[34:35], v224 offset:11264
  v_mfma_f32_16x16x32_bf16 v[140:143], a[36:39], a[116:119], v[140:143]
  v_mfma_f32_16x16x32_bf16 v[132:135], a[36:39], a[112:115], v[132:135]
  v_mfma_f32_16x16x32_bf16 v[160:163], a[40:43], a[112:115], v[160:163]
  ds_read_b64_tr_b16 a[36:37], v225 offset:4096
  s_waitcnt lgkmcnt(8)
  v_mfma_f32_16x16x32_bf16 v[168:171], a[40:43], a[116:119], v[168:171]
  ds_read_b64_tr_b16 a[38:39], v225 offset:11264
  s_add_u32 m0, s53, 0
  v_mfma_f32_16x16x32_bf16 v[176:179], a[40:43], a[120:123], v[176:179]
  buffer_load_dwordx4 v230, s[12:15], s50 offen offset:0 lds
  v_mfma_f32_16x16x32_bf16 v[184:187], a[40:43], a[124:127], v[184:187]
  v_mfma_f32_16x16x32_bf16 v[188:191], a[44:47], a[124:127], v[188:191]
  ds_read_b64_tr_b16 a[40:41], v226 offset:4096
  v_mfma_f32_16x16x32_bf16 v[180:183], a[44:47], a[120:123], v[180:183]
  ds_read_b64_tr_b16 a[42:43], v226 offset:11264
  s_add_u32 m0, s53, 1024
  v_mfma_f32_16x16x32_bf16 v[172:175], a[44:47], a[116:119], v[172:175]
  buffer_load_dwordx4 v231, s[12:15], s50 offen offset:0 lds
  v_mfma_f32_16x16x32_bf16 v[164:167], a[44:47], a[112:115], v[164:167]
  v_mfma_f32_16x16x32_bf16 v[192:195], a[48:51], a[112:115], v[192:195]
  ds_read_b64_tr_b16 a[44:45], v227 offset:4096
  v_mfma_f32_16x16x32_bf16 v[200:203], a[48:51], a[116:119], v[200:203]
  ds_read_b64_tr_b16 a[46:47], v227 offset:11264
  v_mfma_f32_16x16x32_bf16 v[208:211], a[48:51], a[120:123], v[208:211]
  s_add_u32 m0, s53, 1920
  v_mfma_f32_16x16x32_bf16 v[216:219], a[48:51], a[124:127], v[216:219]
  buffer_load_dwordx4 v230, s[12:15], s50 offen offset:128 lds
  v_mfma_f32_16x16x32_bf16 v[220:223], a[52:55], a[124:127], v[220:223]
  ds_read_b64_tr_b16 a[48:49], v228 offset:0
  v_mfma_f32_16x16x32_bf16 v[212:215], a[52:55], a[120:123], v[212:215]
  ds_read_b64_tr_b16 a[50:51], v228 offset:7168
  v_mfma_f32_16x16x32_bf16 v[204:207], a[52:55], a[116:119], v[204:207]
  v_mfma_f32_16x16x32_bf16 v[196:199], a[52:55], a[112:115], v[196:199]
  s_waitcnt vmcnt(22)
  v_mfma_f32_16x16x32_bf16 v[0:3], a[0:3], a[64:67], v[0:3]
  ds_read_b64_tr_b16 a[52:53], v229 offset:0
  v_mfma_f32_16x16x32_bf16 v[8:11], a[0:3], a[68:71], v[8:11]
  ds_read_b64_tr_b16 a[54:55], v229 offset:7168
  v_mfma_f32_16x16x32_bf16 v[16:19], a[0:3], a[72:75], v[16:19]
  buffer_load_dwordx4 a[112:115], v233, s[16:19], s52 offen offset:0 sc1
  v_mfma_f32_16x16x32_bf16 v[24:27], a[0:3], a[76:79], v[24:27]
  v_mfma_f32_16x16x32_bf16 v[28:31], a[4:7], a[76:79], v[28:31]
  ds_read_b64_tr_b16 a[0:1], v224 offset:14336
  v_mfma_f32_16x16x32_bf16 v[20:23], a[4:7], a[72:75], v[20:23]
  ds_read_b64_tr_b16 a[2:3], v224 offset:21504
  v_mfma_f32_16x16x32_bf16 v[12:15], a[4:7], a[68:71], v[12:15]
  v_mfma_f32_16x16x32_bf16 v[4:7], a[4:7], a[64:67], v[4:7]
  buffer_load_dwordx4 a[116:119], v233, s[16:19], s52 offen offset:1024 sc1
  v_mfma_f32_16x16x32_bf16 v[32:35], a[8:11], a[64:67], v[32:35]
  ds_read_b64_tr_b16 a[4:5], v225 offset:14336
  v_mfma_f32_16x16x32_bf16 v[40:43], a[8:11], a[68:71], v[40:43]
  ds_read_b64_tr_b16 a[6:7], v225 offset:21504
  v_mfma_f32_16x16x32_bf16 v[48:51], a[8:11], a[72:75], v[48:51]
  v_mfma_f32_16x16x32_bf16 v[56:59], a[8:11], a[76:79], v[56:59]
  v_mfma_f32_16x16x32_bf16 v[60:63], a[12:15], a[76:79], v[60:63]
  ds_read_b64_tr_b16 a[8:9], v226 offset:14336
  s_waitcnt lgkmcnt(8)
  v_mfma_f32_16x16x32_bf16 v[52:55], a[12:15], a[72:75], v[52:55]
  ds_read_b64_tr_b16 a[10:11], v226 offset:21504
  v_mfma_f32_16x16x32_bf16 v[44:47], a[12:15], a[68:71], v[44:47]
  v_mfma_f32_16x16x32_bf16 v[36:39], a[12:15], a[64:67], v[36:39]
  buffer_load_dwordx4 a[120:123], v233, s[16:19], s52 offen offset:2048 sc1
  v_mfma_f32_16x16x32_bf16 v[64:67], a[16:19], a[64:67], v[64:67]
  ds_read_b64_tr_b16 a[12:13], v227 offset:14336
  v_mfma_f32_16x16x32_bf16 v[72:75], a[16:19], a[68:71], v[72:75]
  ds_read_b64_tr_b16 a[14:15], v227 offset:21504
  v_mfma_f32_16x16x32_bf16 v[80:83], a[16:19], a[72:75], v[80:83]
  v_mfma_f32_16x16x32_bf16 v[88:91], a[16:19], a[76:79], v[88:91]
  v_mfma_f32_16x16x32_bf16 v[92:95], a[20:23], a[76:79], v[92:95]
  ds_read_b64_tr_b16 a[16:17], v224 offset:16384
  v_mfma_f32_16x16x32_bf16 v[84:87], a[20:23], a[72:75], v[84:87]
  ds_read_b64_tr_b16 a[18:19], v224 offset:23552
  v_mfma_f32_16x16x32_bf16 v[76:79], a[20:23], a[68:71], v[76:79]
  buffer_load_dwordx4 a[124:127], v233, s[16:19], s52 offen offset:3072 sc1
  v_mfma_f32_16x16x32_bf16 v[68:71], a[20:23], a[64:67], v[68:71]
  s_add_u32 s52, s52, 4096
  v_mfma_f32_16x16x32_bf16 v[96:99], a[24:27], a[64:67], v[96:99]
  ds_read_b64_tr_b16 a[20:21], v225 offset:16384
  v_mfma_f32_16x16x32_bf16 v[104:107], a[24:27], a[68:71], v[104:107]
  ds_read_b64_tr_b16 a[22:23], v225 offset:23552
  v_mfma_f32_16x16x32_bf16 v[112:115], a[24:27], a[72:75], v[112:115]
  v_mfma_f32_16x16x32_bf16 v[120:123], a[24:27], a[76:79], v[120:123]
  v_mfma_f32_16x16x32_bf16 v[124:127], a[28:31], a[76:79], v[124:127]
  ds_read_b64_tr_b16 a[24:25], v226 offset:16384
  v_mfma_f32_16x16x32_bf16 v[116:119], a[28:31], a[72:75], v[116:119]
  ds_read_b64_tr_b16 a[26:27], v226 offset:23552
  s_add_u32 m0, s53, 2944
  v_mfma_f32_16x16x32_bf16 v[108:111], a[28:31], a[68:71], v[108:111]
  buffer_load_dwordx4 v231, s[12:15], s50 offen offset:128 lds
  v_mfma_f32_16x16x32_bf16 v[100:103], a[28:31], a[64:67], v[100:103]
  v_mfma_f32_16x16x32_bf16 v[128:131], a[32:35], a[64:67], v[128:131]
  ds_read_b64_tr_b16 a[28:29], v227 offset:16384
  v_mfma_f32_16x16x32_bf16 v[136:139], a[32:35], a[68:71], v[136:139]
  ds_read_b64_tr_b16 a[30:31], v227 offset:23552
  v_mfma_f32_16x16x32_bf16 v[144:147], a[32:35], a[72:75], v[144:147]
  s_add_u32 m0, s53, 3840
  v_mfma_f32_16x16x32_bf16 v[152:155], a[32:35], a[76:79], v[152:155]
  buffer_load_dwordx4 v230, s[12:15], s50 offen offset:256 lds
  v_mfma_f32_16x16x32_bf16 v[156:159], a[36:39], a[76:79], v[156:159]
  ds_read_b64_tr_b16 a[32:33], v224 offset:18432
  v_mfma_f32_16x16x32_bf16 v[148:151], a[36:39], a[72:75], v[148:151]
  ds_read_b64_tr_b16 a[34:35], v224 offset:25600
  v_add_u32 v224, 28672, v224
  v_mfma_f32_16x16x32_bf16 v[140:143], a[36:39], a[68:71], v[140:143]
  v_mfma_f32_16x16x32_bf16 v[132:135], a[36:39], a[64:67], v[132:135]
  v_mfma_f32_16x16x32_bf16 v[160:163], a[40:43], a[64:67], v[160:163]
  ds_read_b64_tr_b16 a[36:37], v225 offset:18432
  s_waitcnt lgkmcnt(8)
  v_mfma_f32_16x16x32_bf16 v[168:171], a[40:43], a[68:71], v[168:171]
  ds_read_b64_tr_b16 a[38:39], v225 offset:25600
  v_add_u32 v225, 28672, v225
  v_mfma_f32_16x16x32_bf16 v[176:179], a[40:43], a[72:75], v[176:179]
  s_add_u32 m0, s53, 4864
  v_mfma_f32_16x16x32_bf16 v[184:187], a[40:43], a[76:79], v[184:187]
  buffer_load_dwordx4 v231, s[12:15], s50 offen offset:256 lds
  v_mfma_f32_16x16x32_bf16 v[188:191], a[44:47], a[76:79], v[188:191]
  ds_read_b64_tr_b16 a[40:41], v226 offset:18432
  v_mfma_f32_16x16x32_bf16 v[180:183], a[44:47], a[72:75], v[180:183]
  ds_read_b64_tr_b16 a[42:43], v226 offset:25600
  v_add_u32 v226, 28672, v226
  v_mfma_f32_16x16x32_bf16 v[172:175], a[44:47], a[68:71], v[172:175]
  v_mfma_f32_16x16x32_bf16 v[164:167], a[44:47], a[64:67], v[164:167]
  v_mfma_f32_16x16x32_bf16 v[192:195], a[48:51], a[64:67], v[192:195]
  ds_read_b64_tr_b16 a[44:45], v227 offset:18432
  v_mfma_f32_16x16x32_bf16 v[200:203], a[48:51], a[68:71], v[200:203]
  ds_read_b64_tr_b16 a[46:47], v227 offset:25600
  s_add_u32 m0, s53, 6144
  v_mfma_f32_16x16x32_bf16 v[208:211], a[48:51], a[72:75], v[208:211]
  buffer_load_dwordx4 v232, s[12:15], s50 offen offset:0 lds
  v_mfma_f32_16x16x32_bf16 v[216:219], a[48:51], a[76:79], v[216:219]
  s_add_u32 s50, s50, 458752
  s_add_u32 s53, s53, 28672
  v_mfma_f32_16x16x32_bf16 v[220:223], a[52:55], a[76:79], v[220:223]
  ds_read_b64_tr_b16 a[48:49], v228 offset:14336
  v_add_u32 v227, 28672, v227
  v_mfma_f32_16x16x32_bf16 v[212:215], a[52:55], a[72:75], v[212:215]
  ds_read_b64_tr_b16 a[50:51], v228 offset:21504
  v_mfma_f32_16x16x32_bf16 v[204:207], a[52:55], a[68:71], v[204:207]
  v_mfma_f32_16x16x32_bf16 v[196:199], a[52:55], a[64:67], v[196:199]
  s_sub_u32 s56, s56, 1
  s_cmp_lg_u32 s56, 0
  s_cbranch_scc1 G1w1_loop
G1w1_tail:
  s_waitcnt vmcnt(15)
  s_barrier
  v_mfma_f32_16x16x32_bf16 v[0:3], a[0:3], a[80:83], v[0:3]
  ds_read_b64_tr_b16 a[52:53], v229 offset:14336
  v_mfma_f32_16x16x32_bf16 v[8:11], a[0:3], a[84:87], v[8:11]
  ds_read_b64_tr_b16 a[54:55], v229 offset:21504
  v_add_u32 v228, 28672, v228
  v_mfma_f32_16x16x32_bf16 v[16:19], a[0:3], a[88:91], v[16:19]
  buffer_load_dwordx4 a[64:67], v233, s[16:19], s52 offen offset:0 sc1
  v_mfma_f32_16x16x32_bf16 v[24:27], a[0:3], a[92:95], v[24:27]
  v_add_u32 v229, 28672, v229
  v_mfma_f32_16x16x32_bf16 v[28:31], a[4:7], a[92:95], v[28:31]
  ds_read_b64_tr_b16 a[0:1], v224 offset:0
  v_mfma_f32_16x16x32_bf16 v[20:23], a[4:7], a[88:91], v[20:23]
  ds_read_b64_tr_b16 a[2:3], v224 offset:7168
  v_mfma_f32_16x16x32_bf16 v[12:15], a[4:7], a[84:87], v[12:15]
  buffer_load_dwordx4 a[68:71], v233, s[16:19], s52 offen offset:1024 sc1
  v_mfma_f32_16x16x32_bf16 v[4:7], a[4:7], a[80:83], v[4:7]
  v_mfma_f32_16x16x32_bf16 v[32:35], a[8:11], a[80:83], v[32:35]
  ds_read_b64_tr_b16 a[4:5], v225 offset:0
  v_mfma_f32_16x16x32_bf16 v[40:43], a[8:11], a[84:87], v[40:43]
  ds_read_b64_tr_b16 a[6:7], v225 offset:7168
  v_mfma_f32_16x16x32_bf16 v[48:51], a[8:11], a[88:91], v[48:51]
  v_mfma_f32_16x16x32_bf16 v[56:59], a[8:11], a[92:95], v[56:59]
  buffer_load_dwordx4 a[72:75], v233, s[16:19], s52 offen offset:2048 sc1
  v_mfma_f32_16x16x32_bf16 v[60:63], a[12:15], a[92:95], v[60:63]
  ds_read_b64_tr_b16 a[8:9], v226 offset:0
  s_waitcnt lgkmcnt(8)
  v_mfma_f32_16x16x32_bf16 v[52:55], a[12:15], a[88:91], v[52:55]
  ds_read_b64_tr_b16 a[10:11], v226 offset:7168
  v_mfma_f32_16x16x32_bf16 v[44:47], a[12:15], a[84:87], v[44:47]
  v_mfma_f32_16x16x32_bf16 v[36:39], a[12:15], a[80:83], v[36:39]
  buffer_load_dwordx4 a[76:79], v233, s[16:19], s52 offen offset:3072 sc1
  v_mfma_f32_16x16x32_bf16 v[64:67], a[16:19], a[80:83], v[64:67]
  ds_read_b64_tr_b16 a[12:13], v227 offset:0
  s_add_u32 s52, s52, 4096
  v_mfma_f32_16x16x32_bf16 v[72:75], a[16:19], a[84:87], v[72:75]
  ds_read_b64_tr_b16 a[14:15], v227 offset:7168
  v_mfma_f32_16x16x32_bf16 v[80:83], a[16:19], a[88:91], v[80:83]
  v_mfma_f32_16x16x32_bf16 v[88:91], a[16:19], a[92:95], v[88:91]
  v_mfma_f32_16x16x32_bf16 v[92:95], a[20:23], a[92:95], v[92:95]
  ds_read_b64_tr_b16 a[16:17], v224 offset:2048
  v_mfma_f32_16x16x32_bf16 v[84:87], a[20:23], a[88:91], v[84:87]
  ds_read_b64_tr_b16 a[18:19], v224 offset:9216
  s_add_u32 m0, s53, 0
  v_mfma_f32_16x16x32_bf16 v[76:79], a[20:23], a[84:87], v[76:79]
  buffer_load_dwordx4 v230, s[12:15], s50 offen offset:0 lds
  v_mfma_f32_16x16x32_bf16 v[68:71], a[20:23], a[80:83], v[68:71]
  v_mfma_f32_16x16x32_bf16 v[96:99], a[24:27], a[80:83], v[96:99]
  ds_read_b64_tr_b16 a[20:21], v225 offset:2048
  v_mfma_f32_16x16x32_bf16 v[104:107], a[24:27], a[84:87], v[104:107]
  ds_read_b64_tr_b16 a[22:23], v225 offset:9216
  s_add_u32 m0, s53, 1024
  v_mfma_f32_16x16x32_bf16 v[112:115], a[24:27], a[88:91], v[112:115]
  buffer_load_dwordx4 v231, s[12:15], s50 offen offset:0 lds
  v_mfma_f32_16x16x32_bf16 v[120:123], a[24:27], a[92:95], v[120:123]
  v_mfma_f32_16x16x32_bf16 v[124:127], a[28:31], a[92:95], v[124:127]
  ds_read_b64_tr_b16 a[24:25], v226 offset:2048
  v_mfma_f32_16x16x32_bf16 v[116:119], a[28:31], a[88:91], v[116:119]
  ds_read_b64_tr_b16 a[26:27], v226 offset:9216
  v_mfma_f32_16x16x32_bf16 v[108:111], a[28:31], a[84:87], v[108:111]
  s_add_u32 m0, s53, 1920
  v_mfma_f32_16x16x32_bf16 v[100:103], a[28:31], a[80:83], v[100:103]
  buffer_load_dwordx4 v230, s[12:15], s50 offen offset:128 lds
  v_mfma_f32_16x16x32_bf16 v[128:131], a[32:35], a[80:83], v[128:131]
  ds_read_b64_tr_b16 a[28:29], v227 offset:2048
  v_mfma_f32_16x16x32_bf16 v[136:139], a[32:35], a[84:87], v[136:139]
  ds_read_b64_tr_b16 a[30:31], v227 offset:9216
  v_mfma_f32_16x16x32_bf16 v[144:147], a[32:35], a[88:91], v[144:147]
  s_add_u32 m0, s53, 2944
  v_mfma_f32_16x16x32_bf16 v[152:155], a[32:35], a[92:95], v[152:155]
  buffer_load_dwordx4 v231, s[12:15], s50 offen offset:128 lds
  v_mfma_f32_16x16x32_bf16 v[156:159], a[36:39], a[92:95], v[156:159]
  ds_read_b64_tr_b16 a[32:33], v224 offset:4096
  v_mfma_f32_16x16x32_bf16 v[148:151], a[36:39], a[88:91], v[148:151]
  ds_read_b64_tr_b16 a[34:35], v224 offset:11264
  v_mfma_f32_16x16x32_bf16 v[140:143], a[36:39], a[84:87], v[140:143]
  v_mfma_f32_16x16x32_bf16 v[132:135], a[36:39], a[80:83], v[132:135]
  v_mfma_f32_16x16x32_bf16 v[160:163], a[40:43], a[80:83], v[160:163]
  ds_read_b64_tr_b16 a[36:37], v225 offset:4096
  s_waitcnt lgkmcnt(8)
  v_mfma_f32_16x16x32_bf16 v[168:171], a[40:43], a[84:87], v[168:171]
  ds_read_b64_tr_b16 a[38:39], v225 offset:11264
  s_add_u32 m0, s53, 3840
  v_mfma_f32_16x16x32_bf16 v[176:179], a[40:43], a[88:91], v[176:179]
  buffer_load_dwordx4 v230, s[12:15], s50 offen offset:256 lds
  v_mfma_f32_16x16x32_bf16 v[184:187], a[40:43], a[92:95], v[184:187]
  v_mfma_f32_16x16x32_bf16 v[188:191], a[44:47], a[92:95], v[188:191]
  ds_read_b64_tr_b16 a[40:41], v226 offset:4096
  v_mfma_f32_16x16x32_bf16 v[180:183], a[44:47], a[88:91], v[180:183]
  ds_read_b64_tr_b16 a[42:43], v226 offset:11264
  s_add_u32 m0, s53, 4864
  v_mfma_f32_16x16x32_bf16 v[172:175], a[44:47], a[84:87], v[172:175]
  buffer_load_dwordx4 v231, s[12:15], s50 offen offset:256 lds
  v_mfma_f32_16x16x32_bf16 v[164:167], a[44:47], a[80:83], v[164:167]
  v_mfma_f32_16x16x32_bf16 v[192:195], a[48:51], a[80:83], v[192:195]
  ds_read_b64_tr_b16 a[44:45], v227 offset:4096
  v_mfma_f32_16x16x32_bf16 v[200:203], a[48:51], a[84:87], v[200:203]
  ds_read_b64_tr_b16 a[46:47], v227 offset:11264
  v_mfma_f32_16x16x32_bf16 v[208:211], a[48:51], a[88:91], v[208:211]
  s_add_u32 m0, s53, 6144
  v_mfma_f32_16x16x32_bf16 v[216:219], a[48:51], a[92:95], v[216:219]
  buffer_load_dwordx4 v232, s[12:15], s50 offen offset:0 lds
  v_mfma_f32_16x16x32_bf16 v[220:223], a[52:55], a[92:95], v[220:223]
  ds_read_b64_tr_b16 a[48:49], v228 offset:0
  v_mfma_f32_16x16x32_bf16 v[212:215], a[52:55], a[88:91], v[212:215]
  ds_read_b64_tr_b16 a[50:51], v228 offset:7168
  v_mfma_f32_16x16x32_bf16 v[204:207], a[52:55], a[84:87], v[204:207]
  v_mfma_f32_16x16x32_bf16 v[196:199], a[52:55], a[80:83], v[196:199]
  s_waitcnt vmcnt(22)
  v_mfma_f32_16x16x32_bf16 v[0:3], a[0:3], a[96:99], v[0:3]
  ds_read_b64_tr_b16 a[52:53], v229 offset:0
  v_mfma_f32_16x16x32_bf16 v[8:11], a[0:3], a[100:103], v[8:11]
  ds_read_b64_tr_b16 a[54:55], v229 offset:7168
  v_mfma_f32_16x16x32_bf16 v[16:19], a[0:3], a[104:107], v[16:19]
  buffer_load_dwordx4 a[80:83], v233, s[16:19], s52 offen offset:0 sc1
  v_mfma_f32_16x16x32_bf16 v[24:27], a[0:3], a[108:111], v[24:27]
  v_mfma_f32_16x16x32_bf16 v[28:31], a[4:7], a[108:111], v[28:31]
  ds_read_b64_tr_b16 a[0:1], v224 offset:14336
  v_lshrrev_b32 v234, 3, v253
  v_mfma_f32_16x16x32_bf16 v[20:23], a[4:7], a[104:107], v[20:23]
  ds_read_b64_tr_b16 a[2:3], v224 offset:21504
  v_and_b32 v235, 6, v234
  v_mfma_f32_16x16x32_bf16 v[12:15], a[4:7], a[100:103], v[12:15]
  buffer_load_dwordx4 a[84:87], v233, s[16:19], s52 offen offset:1024 sc1
  v_mfma_f32_16x16x32_bf16 v[4:7], a[4:7], a[96:99], v[4:7]
  v_and_b32 v236, 7, v253
  v_xor_b32 v235, v235, v236
  v_mfma_f32_16x16x32_bf16 v[32:35], a[8:11], a[96:99], v[32:35]
  ds_read_b64_tr_b16 a[4:5], v225 offset:14336
  v_lshlrev_b32 v234, 11, v234
  v_mfma_f32_16x16x32_bf16 v[40:43], a[8:11], a[100:103], v[40:43]
  ds_read_b64_tr_b16 a[6:7], v225 offset:21504
  v_lshl_add_u32 v249, v235, 4, v234
  v_mfma_f32_16x16x32_bf16 v[48:51], a[8:11], a[104:107], v[48:51]
  buffer_load_dwordx4 a[88:91], v233, s[16:19], s52 offen offset:2048 sc1
  v_mfma_f32_16x16x32_bf16 v[56:59], a[8:11], a[108:111], v[56:59]
  s_lshl_b32 s41, s40, 14
  s_add_u32 s41, s41, s38
  v_mfma_f32_16x16x32_bf16 v[60:63], a[12:15], a[108:111], v[60:63]
  ds_read_b64_tr_b16 a[8:9], v226 offset:14336
  s_waitcnt lgkmcnt(8)
  v_mfma_f32_16x16x32_bf16 v[52:55], a[12:15], a[104:107], v[52:55]
  ds_read_b64_tr_b16 a[10:11], v226 offset:21504
  v_add_u32 v249, s41, v249
  v_mfma_f32_16x16x32_bf16 v[44:47], a[12:15], a[100:103], v[44:47]
  v_xor_b32 v250, 128, v249
  s_lshl_b32 s44, s40, 11
  v_mfma_f32_16x16x32_bf16 v[36:39], a[12:15], a[96:99], v[36:39]
  buffer_load_dwordx4 a[92:95], v233, s[16:19], s52 offen offset:3072 sc1
  v_mfma_f32_16x16x32_bf16 v[64:67], a[16:19], a[96:99], v[64:67]
  ds_read_b64_tr_b16 a[12:13], v227 offset:14336
  s_add_u32 s52, s52, 4096
  v_mfma_f32_16x16x32_bf16 v[72:75], a[16:19], a[100:103], v[72:75]
  ds_read_b64_tr_b16 a[14:15], v227 offset:21504
  v_mfma_f32_16x16x32_bf16 v[80:83], a[16:19], a[104:107], v[80:83]
  v_mfma_f32_16x16x32_bf16 v[88:91], a[16:19], a[108:111], v[88:91]
  buffer_load_dwordx4 a[192:195], v233, s[16:19], s52 offen offset:0 sc1
  v_mfma_f32_16x16x32_bf16 v[92:95], a[20:23], a[108:111], v[92:95]
  ds_read_b64_tr_b16 a[16:17], v224 offset:16384
  v_mfma_f32_16x16x32_bf16 v[84:87], a[20:23], a[104:107], v[84:87]
  ds_read_b64_tr_b16 a[18:19], v224 offset:23552
  v_mfma_f32_16x16x32_bf16 v[76:79], a[20:23], a[100:103], v[76:79]
  v_mfma_f32_16x16x32_bf16 v[68:71], a[20:23], a[96:99], v[68:71]
  buffer_load_dwordx4 a[196:199], v233, s[16:19], s52 offen offset:1024 sc1
  v_mfma_f32_16x16x32_bf16 v[96:99], a[24:27], a[96:99], v[96:99]
  ds_read_b64_tr_b16 a[20:21], v225 offset:16384
  v_mfma_f32_16x16x32_bf16 v[104:107], a[24:27], a[100:103], v[104:107]
  ds_read_b64_tr_b16 a[22:23], v225 offset:23552
  v_mfma_f32_16x16x32_bf16 v[112:115], a[24:27], a[104:107], v[112:115]
  v_mfma_f32_16x16x32_bf16 v[120:123], a[24:27], a[108:111], v[120:123]
  v_mfma_f32_16x16x32_bf16 v[124:127], a[28:31], a[108:111], v[124:127]
  ds_read_b64_tr_b16 a[24:25], v226 offset:16384
  v_mfma_f32_16x16x32_bf16 v[116:119], a[28:31], a[104:107], v[116:119]
  ds_read_b64_tr_b16 a[26:27], v226 offset:23552
  v_mfma_f32_16x16x32_bf16 v[108:111], a[28:31], a[100:103], v[108:111]
  buffer_load_dwordx4 a[200:203], v233, s[16:19], s52 offen offset:2048 sc1
  v_mfma_f32_16x16x32_bf16 v[100:103], a[28:31], a[96:99], v[100:103]
  v_mfma_f32_16x16x32_bf16 v[128:131], a[32:35], a[96:99], v[128:131]
  ds_read_b64_tr_b16 a[28:29], v227 offset:16384
  v_mfma_f32_16x16x32_bf16 v[136:139], a[32:35], a[100:103], v[136:139]
  ds_read_b64_tr_b16 a[30:31], v227 offset:23552
  v_mfma_f32_16x16x32_bf16 v[144:147], a[32:35], a[104:107], v[144:147]
  buffer_load_dwordx4 a[204:207], v233, s[16:19], s52 offen offset:3072 sc1
  v_mfma_f32_16x16x32_bf16 v[152:155], a[32:35], a[108:111], v[152:155]
  s_add_u32 s52, s52, 4096
  v_mfma_f32_16x16x32_bf16 v[156:159], a[36:39], a[108:111], v[156:159]
  ds_read_b64_tr_b16 a[32:33], v224 offset:18432
  v_mfma_f32_16x16x32_bf16 v[148:151], a[36:39], a[104:107], v[148:151]
  ds_read_b64_tr_b16 a[34:35], v224 offset:25600
  v_add_u32 v224, s54, v224
  v_mfma_f32_16x16x32_bf16 v[140:143], a[36:39], a[100:103], v[140:143]
  buffer_load_dwordx4 a[208:211], v233, s[16:19], s52 offen offset:0 sc1
  v_mfma_f32_16x16x32_bf16 v[132:135], a[36:39], a[96:99], v[132:135]
  v_mfma_f32_16x16x32_bf16 v[160:163], a[40:43], a[96:99], v[160:163]
  ds_read_b64_tr_b16 a[36:37], v225 offset:18432
  s_waitcnt lgkmcnt(8)
  v_mfma_f32_16x16x32_bf16 v[168:171], a[40:43], a[100:103], v[168:171]
  ds_read_b64_tr_b16 a[38:39], v225 offset:25600
  v_add_u32 v225, s54, v225
  v_mfma_f32_16x16x32_bf16 v[176:179], a[40:43], a[104:107], v[176:179]
  v_mfma_f32_16x16x32_bf16 v[184:187], a[40:43], a[108:111], v[184:187]
  buffer_load_dwordx4 a[212:215], v233, s[16:19], s52 offen offset:1024 sc1
  v_mfma_f32_16x16x32_bf16 v[188:191], a[44:47], a[108:111], v[188:191]
  ds_read_b64_tr_b16 a[40:41], v226 offset:18432
  v_mfma_f32_16x16x32_bf16 v[180:183], a[44:47], a[104:107], v[180:183]
  ds_read_b64_tr_b16 a[42:43], v226 offset:25600
  v_add_u32 v226, s54, v226
  v_mfma_f32_16x16x32_bf16 v[172:175], a[44:47], a[100:103], v[172:175]
  v_mfma_f32_16x16x32_bf16 v[164:167], a[44:47], a[96:99], v[164:167]
  buffer_load_dwordx4 a[216:219], v233, s[16:19], s52 offen offset:2048 sc1
  v_mfma_f32_16x16x32_bf16 v[192:195], a[48:51], a[96:99], v[192:195]
  ds_read_b64_tr_b16 a[44:45], v227 offset:18432
  v_mfma_f32_16x16x32_bf16 v[200:203], a[48:51], a[100:103], v[200:203]
  ds_read_b64_tr_b16 a[46:47], v227 offset:25600
  v_add_u32 v227, s54, v227
  v_mfma_f32_16x16x32_bf16 v[208:211], a[48:51], a[104:107], v[208:211]
  v_mfma_f32_16x16x32_bf16 v[216:219], a[48:51], a[108:111], v[216:219]
  buffer_load_dwordx4 a[220:223], v233, s[16:19], s52 offen offset:3072 sc1
  v_mfma_f32_16x16x32_bf16 v[220:223], a[52:55], a[108:111], v[220:223]
  ds_read_b64_tr_b16 a[48:49], v228 offset:14336
  s_add_u32 s52, s52, 4096
  v_mfma_f32_16x16x32_bf16 v[212:215], a[52:55], a[104:107], v[212:215]
  ds_read_b64_tr_b16 a[50:51], v228 offset:21504
  v_mfma_f32_16x16x32_bf16 v[204:207], a[52:55], a[100:103], v[204:207]
  v_mfma_f32_16x16x32_bf16 v[196:199], a[52:55], a[96:99], v[196:199]
  s_waitcnt vmcnt(12)
  s_barrier
  s_mov_b32 s18, s28
  ds_read_b64_tr_b16 a[52:53], v229 offset:14336
  ds_read_b64_tr_b16 a[54:55], v229 offset:21504
  v_add_u32 v228, s54, v228
  v_add_u32 v229, s54, v229
  ds_read_b64_tr_b16 a[128:129], v224 offset:0
  ds_read_b64_tr_b16 a[130:131], v224 offset:7168
  ds_read_b64_tr_b16 a[132:133], v225 offset:0
  ds_read_b64_tr_b16 a[134:135], v225 offset:7168
  ds_read_b64_tr_b16 a[136:137], v224 offset:14336
  ds_read_b64_tr_b16 a[138:139], v224 offset:21504
  ds_read_b64_tr_b16 a[140:141], v225 offset:14336
  ds_read_b64_tr_b16 a[142:143], v225 offset:21504
  s_waitcnt lgkmcnt(10)
  v_mfma_f32_16x16x32_bf16 v[24:27], a[0:3], a[124:127], v[24:27]
  ds_read_b64_tr_b16 a[144:145], v224 offset:28672
  ds_read_b64_tr_b16 a[146:147], v224 offset:35840
  v_mfma_f32_16x16x32_bf16 v[16:19], a[0:3], a[120:123], v[16:19]
  ds_read_b64_tr_b16 a[148:149], v225 offset:28672
  ds_read_b64_tr_b16 a[150:151], v225 offset:35840
  v_mfma_f32_16x16x32_bf16 v[8:11], a[0:3], a[116:119], v[8:11]
  ds_read_b64_tr_b16 a[152:153], v224 offset:43008
  ds_read_b64_tr_b16 a[154:155], v224 offset:50176
  v_mfma_f32_16x16x32_bf16 v[0:3], a[0:3], a[112:115], v[0:3]
  ds_read_b64_tr_b16 a[156:157], v225 offset:43008
  ds_read_b64_tr_b16 a[158:159], v225 offset:50176
  v_mfma_f32_16x16x32_bf16 v[4:7], a[4:7], a[112:115], v[4:7]
  ds_read_b64_tr_b16 a[160:161], v226 offset:0
  ds_read_b64_tr_b16 a[162:163], v226 offset:7168
  v_mfma_f32_16x16x32_bf16 v[12:15], a[4:7], a[116:119], v[12:15]
  ds_read_b64_tr_b16 a[164:165], v227 offset:0
  ds_read_b64_tr_b16 a[166:167], v227 offset:7168
  v_mfma_f32_16x16x32_bf16 v[20:23], a[4:7], a[120:123], v[20:23]
  ds_read_b64_tr_b16 a[168:169], v226 offset:14336
  ds_read_b64_tr_b16 a[170:171], v226 offset:21504
  v_mfma_f32_16x16x32_bf16 v[28:31], a[4:7], a[124:127], v[28:31]
  ds_read_b64_tr_b16 a[172:173], v227 offset:14336
  ds_read_b64_tr_b16 a[174:175], v227 offset:21504
  s_waitcnt lgkmcnt(8)
  v_mfma_f32_16x16x32_bf16 v[24:27], a[128:131], a[76:79], v[24:27]
  ds_read_b64_tr_b16 a[176:177], v226 offset:28672
  ds_read_b64_tr_b16 a[178:179], v226 offset:35840
  v_mfma_f32_16x16x32_bf16 v[16:19], a[128:131], a[72:75], v[16:19]
  ds_read_b64_tr_b16 a[180:181], v227 offset:28672
  ds_read_b64_tr_b16 a[182:183], v227 offset:35840
  v_mfma_f32_16x16x32_bf16 v[8:11], a[128:131], a[68:71], v[8:11]
  ds_read_b64_tr_b16 a[184:185], v226 offset:43008
  ds_read_b64_tr_b16 a[186:187], v226 offset:50176
  v_mfma_f32_16x16x32_bf16 v[0:3], a[128:131], a[64:67], v[0:3]
  ds_read_b64_tr_b16 a[188:189], v227 offset:43008
  ds_read_b64_tr_b16 a[190:191], v227 offset:50176
  s_waitcnt vmcnt(0)
  s_barrier
  v_mfma_f32_16x16x32_bf16 v[4:7], a[132:135], a[64:67], v[4:7]
  s_add_u32 m0, s44, 0
  s_mov_b32 s41, 0
  v_mfma_f32_16x16x32_bf16 v[12:15], a[132:135], a[68:71], v[12:15]
  buffer_load_dwordx4 v249, s[72:75], s41 offen lds
  v_mfma_f32_16x16x32_bf16 v[20:23], a[132:135], a[72:75], v[20:23]
  s_add_u32 m0, s44, 1024
  v_mfma_f32_16x16x32_bf16 v[28:31], a[132:135], a[76:79], v[28:31]
  buffer_load_dwordx4 v250, s[72:75], s41 offen lds
  v_mfma_f32_16x16x32_bf16 v[24:27], a[136:139], a[92:95], v[24:27]
  s_add_u32 m0, s44, 8192
  s_mov_b32 s41, 65536
  v_mfma_f32_16x16x32_bf16 v[16:19], a[136:139], a[88:91], v[16:19]
  buffer_load_dwordx4 v249, s[72:75], s41 offen lds
  v_mfma_f32_16x16x32_bf16 v[8:11], a[136:139], a[84:87], v[8:11]
  s_add_u32 m0, s44, 9216
  v_mfma_f32_16x16x32_bf16 v[0:3], a[136:139], a[80:83], v[0:3]
  buffer_load_dwordx4 v250, s[72:75], s41 offen lds
  v_mfma_f32_16x16x32_bf16 v[4:7], a[140:143], a[80:83], v[4:7]
  s_add_u32 m0, s44, 16384
  s_mov_b32 s41, 131072
  v_mfma_f32_16x16x32_bf16 v[12:15], a[140:143], a[84:87], v[12:15]
  buffer_load_dwordx4 v249, s[72:75], s41 offen lds
  v_mfma_f32_16x16x32_bf16 v[20:23], a[140:143], a[88:91], v[20:23]
  s_add_u32 m0, s44, 17408
  v_mfma_f32_16x16x32_bf16 v[28:31], a[140:143], a[92:95], v[28:31]
  buffer_load_dwordx4 v250, s[72:75], s41 offen lds
  v_mfma_f32_16x16x32_bf16 v[24:27], a[144:147], a[204:207], v[24:27]
  s_add_u32 m0, s44, 24576
  s_mov_b32 s41, 196608
  v_mfma_f32_16x16x32_bf16 v[16:19], a[144:147], a[200:203], v[16:19]
  buffer_load_dwordx4 v249, s[72:75], s41 offen lds
  v_mfma_f32_16x16x32_bf16 v[8:11], a[144:147], a[196:199], v[8:11]
  s_add_u32 m0, s44, 25600
  v_mfma_f32_16x16x32_bf16 v[0:3], a[144:147], a[192:195], v[0:3]
  buffer_load_dwordx4 v250, s[72:75], s41 offen lds
  v_mfma_f32_16x16x32_bf16 v[4:7], a[148:151], a[192:195], v[4:7]
  s_add_u32 m0, s44, 32768
  s_mov_b32 s41, 524288
  v_mfma_f32_16x16x32_bf16 v[12:15], a[148:151], a[196:199], v[12:15]
  buffer_load_dwordx4 v249, s[72:75], s41 offen lds
  v_mfma_f32_16x16x32_bf16 v[20:23], a[148:151], a[200:203], v[20:23]
  s_add_u32 m0, s44, 33792
  v_mfma_f32_16x16x32_bf16 v[28:31], a[148:151], a[204:207], v[28:31]
  buffer_load_dwordx4 v250, s[72:75], s41 offen lds
  v_mfma_f32_16x16x32_bf16 v[24:27], a[152:155], a[220:223], v[24:27]
  s_add_u32 m0, s44, 40960
  s_mov_b32 s41, 589824
  v_mfma_f32_16x16x32_bf16 v[16:19], a[152:155], a[216:219], v[16:19]
  buffer_load_dwordx4 v249, s[72:75], s41 offen lds
  v_mfma_f32_16x16x32_bf16 v[8:11], a[152:155], a[212:215], v[8:11]
  s_add_u32 m0, s44, 41984
  v_mfma_f32_16x16x32_bf16 v[0:3], a[152:155], a[208:211], v[0:3]
  buffer_load_dwordx4 v250, s[72:75], s41 offen lds
  v_mfma_f32_16x16x32_bf16 v[4:7], a[156:159], a[208:211], v[4:7]
  s_add_u32 m0, s44, 49152
  s_mov_b32 s41, 655360
  v_mfma_f32_16x16x32_bf16 v[12:15], a[156:159], a[212:215], v[12:15]
  buffer_load_dwordx4 v249, s[72:75], s41 offen lds
  v_mfma_f32_16x16x32_bf16 v[20:23], a[156:159], a[216:219], v[20:23]
  s_add_u32 m0, s44, 50176
  v_mfma_f32_16x16x32_bf16 v[28:31], a[156:159], a[220:223], v[28:31]
  buffer_load_dwordx4 v250, s[72:75], s41 offen lds
  v_mfma_f32_16x16x32_bf16 v[56:59], a[8:11], a[124:127], v[56:59]
  ds_read_b64_tr_b16 a[128:129], v224 offset:2048
  ds_read_b64_tr_b16 a[130:131], v224 offset:9216
  v_mfma_f32_16x16x32_bf16 v[48:51], a[8:11], a[120:123], v[48:51]
  ds_read_b64_tr_b16 a[132:133], v225 offset:2048
  ds_read_b64_tr_b16 a[134:135], v225 offset:9216
  v_mfma_f32_16x16x32_bf16 v[40:43], a[8:11], a[116:119], v[40:43]
  ds_read_b64_tr_b16 a[136:137], v224 offset:16384
  ds_read_b64_tr_b16 a[138:139], v224 offset:23552
  v_mfma_f32_16x16x32_bf16 v[32:35], a[8:11], a[112:115], v[32:35]
  ds_read_b64_tr_b16 a[140:141], v225 offset:16384
  ds_read_b64_tr_b16 a[142:143], v225 offset:23552
  v_mfma_f32_16x16x32_bf16 v[36:39], a[12:15], a[112:115], v[36:39]
  ds_read_b64_tr_b16 a[144:145], v224 offset:30720
  v_mul_f32 v0, v0, abs(v0)
  v_mfma_f32_16x16x32_bf16 v[44:47], a[12:15], a[116:119], v[44:47]
  ds_read_b64_tr_b16 a[146:147], v224 offset:37888
  v_mul_f32 v1, v1, abs(v1)
  v_mfma_f32_16x16x32_bf16 v[52:55], a[12:15], a[120:123], v[52:55]
  ds_read_b64_tr_b16 a[148:149], v225 offset:30720
  v_mul_f32 v2, v2, abs(v2)
  v_mfma_f32_16x16x32_bf16 v[60:63], a[12:15], a[124:127], v[60:63]
  ds_read_b64_tr_b16 a[150:151], v225 offset:37888
  v_mul_f32 v3, v3, abs(v3)
  s_waitcnt lgkmcnt(12)
  v_mfma_f32_16x16x32_bf16 v[56:59], a[160:163], a[76:79], v[56:59]
  ds_read_b64_tr_b16 a[152:153], v224 offset:45056
  v_mul_f32 v4, v4, abs(v4)
  v_mfma_f32_16x16x32_bf16 v[48:51], a[160:163], a[72:75], v[48:51]
  ds_read_b64_tr_b16 a[154:155], v224 offset:52224
  v_mul_f32 v5, v5, abs(v5)
  v_mfma_f32_16x16x32_bf16 v[40:43], a[160:163], a[68:71], v[40:43]
  ds_read_b64_tr_b16 a[156:157], v225 offset:45056
  v_mul_f32 v6, v6, abs(v6)
  v_mfma_f32_16x16x32_bf16 v[32:35], a[160:163], a[64:67], v[32:35]
  ds_read_b64_tr_b16 a[158:159], v225 offset:52224
  v_mul_f32 v7, v7, abs(v7)
  v_cvt_pk_bf16_f32 v0, v0, v1
  v_mfma_f32_16x16x32_bf16 v[36:39], a[164:167], a[64:67], v[36:39]
  v_cvt_pk_bf16_f32 v1, v2, v3
  v_cvt_pk_bf16_f32 v2, v4, v5
  v_mfma_f32_16x16x32_bf16 v[44:47], a[164:167], a[68:71], v[44:47]
  v_cvt_pk_bf16_f32 v3, v6, v7
  v_pk_max_i16 v0, v0, 0
  v_mfma_f32_16x16x32_bf16 v[52:55], a[164:167], a[72:75], v[52:55]
  v_pk_max_i16 v1, v1, 0
  v_pk_max_i16 v2, v2, 0
  v_mfma_f32_16x16x32_bf16 v[60:63], a[164:167], a[76:79], v[60:63]
  v_pk_max_i16 v3, v3, 0
  buffer_store_dwordx4 v[0:3], v233, s[84:87], s18 offen offset:0 sc1
  v_mfma_f32_16x16x32_bf16 v[56:59], a[168:171], a[92:95], v[56:59]
  v_mul_f32 v8, v8, abs(v8)
  v_mul_f32 v9, v9, abs(v9)
  v_mfma_f32_16x16x32_bf16 v[48:51], a[168:171], a[88:91], v[48:51]
  v_mul_f32 v10, v10, abs(v10)
  v_mul_f32 v11, v11, abs(v11)
  v_mfma_f32_16x16x32_bf16 v[40:43], a[168:171], a[84:87], v[40:43]
  v_mul_f32 v12, v12, abs(v12)
  v_mul_f32 v13, v13, abs(v13)
  v_mul_f32 v14, v14, abs(v14)
  v_mfma_f32_16x16x32_bf16 v[32:35], a[168:171], a[80:83], v[32:35]
  v_mul_f32 v15, v15, abs(v15)
  v_cvt_pk_bf16_f32 v8, v8, v9
  v_mfma_f32_16x16x32_bf16 v[36:39], a[172:175], a[80:83], v[36:39]
  v_cvt_pk_bf16_f32 v9, v10, v11
  v_cvt_pk_bf16_f32 v10, v12, v13
  v_mfma_f32_16x16x32_bf16 v[44:47], a[172:175], a[84:87], v[44:47]
  v_cvt_pk_bf16_f32 v11, v14, v15
  v_pk_max_i16 v8, v8, 0
  v_mfma_f32_16x16x32_bf16 v[52:55], a[172:175], a[88:91], v[52:55]
  v_pk_max_i16 v9, v9, 0
  v_pk_max_i16 v10, v10, 0
  v_mfma_f32_16x16x32_bf16 v[60:63], a[172:175], a[92:95], v[60:63]
  v_pk_max_i16 v11, v11, 0
  buffer_store_dwordx4 v[8:11], v233, s[84:87], s18 offen offset:1024 sc1
  v_mfma_f32_16x16x32_bf16 v[56:59], a[176:179], a[204:207], v[56:59]
  v_mul_f32 v16, v16, abs(v16)
  v_mul_f32 v17, v17, abs(v17)
  v_mfma_f32_16x16x32_bf16 v[48:51], a[176:179], a[200:203], v[48:51]
  v_mul_f32 v18, v18, abs(v18)
  v_mul_f32 v19, v19, abs(v19)
  v_mul_f32 v20, v20, abs(v20)
  v_mfma_f32_16x16x32_bf16 v[40:43], a[176:179], a[196:199], v[40:43]
  v_mul_f32 v21, v21, abs(v21)
  v_mul_f32 v22, v22, abs(v22)
  v_mfma_f32_16x16x32_bf16 v[32:35], a[176:179], a[192:195], v[32:35]
  v_mul_f32 v23, v23, abs(v23)
  v_cvt_pk_bf16_f32 v16, v16, v17
  v_mfma_f32_16x16x32_bf16 v[36:39], a[180:183], a[192:195], v[36:39]
  v_cvt_pk_bf16_f32 v17, v18, v19
  v_cvt_pk_bf16_f32 v18, v20, v21
  v_mfma_f32_16x16x32_bf16 v[44:47], a[180:183], a[196:199], v[44:47]
  v_cvt_pk_bf16_f32 v19, v22, v23
  v_pk_max_i16 v16, v16, 0
  v_mfma_f32_16x16x32_bf16 v[52:55], a[180:183], a[200:203], v[52:55]
  v_pk_max_i16 v17, v17, 0
  v_pk_max_i16 v18, v18, 0
  v_mfma_f32_16x16x32_bf16 v[60:63], a[180:183], a[204:207], v[60:63]
  v_pk_max_i16 v19, v19, 0
  buffer_store_dwordx4 v[16:19], v233, s[84:87], s18 offen offset:2048 sc1
  v_mfma_f32_16x16x32_bf16 v[56:59], a[184:187], a[220:223], v[56:59]
  v_mul_f32 v24, v24, abs(v24)
  v_mul_f32 v25, v25, abs(v25)
  v_mul_f32 v26, v26, abs(v26)
  v_mfma_f32_16x16x32_bf16 v[48:51], a[184:187], a[216:219], v[48:51]
  v_mul_f32 v27, v27, abs(v27)
  v_mul_f32 v28, v28, abs(v28)
  v_mfma_f32_16x16x32_bf16 v[40:43], a[184:187], a[212:215], v[40:43]
  v_mul_f32 v29, v29, abs(v29)
  v_mul_f32 v30, v30, abs(v30)
  v_mfma_f32_16x16x32_bf16 v[32:35], a[184:187], a[208:211], v[32:35]
  v_mul_f32 v31, v31, abs(v31)
  v_cvt_pk_bf16_f32 v24, v24, v25
  v_mfma_f32_16x16x32_bf16 v[36:39], a[188:191], a[208:211], v[36:39]
  v_cvt_pk_bf16_f32 v25, v26, v27
  v_cvt_pk_bf16_f32 v26, v28, v29
  v_mfma_f32_16x16x32_bf16 v[44:47], a[188:191], a[212:215], v[44:47]
  v_cvt_pk_bf16_f32 v27, v30, v31
  v_pk_max_i16 v24, v24, 0
  v_mfma_f32_16x16x32_bf16 v[52:55], a[188:191], a[216:219], v[52:55]
  v_pk_max_i16 v25, v25, 0
  v_pk_max_i16 v26, v26, 0
  v_mfma_f32_16x16x32_bf16 v[60:63], a[188:191], a[220:223], v[60:63]
  v_pk_max_i16 v27, v27, 0
  buffer_store_dwordx4 v[24:27], v233, s[84:87], s18 offen offset:3072 sc1
  s_add_u32 s18, s18, 4096
  v_mfma_f32_16x16x32_bf16 v[88:91], a[16:19], a[124:127], v[88:91]
  ds_read_b64_tr_b16 a[160:161], v226 offset:2048
  ds_read_b64_tr_b16 a[162:163], v226 offset:9216
  v_mfma_f32_16x16x32_bf16 v[80:83], a[16:19], a[120:123], v[80:83]
  ds_read_b64_tr_b16 a[164:165], v227 offset:2048
  ds_read_b64_tr_b16 a[166:167], v227 offset:9216
  v_mfma_f32_16x16x32_bf16 v[72:75], a[16:19], a[116:119], v[72:75]
  ds_read_b64_tr_b16 a[168:169], v226 offset:16384
  ds_read_b64_tr_b16 a[170:171], v226 offset:23552
  v_mfma_f32_16x16x32_bf16 v[64:67], a[16:19], a[112:115], v[64:67]
  ds_read_b64_tr_b16 a[172:173], v227 offset:16384
  ds_read_b64_tr_b16 a[174:175], v227 offset:23552
  v_mfma_f32_16x16x32_bf16 v[68:71], a[20:23], a[112:115], v[68:71]
  ds_read_b64_tr_b16 a[176:177], v226 offset:30720
  v_mul_f32 v32, v32, abs(v32)
  v_mfma_f32_16x16x32_bf16 v[76:79], a[20:23], a[116:119], v[76:79]
  ds_read_b64_tr_b16 a[178:179], v226 offset:37888
  v_mul_f32 v33, v33, abs(v33)
  v_mfma_f32_16x16x32_bf16 v[84:87], a[20:23], a[120:123], v[84:87]
  ds_read_b64_tr_b16 a[180:181], v227 offset:30720
  v_mul_f32 v34, v34, abs(v34)
  v_mfma_f32_16x16x32_bf16 v[92:95], a[20:23], a[124:127], v[92:95]
  ds_read_b64_tr_b16 a[182:183], v227 offset:37888
  v_mul_f32 v35, v35, abs(v35)
  s_waitcnt lgkmcnt(12)
  v_mfma_f32_16x16x32_bf16 v[88:91], a[128:131], a[76:79], v[88:91]
  ds_read_b64_tr_b16 a[184:185], v226 offset:45056
  v_mul_f32 v36, v36, abs(v36)
  v_mfma_f32_16x16x32_bf16 v[80:83], a[128:131], a[72:75], v[80:83]
  ds_read_b64_tr_b16 a[186:187], v226 offset:52224
  v_mul_f32 v37, v37, abs(v37)
  v_mfma_f32_16x16x32_bf16 v[72:75], a[128:131], a[68:71], v[72:75]
  ds_read_b64_tr_b16 a[188:189], v227 offset:45056
  v_mul_f32 v38, v38, abs(v38)
  v_mfma_f32_16x16x32_bf16 v[64:67], a[128:131], a[64:67], v[64:67]
  ds_read_b64_tr_b16 a[190:191], v227 offset:52224
  v_mul_f32 v39, v39, abs(v39)
  v_cvt_pk_bf16_f32 v32, v32, v33
  v_mfma_f32_16x16x32_bf16 v[68:71], a[132:135], a[64:67], v[68:71]
  v_cvt_pk_bf16_f32 v33, v34, v35
  v_cvt_pk_bf16_f32 v34, v36, v37
  v_mfma_f32_16x16x32_bf16 v[76:79], a[132:135], a[68:71], v[76:79]
  v_cvt_pk_bf16_f32 v35, v38, v39
  v_pk_max_i16 v32, v32, 0
  v_mfma_f32_16x16x32_bf16 v[84:87], a[132:135], a[72:75], v[84:87]
  v_pk_max_i16 v33, v33, 0
  v_pk_max_i16 v34, v34, 0
  v_mfma_f32_16x16x32_bf16 v[92:95], a[132:135], a[76:79], v[92:95]
  v_pk_max_i16 v35, v35, 0
  buffer_store_dwordx4 v[32:35], v233, s[84:87], s18 offen offset:0 sc1
  v_mfma_f32_16x16x32_bf16 v[88:91], a[136:139], a[92:95], v[88:91]
  v_mul_f32 v40, v40, abs(v40)
  v_mul_f32 v41, v41, abs(v41)
  v_mfma_f32_16x16x32_bf16 v[80:83], a[136:139], a[88:91], v[80:83]
  v_mul_f32 v42, v42, abs(v42)
  v_mul_f32 v43, v43, abs(v43)
  v_mfma_f32_16x16x32_bf16 v[72:75], a[136:139], a[84:87], v[72:75]
  v_mul_f32 v44, v44, abs(v44)
  v_mul_f32 v45, v45, abs(v45)
  v_mul_f32 v46, v46, abs(v46)
  v_mfma_f32_16x16x32_bf16 v[64:67], a[136:139], a[80:83], v[64:67]
  v_mul_f32 v47, v47, abs(v47)
  v_cvt_pk_bf16_f32 v40, v40, v41
  v_mfma_f32_16x16x32_bf16 v[68:71], a[140:143], a[80:83], v[68:71]
  v_cvt_pk_bf16_f32 v41, v42, v43
  v_cvt_pk_bf16_f32 v42, v44, v45
  v_mfma_f32_16x16x32_bf16 v[76:79], a[140:143], a[84:87], v[76:79]
  v_cvt_pk_bf16_f32 v43, v46, v47
  v_pk_max_i16 v40, v40, 0
  v_mfma_f32_16x16x32_bf16 v[84:87], a[140:143], a[88:91], v[84:87]
  v_pk_max_i16 v41, v41, 0
  v_pk_max_i16 v42, v42, 0
  v_mfma_f32_16x16x32_bf16 v[92:95], a[140:143], a[92:95], v[92:95]
  v_pk_max_i16 v43, v43, 0
  buffer_store_dwordx4 v[40:43], v233, s[84:87], s18 offen offset:1024 sc1
  v_mfma_f32_16x16x32_bf16 v[88:91], a[144:147], a[204:207], v[88:91]
  v_mul_f32 v48, v48, abs(v48)
  v_mul_f32 v49, v49, abs(v49)
  v_mfma_f32_16x16x32_bf16 v[80:83], a[144:147], a[200:203], v[80:83]
  v_mul_f32 v50, v50, abs(v50)
  v_mul_f32 v51, v51, abs(v51)
  v_mul_f32 v52, v52, abs(v52)
  v_mfma_f32_16x16x32_bf16 v[72:75], a[144:147], a[196:199], v[72:75]
  v_mul_f32 v53, v53, abs(v53)
  v_mul_f32 v54, v54, abs(v54)
  v_mfma_f32_16x16x32_bf16 v[64:67], a[144:147], a[192:195], v[64:67]
  v_mul_f32 v55, v55, abs(v55)
  v_cvt_pk_bf16_f32 v48, v48, v49
  v_mfma_f32_16x16x32_bf16 v[68:71], a[148:151], a[192:195], v[68:71]
  v_cvt_pk_bf16_f32 v49, v50, v51
  v_cvt_pk_bf16_f32 v50, v52, v53
  v_mfma_f32_16x16x32_bf16 v[76:79], a[148:151], a[196:199], v[76:79]
  v_cvt_pk_bf16_f32 v51, v54, v55
  v_pk_max_i16 v48, v48, 0
  v_mfma_f32_16x16x32_bf16 v[84:87], a[148:151], a[200:203], v[84:87]
  v_pk_max_i16 v49, v49, 0
  v_pk_max_i16 v50, v50, 0
  v_mfma_f32_16x16x32_bf16 v[92:95], a[148:151], a[204:207], v[92:95]
  v_pk_max_i16 v51, v51, 0
  buffer_store_dwordx4 v[48:51], v233, s[84:87], s18 offen offset:2048 sc1
  v_mfma_f32_16x16x32_bf16 v[88:91], a[152:155], a[220:223], v[88:91]
  v_mul_f32 v56, v56, abs(v56)
  v_mul_f32 v57, v57, abs(v57)
  v_mul_f32 v58, v58, abs(v58)
  v_mfma_f32_16x16x32_bf16 v[80:83], a[152:155], a[216:219], v[80:83]
  v_mul_f32 v59, v59, abs(v59)
  v_mul_f32 v60, v60, abs(v60)
  v_mfma_f32_16x16x32_bf16 v[72:75], a[152:155], a[212:215], v[72:75]
  v_mul_f32 v61, v61, abs(v61)
  v_mul_f32 v62, v62, abs(v62)
  v_mfma_f32_16x16x32_bf16 v[64:67], a[152:155], a[208:211], v[64:67]
  v_mul_f32 v63, v63, abs(v63)
  v_cvt_pk_bf16_f32 v56, v56, v57
  v_mfma_f32_16x16x32_bf16 v[68:71], a[156:159], a[208:211], v[68:71]
  v_cvt_pk_bf16_f32 v57, v58, v59
  v_cvt_pk_bf16_f32 v58, v60, v61
  v_mfma_f32_16x16x32_bf16 v[76:79], a[156:159], a[212:215], v[76:79]
  v_cvt_pk_bf16_f32 v59, v62, v63
  v_pk_max_i16 v56, v56, 0
  v_mfma_f32_16x16x32_bf16 v[84:87], a[156:159], a[216:219], v[84:87]
  v_pk_max_i16 v57, v57, 0
  v_pk_max_i16 v58, v58, 0
  v_mfma_f32_16x16x32_bf16 v[92:95], a[156:159], a[220:223], v[92:95]
  v_pk_max_i16 v59, v59, 0
  buffer_store_dwordx4 v[56:59], v233, s[84:87], s18 offen offset:3072 sc1
  s_add_u32 s18, s18, 4096
  v_mfma_f32_16x16x32_bf16 v[120:123], a[24:27], a[124:127], v[120:123]
  ds_read_b64_tr_b16 a[128:129], v224 offset:4096
  ds_read_b64_tr_b16 a[130:131], v224 offset:11264
  v_mfma_f32_16x16x32_bf16 v[112:115], a[24:27], a[120:123], v[112:115]
  ds_read_b64_tr_b16 a[132:133], v225 offset:4096
  ds_read_b64_tr_b16 a[134:135], v225 offset:11264
  v_mfma_f32_16x16x32_bf16 v[104:107], a[24:27], a[116:119], v[104:107]
  ds_read_b64_tr_b16 a[136:137], v224 offset:18432
  ds_read_b64_tr_b16 a[138:139], v224 offset:25600
  v_mfma_f32_16x16x32_bf16 v[96:99], a[24:27], a[112:115], v[96:99]
  ds_read_b64_tr_b16 a[140:141], v225 offset:18432
  ds_read_b64_tr_b16 a[142:143], v225 offset:25600
  v_mfma_f32_16x16x32_bf16 v[100:103], a[28:31], a[112:115], v[100:103]
  ds_read_b64_tr_b16 a[144:145], v224 offset:32768
  v_mul_f32 v64, v64, abs(v64)
  v_mfma_f32_16x16x32_bf16 v[108:111], a[28:31], a[116:119], v[108:111]
  ds_read_b64_tr_b16 a[146:147], v224 offset:39936
  v_mul_f32 v65, v65, abs(v65)
  v_mfma_f32_16x16x32_bf16 v[116:119], a[28:31], a[120:123], v[116:119]
  ds_read_b64_tr_b16 a[148:149], v225 offset:32768
  v_mul_f32 v66, v66, abs(v66)
  v_mfma_f32_16x16x32_bf16 v[124:127], a[28:31], a[124:127], v[124:127]
  ds_read_b64_tr_b16 a[150:151], v225 offset:39936
  v_mul_f32 v67, v67, abs(v67)
  s_waitcnt lgkmcnt(12)
  v_mfma_f32_16x16x32_bf16 v[120:123], a[160:163], a[76:79], v[120:123]
  ds_read_b64_tr_b16 a[152:153], v224 offset:47104
  v_mul_f32 v68, v68, abs(v68)
  v_mfma_f32_16x16x32_bf16 v[112:115], a[160:163], a[72:75], v[112:115]
  ds_read_b64_tr_b16 a[154:155], v224 offset:54272
  v_mul_f32 v69, v69, abs(v69)
  v_mfma_f32_16x16x32_bf16 v[104:107], a[160:163], a[68:71], v[104:107]
  ds_read_b64_tr_b16 a[156:157], v225 offset:47104
  v_mul_f32 v70, v70, abs(v70)
  v_mfma_f32_16x16x32_bf16 v[96:99], a[160:163], a[64:67], v[96:99]
  ds_read_b64_tr_b16 a[158:159], v225 offset:54272
  v_mul_f32 v71, v71, abs(v71)
  v_cvt_pk_bf16_f32 v64, v64, v65
  v_mfma_f32_16x16x32_bf16 v[100:103], a[164:167], a[64:67], v[100:103]
  v_cvt_pk_bf16_f32 v65, v66, v67
  v_cvt_pk_bf16_f32 v66, v68, v69
  v_mfma_f32_16x16x32_bf16 v[108:111], a[164:167], a[68:71], v[108:111]
  v_cvt_pk_bf16_f32 v67, v70, v71
  v_pk_max_i16 v64, v64, 0
  v_mfma_f32_16x16x32_bf16 v[116:119], a[164:167], a[72:75], v[116:119]
  v_pk_max_i16 v65, v65, 0
  v_pk_max_i16 v66, v66, 0
  v_mfma_f32_16x16x32_bf16 v[124:127], a[164:167], a[76:79], v[124:127]
  v_pk_max_i16 v67, v67, 0
  buffer_store_dwordx4 v[64:67], v233, s[84:87], s18 offen offset:0 sc1
  v_mfma_f32_16x16x32_bf16 v[120:123], a[168:171], a[92:95], v[120:123]
  v_mul_f32 v72, v72, abs(v72)
  v_mul_f32 v73, v73, abs(v73)
  v_mfma_f32_16x16x32_bf16 v[112:115], a[168:171], a[88:91], v[112:115]
  v_mul_f32 v74, v74, abs(v74)
  v_mul_f32 v75, v75, abs(v75)
  v_mfma_f32_16x16x32_bf16 v[104:107], a[168:171], a[84:87], v[104:107]
  v_mul_f32 v76, v76, abs(v76)
  v_mul_f32 v77, v77, abs(v77)
  v_mul_f32 v78, v78, abs(v78)
  v_mfma_f32_16x16x32_bf16 v[96:99], a[168:171], a[80:83], v[96:99]
  v_mul_f32 v79, v79, abs(v79)
  v_cvt_pk_bf16_f32 v72, v72, v73
  v_mfma_f32_16x16x32_bf16 v[100:103], a[172:175], a[80:83], v[100:103]
  v_cvt_pk_bf16_f32 v73, v74, v75
  v_cvt_pk_bf16_f32 v74, v76, v77
  v_mfma_f32_16x16x32_bf16 v[108:111], a[172:175], a[84:87], v[108:111]
  v_cvt_pk_bf16_f32 v75, v78, v79
  v_pk_max_i16 v72, v72, 0
  v_mfma_f32_16x16x32_bf16 v[116:119], a[172:175], a[88:91], v[116:119]
  v_pk_max_i16 v73, v73, 0
  v_pk_max_i16 v74, v74, 0
  v_mfma_f32_16x16x32_bf16 v[124:127], a[172:175], a[92:95], v[124:127]
  v_pk_max_i16 v75, v75, 0
  buffer_store_dwordx4 v[72:75], v233, s[84:87], s18 offen offset:1024 sc1
  v_mfma_f32_16x16x32_bf16 v[120:123], a[176:179], a[204:207], v[120:123]
  v_mul_f32 v80, v80, abs(v80)
  v_mul_f32 v81, v81, abs(v81)
  v_mfma_f32_16x16x32_bf16 v[112:115], a[176:179], a[200:203], v[112:115]
  v_mul_f32 v82, v82, abs(v82)
  v_mul_f32 v83, v83, abs(v83)
  v_mul_f32 v84, v84, abs(v84)
  v_mfma_f32_16x16x32_bf16 v[104:107], a[176:179], a[196:199], v[104:107]
  v_mul_f32 v85, v85, abs(v85)
  v_mul_f32 v86, v86, abs(v86)
  v_mfma_f32_16x16x32_bf16 v[96:99], a[176:179], a[192:195], v[96:99]
  v_mul_f32 v87, v87, abs(v87)
  v_cvt_pk_bf16_f32 v80, v80, v81
  v_mfma_f32_16x16x32_bf16 v[100:103], a[180:183], a[192:195], v[100:103]
  v_cvt_pk_bf16_f32 v81, v82, v83
  v_cvt_pk_bf16_f32 v82, v84, v85
  v_mfma_f32_16x16x32_bf16 v[108:111], a[180:183], a[196:199], v[108:111]
  v_cvt_pk_bf16_f32 v83, v86, v87
  v_pk_max_i16 v80, v80, 0
  v_mfma_f32_16x16x32_bf16 v[116:119], a[180:183], a[200:203], v[116:119]
  v_pk_max_i16 v81, v81, 0
  v_pk_max_i16 v82, v82, 0
  v_mfma_f32_16x16x32_bf16 v[124:127], a[180:183], a[204:207], v[124:127]
  v_pk_max_i16 v83, v83, 0
  buffer_store_dwordx4 v[80:83], v233, s[84:87], s18 offen offset:2048 sc1
  v_mfma_f32_16x16x32_bf16 v[120:123], a[184:187], a[220:223], v[120:123]
  v_mul_f32 v88, v88, abs(v88)
  v_mul_f32 v89, v89, abs(v89)
  v_mul_f32 v90, v90, abs(v90)
  v_mfma_f32_16x16x32_bf16 v[112:115], a[184:187], a[216:219], v[112:115]
  v_mul_f32 v91, v91, abs(v91)
  v_mul_f32 v92, v92, abs(v92)
  v_mfma_f32_16x16x32_bf16 v[104:107], a[184:187], a[212:215], v[104:107]
  v_mul_f32 v93, v93, abs(v93)
  v_mul_f32 v94, v94, abs(v94)
  v_mfma_f32_16x16x32_bf16 v[96:99], a[184:187], a[208:211], v[96:99]
  v_mul_f32 v95, v95, abs(v95)
  v_cvt_pk_bf16_f32 v88, v88, v89
  v_mfma_f32_16x16x32_bf16 v[100:103], a[188:191], a[208:211], v[100:103]
  v_cvt_pk_bf16_f32 v89, v90, v91
  v_cvt_pk_bf16_f32 v90, v92, v93
  v_mfma_f32_16x16x32_bf16 v[108:111], a[188:191], a[212:215], v[108:111]
  v_cvt_pk_bf16_f32 v91, v94, v95
  v_pk_max_i16 v88, v88, 0
  v_mfma_f32_16x16x32_bf16 v[116:119], a[188:191], a[216:219], v[116:119]
  v_pk_max_i16 v89, v89, 0
  v_pk_max_i16 v90, v90, 0
  v_mfma_f32_16x16x32_bf16 v[124:127], a[188:191], a[220:223], v[124:127]
  v_pk_max_i16 v91, v91, 0
  buffer_store_dwordx4 v[88:91], v233, s[84:87], s18 offen offset:3072 sc1
  s_add_u32 s18, s18, 4096
  v_mfma_f32_16x16x32_bf16 v[152:155], a[32:35], a[124:127], v[152:155]
  ds_read_b64_tr_b16 a[160:161], v226 offset:4096
  ds_read_b64_tr_b16 a[162:163], v226 offset:11264
  v_mfma_f32_16x16x32_bf16 v[144:147], a[32:35], a[120:123], v[144:147]
  ds_read_b64_tr_b16 a[164:165], v227 offset:4096
  ds_read_b64_tr_b16 a[166:167], v227 offset:11264
  v_mfma_f32_16x16x32_bf16 v[136:139], a[32:35], a[116:119], v[136:139]
  ds_read_b64_tr_b16 a[168:169], v226 offset:18432
  ds_read_b64_tr_b16 a[170:171], v226 offset:25600
  v_mfma_f32_16x16x32_bf16 v[128:131], a[32:35], a[112:115], v[128:131]
  ds_read_b64_tr_b16 a[172:173], v227 offset:18432
  ds_read_b64_tr_b16 a[174:175], v227 offset:25600
  v_mfma_f32_16x16x32_bf16 v[132:135], a[36:39], a[112:115], v[132:135]
  ds_read_b64_tr_b16 a[176:177], v226 offset:32768
  v_mul_f32 v96, v96, abs(v96)
  v_mfma_f32_16x16x32_bf16 v[140:143], a[36:39], a[116:119], v[140:143]
  ds_read_b64_tr_b16 a[178:179], v226 offset:39936
  v_mul_f32 v97, v97, abs(v97)
  v_mfma_f32_16x16x32_bf16 v[148:151], a[36:39], a[120:123], v[148:151]
  ds_read_b64_tr_b16 a[180:181], v227 offset:32768
  v_mul_f32 v98, v98, abs(v98)
  v_mfma_f32_16x16x32_bf16 v[156:159], a[36:39], a[124:127], v[156:159]
  ds_read_b64_tr_b16 a[182:183], v227 offset:39936
  v_mul_f32 v99, v99, abs(v99)
  s_waitcnt lgkmcnt(12)
  v_mfma_f32_16x16x32_bf16 v[152:155], a[128:131], a[76:79], v[152:155]
  ds_read_b64_tr_b16 a[184:185], v226 offset:47104
  v_mul_f32 v100, v100, abs(v100)
  v_mfma_f32_16x16x32_bf16 v[144:147], a[128:131], a[72:75], v[144:147]
  ds_read_b64_tr_b16 a[186:187], v226 offset:54272
  v_mul_f32 v101, v101, abs(v101)
  v_mfma_f32_16x16x32_bf16 v[136:139], a[128:131], a[68:71], v[136:139]
  ds_read_b64_tr_b16 a[188:189], v227 offset:47104
  v_mul_f32 v102, v102, abs(v102)
  v_mfma_f32_16x16x32_bf16 v[128:131], a[128:131], a[64:67], v[128:131]
  ds_read_b64_tr_b16 a[190:191], v227 offset:54272
  v_mul_f32 v103, v103, abs(v103)
  v_mfma_f32_16x16x32_bf16 v[132:135], a[132:135], a[64:67], v[132:135]
  v_cvt_pk_bf16_f32 v96, v96, v97
  v_cvt_pk_bf16_f32 v97, v98, v99
  v_cvt_pk_bf16_f32 v98, v100, v101
  v_mfma_f32_16x16x32_bf16 v[140:143], a[132:135], a[68:71], v[140:143]
  v_cvt_pk_bf16_f32 v99, v102, v103
  v_pk_max_i16 v96, v96, 0
  v_mfma_f32_16x16x32_bf16 v[148:151], a[132:135], a[72:75], v[148:151]
  v_pk_max_i16 v97, v97, 0
  v_pk_max_i16 v98, v98, 0
  v_mfma_f32_16x16x32_bf16 v[156:159], a[132:135], a[76:79], v[156:159]
  v_pk_max_i16 v99, v99, 0
  buffer_store_dwordx4 v[96:99], v233, s[84:87], s18 offen offset:0 sc1
  v_mfma_f32_16x16x32_bf16 v[152:155], a[136:139], a[92:95], v[152:155]
  v_mul_f32 v104, v104, abs(v104)
  v_mul_f32 v105, v105, abs(v105)
  v_mfma_f32_16x16x32_bf16 v[144:147], a[136:139], a[88:91], v[144:147]
  v_mul_f32 v106, v106, abs(v106)
  v_mul_f32 v107, v107, abs(v107)
  v_mfma_f32_16x16x32_bf16 v[136:139], a[136:139], a[84:87], v[136:139]
  v_mul_f32 v108, v108, abs(v108)
  v_mul_f32 v109, v109, abs(v109)
  v_mfma_f32_16x16x32_bf16 v[128:131], a[136:139], a[80:83], v[128:131]
  v_mul_f32 v110, v110, abs(v110)
  v_mul_f32 v111, v111, abs(v111)
  v_mfma_f32_16x16x32_bf16 v[132:135], a[140:143], a[80:83], v[132:135]
  v_cvt_pk_bf16_f32 v104, v104, v105
  v_cvt_pk_bf16_f32 v105, v106, v107
  v_mfma_f32_16x16x32_bf16 v[140:143], a[140:143], a[84:87], v[140:143]
  v_cvt_pk_bf16_f32 v106, v108, v109
  v_cvt_pk_bf16_f32 v107, v110, v111
  v_pk_max_i16 v104, v104, 0
  v_mfma_f32_16x16x32_bf16 v[148:151], a[140:143], a[88:91], v[148:151]
  v_pk_max_i16 v105, v105, 0
  v_pk_max_i16 v106, v106, 0
  v_mfma_f32_16x16x32_bf16 v[156:159], a[140:143], a[92:95], v[156:159]
  v_pk_max_i16 v107, v107, 0
  buffer_store_dwordx4 v[104:107], v233, s[84:87], s18 offen offset:1024 sc1
  v_mfma_f32_16x16x32_bf16 v[152:155], a[144:147], a[204:207], v[152:155]
  v_mul_f32 v112, v112, abs(v112)
  v_mul_f32 v113, v113, abs(v113)
  v_mfma_f32_16x16x32_bf16 v[144:147], a[144:147], a[200:203], v[144:147]
  v_mul_f32 v114, v114, abs(v114)
  v_mul_f32 v115, v115, abs(v115)
  v_mfma_f32_16x16x32_bf16 v[136:139], a[144:147], a[196:199], v[136:139]
  v_mul_f32 v116, v116, abs(v116)
  v_mul_f32 v117, v117, abs(v117)
  v_mfma_f32_16x16x32_bf16 v[128:131], a[144:147], a[192:195], v[128:131]
  v_mul_f32 v118, v118, abs(v118)
  v_mul_f32 v119, v119, abs(v119)
  v_mfma_f32_16x16x32_bf16 v[132:135], a[148:151], a[192:195], v[132:135]
  v_cvt_pk_bf16_f32 v112, v112, v113
  v_cvt_pk_bf16_f32 v113, v114, v115
  v_mfma_f32_16x16x32_bf16 v[140:143], a[148:151], a[196:199], v[140:143]
  v_cvt_pk_bf16_f32 v114, v116, v117
  v_cvt_pk_bf16_f32 v115, v118, v119
  v_mfma_f32_16x16x32_bf16 v[148:151], a[148:151], a[200:203], v[148:151]
  v_pk_max_i16 v112, v112, 0
  v_pk_max_i16 v113, v113, 0
  v_pk_max_i16 v114, v114, 0
  v_mfma_f32_16x16x32_bf16 v[156:159], a[148:151], a[204:207], v[156:159]
  v_pk_max_i16 v115, v115, 0
  buffer_store_dwordx4 v[112:115], v233, s[84:87], s18 offen offset:2048 sc1
  v_mfma_f32_16x16x32_bf16 v[152:155], a[152:155], a[220:223], v[152:155]
  v_mul_f32 v120, v120, abs(v120)
  v_mul_f32 v121, v121, abs(v121)
  v_mfma_f32_16x16x32_bf16 v[144:147], a[152:155], a[216:219], v[144:147]
  v_mul_f32 v122, v122, abs(v122)
  v_mul_f32 v123, v123, abs(v123)
  v_mfma_f32_16x16x32_bf16 v[136:139], a[152:155], a[212:215], v[136:139]
  v_mul_f32 v124, v124, abs(v124)
  v_mul_f32 v125, v125, abs(v125)
  v_mfma_f32_16x16x32_bf16 v[128:131], a[152:155], a[208:211], v[128:131]
  v_mul_f32 v126, v126, abs(v126)
  v_mul_f32 v127, v127, abs(v127)
  v_mfma_f32_16x16x32_bf16 v[132:135], a[156:159], a[208:211], v[132:135]
  v_cvt_pk_bf16_f32 v120, v120, v121
  v_cvt_pk_bf16_f32 v121, v122, v123
  v_mfma_f32_16x16x32_bf16 v[140:143], a[156:159], a[212:215], v[140:143]
  v_cvt_pk_bf16_f32 v122, v124, v125
  v_cvt_pk_bf16_f32 v123, v126, v127
  v_mfma_f32_16x16x32_bf16 v[148:151], a[156:159], a[216:219], v[148:151]
  v_pk_max_i16 v120, v120, 0
  v_pk_max_i16 v121, v121, 0
  v_mfma_f32_16x16x32_bf16 v[156:159], a[156:159], a[220:223], v[156:159]
  v_pk_max_i16 v122, v122, 0
  v_pk_max_i16 v123, v123, 0
  buffer_store_dwordx4 v[120:123], v233, s[84:87], s18 offen offset:3072 sc1
  v_mfma_f32_16x16x32_bf16 v[184:187], a[40:43], a[124:127], v[184:187]
  ds_read_b64_tr_b16 a[128:129], v228 offset:0
  ds_read_b64_tr_b16 a[130:131], v228 offset:7168
  v_mfma_f32_16x16x32_bf16 v[176:179], a[40:43], a[120:123], v[176:179]
  ds_read_b64_tr_b16 a[132:133], v229 offset:0
  ds_read_b64_tr_b16 a[134:135], v229 offset:7168
  v_mfma_f32_16x16x32_bf16 v[168:171], a[40:43], a[116:119], v[168:171]
  ds_read_b64_tr_b16 a[136:137], v228 offset:14336
  ds_read_b64_tr_b16 a[138:139], v228 offset:21504
  v_mfma_f32_16x16x32_bf16 v[160:163], a[40:43], a[112:115], v[160:163]
  ds_read_b64_tr_b16 a[140:141], v229 offset:14336
  ds_read_b64_tr_b16 a[142:143], v229 offset:21504
  v_mfma_f32_16x16x32_bf16 v[164:167], a[44:47], a[112:115], v[164:167]
  ds_read_b64_tr_b16 a[144:145], v228 offset:28672
  v_mul_f32 v128, v128, abs(v128)
  v_mfma_f32_16x16x32_bf16 v[172:175], a[44:47], a[116:119], v[172:175]
  ds_read_b64_tr_b16 a[146:147], v228 offset:35840
  v_mul_f32 v129, v129, abs(v129)
  v_mfma_f32_16x16x32_bf16 v[180:183], a[44:47], a[120:123], v[180:183]
  ds_read_b64_tr_b16 a[148:149], v229 offset:28672
  v_mul_f32 v130, v130, abs(v130)
  v_mfma_f32_16x16x32_bf16 v[188:191], a[44:47], a[124:127], v[188:191]
  ds_read_b64_tr_b16 a[150:151], v229 offset:35840
  v_mul_f32 v131, v131, abs(v131)
  s_waitcnt lgkmcnt(12)
  v_mfma_f32_16x16x32_bf16 v[184:187], a[160:163], a[76:79], v[184:187]
  ds_read_b64_tr_b16 a[152:153], v228 offset:43008
  v_mul_f32 v132, v132, abs(v132)
  v_mfma_f32_16x16x32_bf16 v[176:179], a[160:163], a[72:75], v[176:179]
  ds_read_b64_tr_b16 a[154:155], v228 offset:50176
  v_mul_f32 v133, v133, abs(v133)
  v_mfma_f32_16x16x32_bf16 v[168:171], a[160:163], a[68:71], v[168:171]
  ds_read_b64_tr_b16 a[156:157], v229 offset:43008
  v_mul_f32 v134, v134, abs(v134)
  v_mfma_f32_16x16x32_bf16 v[160:163], a[160:163], a[64:67], v[160:163]
  ds_read_b64_tr_b16 a[158:159], v229 offset:50176
  v_mul_f32 v135, v135, abs(v135)
  v_mfma_f32_16x16x32_bf16 v[164:167], a[164:167], a[64:67], v[164:167]
  v_cvt_pk_bf16_f32 v128, v128, v129
  v_cvt_pk_bf16_f32 v129, v130, v131
  v_cvt_pk_bf16_f32 v130, v132, v133
  v_mfma_f32_16x16x32_bf16 v[172:175], a[164:167], a[68:71], v[172:175]
  v_cvt_pk_bf16_f32 v131, v134, v135
  v_pk_max_i16 v128, v128, 0
  v_mfma_f32_16x16x32_bf16 v[180:183], a[164:167], a[72:75], v[180:183]
  v_pk_max_i16 v129, v129, 0
  v_pk_max_i16 v130, v130, 0
  v_mfma_f32_16x16x32_bf16 v[188:191], a[164:167], a[76:79], v[188:191]
  v_pk_max_i16 v131, v131, 0
  buffer_store_dwordx4 v[128:131], v233, s[84:87], s32 offen offset:0 sc1
  v_mfma_f32_16x16x32_bf16 v[184:187], a[168:171], a[92:95], v[184:187]
  v_mul_f32 v136, v136, abs(v136)
  v_mul_f32 v137, v137, abs(v137)
  v_mfma_f32_16x16x32_bf16 v[176:179], a[168:171], a[88:91], v[176:179]
  v_mul_f32 v138, v138, abs(v138)
  v_mul_f32 v139, v139, abs(v139)
  v_mfma_f32_16x16x32_bf16 v[168:171], a[168:171], a[84:87], v[168:171]
  v_mul_f32 v140, v140, abs(v140)
  v_mul_f32 v141, v141, abs(v141)
  v_mfma_f32_16x16x32_bf16 v[160:163], a[168:171], a[80:83], v[160:163]
  v_mul_f32 v142, v142, abs(v142)
  v_mul_f32 v143, v143, abs(v143)
  v_mfma_f32_16x16x32_bf16 v[164:167], a[172:175], a[80:83], v[164:167]
  v_cvt_pk_bf16_f32 v136, v136, v137
  v_cvt_pk_bf16_f32 v137, v138, v139
  v_mfma_f32_16x16x32_bf16 v[172:175], a[172:175], a[84:87], v[172:175]
  v_cvt_pk_bf16_f32 v138, v140, v141
  v_cvt_pk_bf16_f32 v139, v142, v143
  v_pk_max_i16 v136, v136, 0
  v_mfma_f32_16x16x32_bf16 v[180:183], a[172:175], a[88:91], v[180:183]
  v_pk_max_i16 v137, v137, 0
  v_pk_max_i16 v138, v138, 0
  v_mfma_f32_16x16x32_bf16 v[188:191], a[172:175], a[92:95], v[188:191]
  v_pk_max_i16 v139, v139, 0
  buffer_store_dwordx4 v[136:139], v233, s[84:87], s32 offen offset:1024 sc1
  v_mfma_f32_16x16x32_bf16 v[184:187], a[176:179], a[204:207], v[184:187]
  v_mul_f32 v144, v144, abs(v144)
  v_mul_f32 v145, v145, abs(v145)
  v_mfma_f32_16x16x32_bf16 v[176:179], a[176:179], a[200:203], v[176:179]
  v_mul_f32 v146, v146, abs(v146)
  v_mul_f32 v147, v147, abs(v147)
  v_mfma_f32_16x16x32_bf16 v[168:171], a[176:179], a[196:199], v[168:171]
  v_mul_f32 v148, v148, abs(v148)
  v_mul_f32 v149, v149, abs(v149)
  v_mfma_f32_16x16x32_bf16 v[160:163], a[176:179], a[192:195], v[160:163]
  v_mul_f32 v150, v150, abs(v150)
  v_mul_f32 v151, v151, abs(v151)
  v_mfma_f32_16x16x32_bf16 v[164:167], a[180:183], a[192:195], v[164:167]
  v_cvt_pk_bf16_f32 v144, v144, v145
  v_cvt_pk_bf16_f32 v145, v146, v147
  v_mfma_f32_16x16x32_bf16 v[172:175], a[180:183], a[196:199], v[172:175]
  v_cvt_pk_bf16_f32 v146, v148, v149
  v_cvt_pk_bf16_f32 v147, v150, v151
  v_mfma_f32_16x16x32_bf16 v[180:183], a[180:183], a[200:203], v[180:183]
  v_pk_max_i16 v144, v144, 0
  v_pk_max_i16 v145, v145, 0
  v_pk_max_i16 v146, v146, 0
  v_mfma_f32_16x16x32_bf16 v[188:191], a[180:183], a[204:207], v[188:191]
  v_pk_max_i16 v147, v147, 0
  buffer_store_dwordx4 v[144:147], v233, s[84:87], s32 offen offset:2048 sc1
  v_mfma_f32_16x16x32_bf16 v[184:187], a[184:187], a[220:223], v[184:187]
  v_mul_f32 v152, v152, abs(v152)
  v_mul_f32 v153, v153, abs(v153)
  v_mfma_f32_16x16x32_bf16 v[176:179], a[184:187], a[216:219], v[176:179]
  v_mul_f32 v154, v154, abs(v154)
  v_mul_f32 v155, v155, abs(v155)
  v_mfma_f32_16x16x32_bf16 v[168:171], a[184:187], a[212:215], v[168:171]
  v_mul_f32 v156, v156, abs(v156)
  v_mul_f32 v157, v157, abs(v157)
  v_mfma_f32_16x16x32_bf16 v[160:163], a[184:187], a[208:211], v[160:163]
  v_mul_f32 v158, v158, abs(v158)
  v_mul_f32 v159, v159, abs(v159)
  v_mfma_f32_16x16x32_bf16 v[164:167], a[188:191], a[208:211], v[164:167]
  v_cvt_pk_bf16_f32 v152, v152, v153
  v_cvt_pk_bf16_f32 v153, v154, v155
  v_mfma_f32_16x16x32_bf16 v[172:175], a[188:191], a[212:215], v[172:175]
  v_cvt_pk_bf16_f32 v154, v156, v157
  v_cvt_pk_bf16_f32 v155, v158, v159
  v_mfma_f32_16x16x32_bf16 v[180:183], a[188:191], a[216:219], v[180:183]
  v_pk_max_i16 v152, v152, 0
  v_pk_max_i16 v153, v153, 0
  v_mfma_f32_16x16x32_bf16 v[188:191], a[188:191], a[220:223], v[188:191]
  v_pk_max_i16 v154, v154, 0
  v_pk_max_i16 v155, v155, 0
  buffer_store_dwordx4 v[152:155], v233, s[84:87], s32 offen offset:3072 sc1
  s_waitcnt vmcnt(4)
  s_barrier
  s_cmp_lg_u32 s40, 0
  s_cbranch_scc1 G1w1_noha
  v_mov_b32 v234, s3
  s_mov_b64 exec, 1
  buffer_store_dword v234, v245, s[84:87], s83 offen sc1
  s_mov_b64 exec, -1
G1w1_noha:
  v_mfma_f32_16x16x32_bf16 v[216:219], a[48:51], a[124:127], v[216:219]
  s_nop 0
  v_mfma_f32_16x16x32_bf16 v[208:211], a[48:51], a[120:123], v[208:211]
  s_nop 0
  v_mfma_f32_16x16x32_bf16 v[200:203], a[48:51], a[116:119], v[200:203]
  s_nop 0
  v_mfma_f32_16x16x32_bf16 v[192:195], a[48:51], a[112:115], v[192:195]
  s_nop 0
  v_mfma_f32_16x16x32_bf16 v[196:199], a[52:55], a[112:115], v[196:199]
  v_mul_f32 v160, v160, abs(v160)
  v_mfma_f32_16x16x32_bf16 v[204:207], a[52:55], a[116:119], v[204:207]
  v_mul_f32 v161, v161, abs(v161)
  v_mul_f32 v162, v162, abs(v162)
  v_mfma_f32_16x16x32_bf16 v[212:215], a[52:55], a[120:123], v[212:215]
  v_mul_f32 v163, v163, abs(v163)
  v_mul_f32 v164, v164, abs(v164)
  v_mfma_f32_16x16x32_bf16 v[220:223], a[52:55], a[124:127], v[220:223]
  v_mul_f32 v165, v165, abs(v165)
  v_mul_f32 v166, v166, abs(v166)
  s_waitcnt lgkmcnt(0)
  v_mfma_f32_16x16x32_bf16 v[216:219], a[128:131], a[76:79], v[216:219]
  v_mul_f32 v167, v167, abs(v167)
  v_cvt_pk_bf16_f32 v160, v160, v161
  v_mfma_f32_16x16x32_bf16 v[208:211], a[128:131], a[72:75], v[208:211]
  v_cvt_pk_bf16_f32 v161, v162, v163
  v_cvt_pk_bf16_f32 v162, v164, v165
  v_mfma_f32_16x16x32_bf16 v[200:203], a[128:131], a[68:71], v[200:203]
  v_cvt_pk_bf16_f32 v163, v166, v167
  v_pk_max_i16 v160, v160, 0
  v_mfma_f32_16x16x32_bf16 v[192:195], a[128:131], a[64:67], v[192:195]
  v_pk_max_i16 v161, v161, 0
  v_pk_max_i16 v162, v162, 0
  v_mfma_f32_16x16x32_bf16 v[196:199], a[132:135], a[64:67], v[196:199]
  v_pk_max_i16 v163, v163, 0
  buffer_store_dwordx4 v[160:163], v233, s[84:87], s33 offen offset:0 sc1
  v_mfma_f32_16x16x32_bf16 v[204:207], a[132:135], a[68:71], v[204:207]
  v_mul_f32 v168, v168, abs(v168)
  v_mfma_f32_16x16x32_bf16 v[212:215], a[132:135], a[72:75], v[212:215]
  v_mul_f32 v169, v169, abs(v169)
  v_mul_f32 v170, v170, abs(v170)
  v_mfma_f32_16x16x32_bf16 v[220:223], a[132:135], a[76:79], v[220:223]
  v_mul_f32 v171, v171, abs(v171)
  v_mul_f32 v172, v172, abs(v172)
  v_mfma_f32_16x16x32_bf16 v[216:219], a[136:139], a[92:95], v[216:219]
  v_mul_f32 v173, v173, abs(v173)
  v_mul_f32 v174, v174, abs(v174)
  v_mfma_f32_16x16x32_bf16 v[208:211], a[136:139], a[88:91], v[208:211]
  v_mul_f32 v175, v175, abs(v175)
  v_cvt_pk_bf16_f32 v168, v168, v169
  v_mfma_f32_16x16x32_bf16 v[200:203], a[136:139], a[84:87], v[200:203]
  v_cvt_pk_bf16_f32 v169, v170, v171
  v_cvt_pk_bf16_f32 v170, v172, v173
  v_mfma_f32_16x16x32_bf16 v[192:195], a[136:139], a[80:83], v[192:195]
  v_cvt_pk_bf16_f32 v171, v174, v175
  v_pk_max_i16 v168, v168, 0
  v_mfma_f32_16x16x32_bf16 v[196:199], a[140:143], a[80:83], v[196:199]
  v_pk_max_i16 v169, v169, 0
  v_pk_max_i16 v170, v170, 0
  v_mfma_f32_16x16x32_bf16 v[204:207], a[140:143], a[84:87], v[204:207]
  v_pk_max_i16 v171, v171, 0
  buffer_store_dwordx4 v[168:171], v233, s[84:87], s33 offen offset:1024 sc1
  v_mfma_f32_16x16x32_bf16 v[212:215], a[140:143], a[88:91], v[212:215]
  v_mul_f32 v176, v176, abs(v176)
  v_mfma_f32_16x16x32_bf16 v[220:223], a[140:143], a[92:95], v[220:223]
  v_mul_f32 v177, v177, abs(v177)
  v_mul_f32 v178, v178, abs(v178)
  v_mfma_f32_16x16x32_bf16 v[216:219], a[144:147], a[204:207], v[216:219]
  v_mul_f32 v179, v179, abs(v179)
  v_mul_f32 v180, v180, abs(v180)
  v_mfma_f32_16x16x32_bf16 v[208:211], a[144:147], a[200:203], v[208:211]
  v_mul_f32 v181, v181, abs(v181)
  v_mul_f32 v182, v182, abs(v182)
  v_mfma_f32_16x16x32_bf16 v[200:203], a[144:147], a[196:199], v[200:203]
  v_mul_f32 v183, v183, abs(v183)
  v_cvt_pk_bf16_f32 v176, v176, v177
  v_mfma_f32_16x16x32_bf16 v[192:195], a[144:147], a[192:195], v[192:195]
  v_cvt_pk_bf16_f32 v177, v178, v179
  v_cvt_pk_bf16_f32 v178, v180, v181
  v_mfma_f32_16x16x32_bf16 v[196:199], a[148:151], a[192:195], v[196:199]
  v_cvt_pk_bf16_f32 v179, v182, v183
  v_pk_max_i16 v176, v176, 0
  v_mfma_f32_16x16x32_bf16 v[204:207], a[148:151], a[196:199], v[204:207]
  v_pk_max_i16 v177, v177, 0
  v_pk_max_i16 v178, v178, 0
  v_mfma_f32_16x16x32_bf16 v[212:215], a[148:151], a[200:203], v[212:215]
  v_pk_max_i16 v179, v179, 0
  buffer_store_dwordx4 v[176:179], v233, s[84:87], s33 offen offset:2048 sc1
  v_mfma_f32_16x16x32_bf16 v[220:223], a[148:151], a[204:207], v[220:223]
  v_mul_f32 v184, v184, abs(v184)
  v_mfma_f32_16x16x32_bf16 v[216:219], a[152:155], a[220:223], v[216:219]
  v_mul_f32 v185, v185, abs(v185)
  v_mul_f32 v186, v186, abs(v186)
  v_mfma_f32_16x16x32_bf16 v[208:211], a[152:155], a[216:219], v[208:211]
  v_mul_f32 v187, v187, abs(v187)
  v_mul_f32 v188, v188, abs(v188)
  v_mfma_f32_16x16x32_bf16 v[200:203], a[152:155], a[212:215], v[200:203]
  v_mul_f32 v189, v189, abs(v189)
  v_mul_f32 v190, v190, abs(v190)
  v_mfma_f32_16x16x32_bf16 v[192:195], a[152:155], a[208:211], v[192:195]
  v_mul_f32 v191, v191, abs(v191)
  v_cvt_pk_bf16_f32 v184, v184, v185
  v_mfma_f32_16x16x32_bf16 v[196:199], a[156:159], a[208:211], v[196:199]
  v_cvt_pk_bf16_f32 v185, v186, v187
  v_cvt_pk_bf16_f32 v186, v188, v189
  v_mfma_f32_16x16x32_bf16 v[204:207], a[156:159], a[212:215], v[204:207]
  v_cvt_pk_bf16_f32 v187, v190, v191
  v_pk_max_i16 v184, v184, 0
  v_mfma_f32_16x16x32_bf16 v[212:215], a[156:159], a[216:219], v[212:215]
  v_pk_max_i16 v185, v185, 0
  v_pk_max_i16 v186, v186, 0
  v_mfma_f32_16x16x32_bf16 v[220:223], a[156:159], a[220:223], v[220:223]
  v_pk_max_i16 v187, v187, 0
  buffer_store_dwordx4 v[184:187], v233, s[84:87], s33 offen offset:3072 sc1
  s_mov_b32 s90, s32
  s_mov_b32 s91, s33
  s_mov_b32 s92, s34
  s_load_dwordx2 s[4:5], s[0:1], 48
  s_load_dwordx2 s[6:7], s[0:1], 16
  s_load_dwordx2 s[16:17], s[0:1], 64
  s_barrier
  v_mul_f32 v192, v192, abs(v192)
  v_mul_f32 v193, v193, abs(v193)
  v_mul_f32 v194, v194, abs(v194)
  v_mul_f32 v195, v195, abs(v195)
  v_mul_f32 v196, v196, abs(v196)
  v_mul_f32 v197, v197, abs(v197)
  v_mul_f32 v198, v198, abs(v198)
  v_mul_f32 v199, v199, abs(v199)
  v_cvt_pk_bf16_f32 v192, v192, v193
  v_cvt_pk_bf16_f32 v193, v194, v195
  v_cvt_pk_bf16_f32 v194, v196, v197
  v_cvt_pk_bf16_f32 v195, v198, v199
  v_pk_max_i16 v192, v192, 0
  v_pk_max_i16 v193, v193, 0
  v_pk_max_i16 v194, v194, 0
  v_pk_max_i16 v195, v195, 0
  buffer_store_dwordx4 v[192:195], v233, s[84:87], s34 offen offset:0 sc1
  v_mul_f32 v200, v200, abs(v200)
  v_mul_f32 v201, v201, abs(v201)
  v_mul_f32 v202, v202, abs(v202)
  v_mul_f32 v203, v203, abs(v203)
  v_mul_f32 v204, v204, abs(v204)
  v_mul_f32 v205, v205, abs(v205)
  v_mul_f32 v206, v206, abs(v206)
  v_mul_f32 v207, v207, abs(v207)
  v_cvt_pk_bf16_f32 v200, v200, v201
  v_cvt_pk_bf16_f32 v201, v202, v203
  v_cvt_pk_bf16_f32 v202, v204, v205
  v_cvt_pk_bf16_f32 v203, v206, v207
  v_pk_max_i16 v200, v200, 0
  v_pk_max_i16 v201, v201, 0
  v_pk_max_i16 v202, v202, 0
  v_pk_max_i16 v203, v203, 0
  buffer_store_dwordx4 v[200:203], v233, s[84:87], s34 offen offset:1024 sc1
  v_mul_f32 v208, v208, abs(v208)
  v_mul_f32 v209, v209, abs(v209)
  v_mul_f32 v210, v210, abs(v210)
  v_mul_f32 v211, v211, abs(v211)
  v_mul_f32 v212, v212, abs(v212)
  v_mul_f32 v213, v213, abs(v213)
  v_mul_f32 v214, v214, abs(v214)
  v_mul_f32 v215, v215, abs(v215)
  v_cvt_pk_bf16_f32 v208, v208, v209
  v_cvt_pk_bf16_f32 v209, v210, v211
  v_cvt_pk_bf16_f32 v210, v212, v213
  v_cvt_pk_bf16_f32 v211, v214, v215
  v_pk_max_i16 v208, v208, 0
  v_pk_max_i16 v209, v209, 0
  v_pk_max_i16 v210, v210, 0
  v_pk_max_i16 v211, v211, 0
  buffer_store_dwordx4 v[208:211], v233, s[84:87], s34 offen offset:2048 sc1
  v_mul_f32 v216, v216, abs(v216)
  v_mul_f32 v217, v217, abs(v217)
  v_mul_f32 v218, v218, abs(v218)
  v_mul_f32 v219, v219, abs(v219)
  v_mul_f32 v220, v220, abs(v220)
  v_mul_f32 v221, v221, abs(v221)
  v_mul_f32 v222, v222, abs(v222)
  v_mul_f32 v223, v223, abs(v223)
  v_cvt_pk_bf16_f32 v216, v216, v217
  v_cvt_pk_bf16_f32 v217, v218, v219
  v_cvt_pk_bf16_f32 v218, v220, v221
  v_cvt_pk_bf16_f32 v219, v222, v223
  v_pk_max_i16 v216, v216, 0
  v_pk_max_i16 v217, v217, 0
  v_pk_max_i16 v218, v218, 0
  v_pk_max_i16 v219, v219, 0
  buffer_store_dwordx4 v[216:219], v233, s[84:87], s34 offen offset:3072 sc1
  buffer_load_dword v247, v245, s[84:87], s99 offen sc1
  s_branch MG_w1
G1w1_tail_end:
G1w1_xspin:
  s_mov_b32 s98, 0
G1w1_xspin_l:
  s_sleep 2
  buffer_load_dword v2, v0, s[84:87], s36 offen sc1
  s_add_u32 s98, s98, 1
  s_cmp_gt_u32 s98, 400000
  s_cbranch_scc1 G1w1_xgo
  s_waitcnt vmcnt(0)
  v_cmp_ne_u32 vcc, s3, v2
  s_nop 1
  s_and_b64 vcc, vcc, -1
  s_cbranch_scc1 G1w1_xspin_l
  s_branch G1w1_xgo
G1w1_tok:
  s_mov_b32 s98, 0
  s_mov_b32 s60, s48
  s_and_b32 s61, s49, 0xffff
  s_mov_b32 s62, 0x100
  s_mov_b32 s63, 0x20000
G1w1_tok_l:
  s_sleep 2
  buffer_load_dword v64, v65, s[60:63], 0 offen sc1
  s_add_u32 s98, s98, 1
  s_cmp_gt_u32 s98, 400000
  s_cbranch_scc1 G1w1_tok_ret
  s_waitcnt vmcnt(0)
  v_readfirstlane_b32 s3, v64
  s_nop 1
  s_cmp_eq_u32 s3, 0
  s_cbranch_scc1 G1w1_tok_l
  s_branch G1w1_tok_ret
MG_att:
  s_waitcnt lgkmcnt(0)
  v_mbcnt_lo_u32_b32 v3, -1, 0
  v_mbcnt_hi_u32_b32 v3, -1, v3
  v_lshlrev_b32 v1, 4, v3
  v_mov_b32 v2, 0
  v_mbcnt_lo_u32_b32 v255, -1, 0
  v_mbcnt_hi_u32_b32 v255, -1, v255
  s_mov_b32 s52, s42
  s_bfe_u32 s46, s2, 0x10007
  v_lshrrev_b32 v236, 3, v255
  v_and_b32 v237, 6, v236
  v_and_b32 v238, 7, v255
  v_xor_b32 v237, v237, v238
  v_lshlrev_b32 v236, 11, v236
  v_lshl_add_u32 v228, v237, 4, v236
  s_lshl_b32 s41, s40, 14
  s_add_u32 s41, s41, s38
  v_add_u32 v228, s41, v228
  v_xor_b32 v229, 128, v228
  s_cmp_eq_u32 s46, 0
  s_cselect_b32 s41, 4, 11
  s_cselect_b32 s65, 11, 5
  s_cselect_b32 s67, 11, 3
  s_cselect_b32 s73, 3, 31
  s_mov_b32 s64, 65536
  s_mov_b32 s66, 65536
  s_lshl_b32 s65, s65, 16
  s_lshl_b32 s67, s67, 16
  s_lshl_b32 s43, s40, 11
  s_lshl_b32 s41, s41, 16
  s_mov_b32 s20, s4
  s_and_b32 s21, s5, 0xffff
  s_mov_b32 s22, 0x700000
  s_mov_b32 s23, 0x20000
  s_mul_i32 s42, s46, 196608
  s_lshl_b32 s58, s52, 1
  s_lshr_b32 s59, s40, 1
  s_add_u32 s58, s58, s59
  s_mul_i32 s58, s58, 589824
  s_and_b32 s57, s40, 1
  s_lshl_b32 s57, s57, 11
  s_add_u32 s58, s58, s57
  s_add_u32 s58, s58, 16777216
  s_add_u32 s60, s10, s58
  s_addc_u32 s61, s11, 0
  s_mov_b32 s24, s60
  s_and_b32 s25, s61, 0xffff
  s_mov_b32 s26, 0x8f800
  s_mov_b32 s27, 0x20000
  v_bfe_u32 v236, v255, 2, 3
  v_and_b32 v237, 6, v236
  v_bfe_u32 v238, v255, 1, 1
  v_or_b32 v237, v237, v238
  v_lshlrev_b32 v236, 7, v236
  v_lshl_add_u32 v236, v237, 4, v236
  v_lshrrev_b32 v238, 5, v255
  v_lshl_add_u32 v236, v238, 11, v236
  v_and_b32 v238, 1, v255
  v_lshl_add_u32 v224, v238, 3, v236
  v_xor_b32 v225, 32, v224
  v_xor_b32 v226, 64, v224
  v_xor_b32 v227, 96, v224
  s_mov_b32 s32, s16
  s_and_b32 s33, s17, 0xffff
  s_mov_b32 s34, 0x400000
  s_mov_b32 s35, 0x20000
  v_and_b32 v232, 15, v255
  v_lshlrev_b32 v232, 8, v232
  v_lshrrev_b32 v236, 3, v255
  v_and_b32 v230, 7, v255
  v_xor_b32 v230, v230, v236
  v_lshlrev_b32 v236, 11, v236
  v_lshl_add_u32 v230, v230, 4, v236
  v_lshrrev_b32 v234, 4, v255
  v_lshlrev_b32 v234, 3, v234
  v_lshlrev_b32 v233, 4, v255
  v_and_b32 v236, 0x70, v233
  v_xor_b32 v236, v236, v234
  v_and_b32 v237, 15, v255
  v_lshl_add_u32 v236, v237, 7, v236
  s_lshl_b32 s57, s40, 12
  s_add_u32 s45, s57, 147456
  v_add_u32 v235, s45, v236
  s_lshr_b32 s57, s52, 1
  s_lshl_b32 s63, s57, 12
  s_add_u32 s63, s63, 46301184
  s_lshl_b32 s76, s57, 12
  s_add_u32 s76, s76, 46333952
  s_lshl_b32 s57, s89, 12
  s_lshl_b32 s58, s88, 8
  s_add_u32 s57, s57, s58
  s_mul_i32 s58, s46, 32768
  s_add_u32 s57, s57, s58
  s_add_u32 s74, s57, 46301184
  s_lshl_b32 s57, s47, 1
  s_add_u32 s57, s57, s46
  s_lshl_b32 s62, s57, 8
  s_add_u32 s62, s62, 46137344
  s_xor_b32 s75, s62, 256
  s_lshl_b32 s57, s57, 15
  s_lshl_b32 s58, s40, 13
  s_add_u32 s57, s57, s58
  s_add_u32 s80, s57, 37748736
  s_xor_b32 s81, s80, 32768
  s_cmp_eq_u32 s46, 0
  s_cselect_b32 s77, 6, 8
  v_and_b32 v4, 15, v3
  v_lshrrev_b32 v5, 4, v3
  v_lshlrev_b32 v5, 2, v5
  v_mov_b32 v6, 0xf149f2ca
  v_mov_b32 v8, 0x3f803f80
  v_add_u32 v7, 0, v5
  v_cmp_le_u32 vcc, v7, v4
  v_accvgpr_write_b32 a32, v8
  s_nop 0
  v_cndmask_b32 v96, v6, 0, vcc
  v_cndmask_b32 v100, 0, v6, vcc
  v_add_u32 v7, 1, v5
  v_cmp_le_u32 vcc, v7, v4
  v_accvgpr_write_b32 a33, v8
  s_nop 0
  v_cndmask_b32 v97, v6, 0, vcc
  v_cndmask_b32 v101, 0, v6, vcc
  v_add_u32 v7, 2, v5
  v_cmp_le_u32 vcc, v7, v4
  v_accvgpr_write_b32 a34, v8
  s_nop 0
  v_cndmask_b32 v98, v6, 0, vcc
  v_cndmask_b32 v102, 0, v6, vcc
  v_add_u32 v7, 3, v5
  v_cmp_le_u32 vcc, v7, v4
  v_accvgpr_write_b32 a35, v8
  s_nop 0
  v_cndmask_b32 v99, v6, 0, vcc
  v_cndmask_b32 v103, 0, v6, vcc
  v_add_u32 v238, s94, v1
  v_add_u32 v239, 81920, v238
  s_add_u32 s92, s40, 1
  s_cmp_eq_u32 s89, 0
  s_cselect_b32 s92, s92, 99
  s_lshl_b32 s90, s89, 2
  s_add_u32 s90, s90, s40
  s_mul_i32 s90, s90, 589824
  s_lshl_b32 s93, s88, 13
  s_add_u32 s90, s90, s93
  s_add_u32 s90, s90, 17235968
  s_add_u32 s91, s90, 4096
  s_mov_b32 s95, 0
  s_mov_b32 s18, 0x5d800000
  ds_read_b128 a[36:39], v238 offset:24576
  ds_read_b128 a[40:43], v238 offset:25600
  s_waitcnt lgkmcnt(0)
  v_mfma_f32_16x16x32_bf16 v[40:43], a[36:39], a[72:75], v[96:99]
  v_mfma_f32_16x16x32_bf16 v[48:51], a[36:39], a[76:79], 0
  v_mfma_f32_16x16x32_bf16 v[52:55], a[40:43], a[76:79], v[96:99]
  s_barrier
  s_nop 6
  ds_read_b128 a[8:11], v238 offset:22528
  ds_read_b128 a[12:15], v238 offset:23552
  v_max3_f32 v236, v40, v41, v42
  v_max3_f32 v237, v48, v49, v50
  v_max_f32 v236, v236, v43
  v_max3_f32 v237, v237, v51, v52
  v_max3_f32 v237, v237, v53, v54
  v_max_f32 v237, v237, v55
  v_mov_b32 v4, v236
  v_mov_b32 v5, v237
  s_nop 0
  v_permlane16_swap_b32 v236, v4
  v_permlane16_swap_b32 v237, v5
  v_max_f32 v236, v236, v4
  v_max_f32 v237, v237, v5
  v_mov_b32 v4, v236
  v_mov_b32 v5, v237
  s_nop 0
  v_permlane32_swap_b32 v236, v4
  v_permlane32_swap_b32 v237, v5
  v_max_f32 v236, v236, v4
  v_max_f32 v237, v237, v5
  v_sub_f32 v104, 0, v236
  v_sub_f32 v105, 0, v236
  v_sub_f32 v106, 0, v236
  v_sub_f32 v107, 0, v236
  v_sub_f32 v108, 0, v237
  v_sub_f32 v109, 0, v237
  v_sub_f32 v110, 0, v237
  v_sub_f32 v111, 0, v237
  v_sub_f32 v40, v40, v236
  v_sub_f32 v41, v41, v236
  v_sub_f32 v42, v42, v236
  v_sub_f32 v43, v43, v236
  v_sub_f32 v48, v48, v237
  v_sub_f32 v49, v49, v237
  v_sub_f32 v50, v50, v237
  v_sub_f32 v51, v51, v237
  v_sub_f32 v52, v52, v237
  v_sub_f32 v53, v53, v237
  v_sub_f32 v54, v54, v237
  v_sub_f32 v55, v55, v237
  s_mov_b32 s28, s10
  s_and_b32 s29, s11, 0xffff
  s_mov_b32 s30, 0
  s_mov_b32 s31, 0x20000
  buffer_load_dword v0, v2, s[84:87], s99 offen sc1
  s_waitcnt lgkmcnt(0)
  v_mfma_f32_16x16x32_bf16 v[24:27], a[8:11], a[72:75], v[104:107]
  ds_read_b128 a[0:3], v238 offset:20480
  v_exp_f32 v40, v40
  v_exp_f32 v41, v41
  v_exp_f32 v42, v42
  v_exp_f32 v43, v43
  v_exp_f32 v48, v48
  v_mfma_f32_16x16x32_bf16 v[28:31], a[12:15], a[72:75], v[104:107]
  ds_read_b128 a[4:7], v238 offset:21504
  ds_read_b128 a[16:19], v238 offset:57344
  v_exp_f32 v49, v49
  v_exp_f32 v50, v50
  v_exp_f32 v51, v51
  v_exp_f32 v52, v52
  v_exp_f32 v53, v53
  v_mfma_f32_16x16x32_bf16 v[32:35], a[8:11], a[76:79], v[108:111]
  ds_read_b128 a[20:23], v238 offset:58368
  v_exp_f32 v54, v54
  v_exp_f32 v55, v55
  v_cvt_pk_bf16_f32 v56, v40, v41
  v_cvt_pk_bf16_f32 v57, v42, v43
  v_mov_b32 v58, 0
  v_mfma_f32_16x16x32_bf16 v[36:39], a[12:15], a[76:79], v[108:111]
  ds_read_b128 a[36:39], v239 offset:24576
  ds_read_b128 a[40:43], v239 offset:25600
  v_mov_b32 v59, 0
  v_cvt_pk_bf16_f32 v60, v48, v49
  v_cvt_pk_bf16_f32 v61, v50, v51
  v_cvt_pk_bf16_f32 v62, v52, v53
  v_cvt_pk_bf16_f32 v63, v54, v55
  s_waitcnt lgkmcnt(0)
  v_mfma_f32_16x16x32_bf16 v[8:11], a[0:3], a[72:75], v[104:107]
  ds_read_b128 a[8:11], v238 offset:18432
  v_exp_f32 v24, v24
  v_mfma_f32_16x16x32_bf16 v[12:15], a[4:7], a[72:75], v[104:107]
  ds_read_b128 a[12:15], v238 offset:19456
  v_exp_f32 v25, v25
  v_exp_f32 v26, v26
  v_mfma_f32_16x16x32_bf16 v[16:19], a[0:3], a[76:79], v[108:111]
  ds_read_b128 a[24:27], v238 offset:55296
  v_exp_f32 v27, v27
  v_exp_f32 v28, v28
  v_mfma_f32_16x16x32_bf16 v[20:23], a[4:7], a[76:79], v[108:111]
  ds_read_b128 a[28:31], v238 offset:56320
  v_exp_f32 v29, v29
  v_exp_f32 v30, v30
  v_mfma_f32_16x16x32_bf16 v[40:43], a[36:39], a[88:91], v[96:99]
  v_exp_f32 v31, v31
  v_exp_f32 v32, v32
  v_mfma_f32_16x16x32_bf16 v[48:51], a[36:39], a[92:95], 0
  v_exp_f32 v33, v33
  v_exp_f32 v34, v34
  v_mfma_f32_16x16x32_bf16 v[52:55], a[40:43], a[92:95], v[96:99]
  v_exp_f32 v35, v35
  v_mfma_f32_16x16x32_bf16 v[72:75], a[16:19], v[56:59], 0
  v_exp_f32 v36, v36
  v_exp_f32 v37, v37
  v_mfma_f32_16x16x32_bf16 v[76:79], a[20:23], v[56:59], 0
  v_exp_f32 v38, v38
  v_exp_f32 v39, v39
  v_mfma_f32_16x16x32_bf16 v[80:83], a[32:35], v[56:59], 0
  v_cvt_pk_bf16_f32 v64, v24, v25
  v_cvt_pk_bf16_f32 v65, v26, v27
  v_mfma_f32_16x16x32_bf16 v[84:87], a[16:19], v[60:63], 0
  v_cvt_pk_bf16_f32 v66, v28, v29
  v_cvt_pk_bf16_f32 v67, v30, v31
  v_mfma_f32_16x16x32_bf16 v[88:91], a[20:23], v[60:63], 0
  v_cvt_pk_bf16_f32 v68, v32, v33
  v_cvt_pk_bf16_f32 v69, v34, v35
  v_mfma_f32_16x16x32_bf16 v[92:95], a[32:35], v[60:63], 0
  v_cvt_pk_bf16_f32 v70, v36, v37
  v_cvt_pk_bf16_f32 v71, v38, v39
  s_waitcnt vmcnt(0)
  v_cmp_ne_u32 vcc, s3, v0
  s_nop 1
  s_and_b64 vcc, vcc, s[96:97]
  s_cselect_b32 s30, 0, 47185920
  s_barrier
  s_cmp_lg_u32 s40, 0
  s_cbranch_scc1 AT_nofb
  v_mov_b32 v7, s3
  s_mov_b64 exec, 1
  buffer_store_dword v7, v2, s[84:87], s99 offen offset:2304 sc1
  s_mov_b64 exec, -1
AT_nofb:
  s_waitcnt lgkmcnt(0)
  v_mfma_f32_16x16x32_bf16 v[24:27], a[8:11], a[72:75], v[104:107]
  ds_read_b128 a[0:3], v238 offset:16384
  v_exp_f32 v8, v8
  v_exp_f32 v9, v9
  v_mfma_f32_16x16x32_bf16 v[28:31], a[12:15], a[72:75], v[104:107]
  ds_read_b128 a[4:7], v238 offset:17408
  v_exp_f32 v10, v10
  v_exp_f32 v11, v11
  v_max3_f32 v236, v40, v41, v42
  v_mfma_f32_16x16x32_bf16 v[32:35], a[8:11], a[76:79], v[108:111]
  ds_read_b128 a[16:19], v238 offset:53248
  v_exp_f32 v12, v12
  v_exp_f32 v13, v13
  v_exp_f32 v14, v14
  v_mfma_f32_16x16x32_bf16 v[36:39], a[12:15], a[76:79], v[108:111]
  ds_read_b128 a[20:23], v238 offset:54272
  v_exp_f32 v15, v15
  v_exp_f32 v16, v16
  v_max3_f32 v237, v48, v49, v50
  v_mfma_f32_16x16x32_bf16 v[72:75], a[24:27], v[64:67], v[72:75]
  v_exp_f32 v17, v17
  v_exp_f32 v18, v18
  v_exp_f32 v19, v19
  v_max_f32 v236, v236, v43
  s_add_u32 m0, s94, 0
  s_add_u32 s93, s83, 8372224
  buffer_load_dwordx4 v1, s[28:31], s93 offen offset:0 sc1 lds
  v_mfma_f32_16x16x32_bf16 v[76:79], a[28:31], v[64:67], v[76:79]
  v_exp_f32 v20, v20
  v_exp_f32 v21, v21
  v_mfma_f32_16x16x32_bf16 v[80:83], a[32:35], v[64:67], v[80:83]
  v_exp_f32 v22, v22
  v_exp_f32 v23, v23
  v_max3_f32 v237, v237, v51, v52
  v_mfma_f32_16x16x32_bf16 v[84:87], a[24:27], v[68:71], v[84:87]
  v_cvt_pk_bf16_f32 v56, v8, v9
  v_cvt_pk_bf16_f32 v57, v10, v11
  v_cvt_pk_bf16_f32 v58, v12, v13
  v_mfma_f32_16x16x32_bf16 v[88:91], a[28:31], v[68:71], v[88:91]
  v_cvt_pk_bf16_f32 v59, v14, v15
  v_cvt_pk_bf16_f32 v60, v16, v17
  v_max3_f32 v237, v237, v53, v54
  v_mfma_f32_16x16x32_bf16 v[92:95], a[32:35], v[68:71], v[92:95]
  v_cvt_pk_bf16_f32 v61, v18, v19
  v_cvt_pk_bf16_f32 v62, v20, v21
  v_cvt_pk_bf16_f32 v63, v22, v23
  v_max_f32 v237, v237, v55
  buffer_load_dwordx4 v1, s[28:31], s93 offen offset:1024 sc1 lds
  s_waitcnt lgkmcnt(0)
  v_mfma_f32_16x16x32_bf16 v[8:11], a[0:3], a[72:75], v[104:107]
  ds_read_b128 a[24:27], v238 offset:51200
  v_exp_f32 v24, v24
  v_exp_f32 v25, v25
  v_mov_b32 v4, v236
  v_mov_b32 v5, v237
  s_nop 0
  v_permlane16_swap_b32 v236, v4
  v_permlane16_swap_b32 v237, v5
  v_mfma_f32_16x16x32_bf16 v[12:15], a[4:7], a[72:75], v[104:107]
  ds_read_b128 a[28:31], v238 offset:52224
  v_exp_f32 v26, v26
  v_exp_f32 v27, v27
  v_max_f32 v236, v236, v4
  v_max_f32 v237, v237, v5
  v_mov_b32 v4, v236
  v_mov_b32 v5, v237
  s_nop 0
  v_permlane32_swap_b32 v236, v4
  v_permlane32_swap_b32 v237, v5
  v_mfma_f32_16x16x32_bf16 v[16:19], a[0:3], a[76:79], v[108:111]
  v_exp_f32 v28, v28
  v_exp_f32 v29, v29
  v_exp_f32 v30, v30
  v_max_f32 v236, v236, v4
  v_max_f32 v237, v237, v5
  v_mfma_f32_16x16x32_bf16 v[20:23], a[4:7], a[76:79], v[108:111]
  v_exp_f32 v31, v31
  v_exp_f32 v32, v32
  v_sub_f32 v40, v40, v236
  v_sub_f32 v41, v41, v236
  v_mfma_f32_16x16x32_bf16 v[72:75], a[16:19], v[56:59], v[72:75]
  v_exp_f32 v33, v33
  v_exp_f32 v34, v34
  v_exp_f32 v35, v35
  v_sub_f32 v42, v42, v236
  v_sub_f32 v43, v43, v236
  s_add_u32 m0, s94, 6144
  s_nop 0
  buffer_load_dwordx4 v1, s[28:31], s93 offen offset:2048 sc1 lds
  v_mfma_f32_16x16x32_bf16 v[76:79], a[20:23], v[56:59], v[76:79]
  v_exp_f32 v36, v36
  v_exp_f32 v37, v37
  v_sub_f32 v48, v48, v237
  v_mfma_f32_16x16x32_bf16 v[80:83], a[32:35], v[56:59], v[80:83]
  v_exp_f32 v38, v38
  v_exp_f32 v39, v39
  v_sub_f32 v49, v49, v237
  v_sub_f32 v50, v50, v237
  v_mfma_f32_16x16x32_bf16 v[84:87], a[16:19], v[60:63], v[84:87]
  v_cvt_pk_bf16_f32 v64, v24, v25
  v_cvt_pk_bf16_f32 v65, v26, v27
  v_cvt_pk_bf16_f32 v66, v28, v29
  v_sub_f32 v51, v51, v237
  v_mfma_f32_16x16x32_bf16 v[88:91], a[20:23], v[60:63], v[88:91]
  v_cvt_pk_bf16_f32 v67, v30, v31
  v_cvt_pk_bf16_f32 v68, v32, v33
  v_sub_f32 v52, v52, v237
  v_sub_f32 v53, v53, v237
  v_mfma_f32_16x16x32_bf16 v[92:95], a[32:35], v[60:63], v[92:95]
  v_cvt_pk_bf16_f32 v69, v34, v35
  v_cvt_pk_bf16_f32 v70, v36, v37
  v_cvt_pk_bf16_f32 v71, v38, v39
  v_sub_f32 v54, v54, v237
  v_sub_f32 v55, v55, v237
  buffer_load_dwordx4 v1, s[28:31], s93 offen offset:3072 sc1 lds
  s_waitcnt lgkmcnt(0)
  s_nop 0
  v_mfma_f32_16x16x32_bf16 v[72:75], a[24:27], v[64:67], v[72:75]
  ds_read_b128 a[0:3], v239 offset:22528
  v_exp_f32 v8, v8
  v_exp_f32 v9, v9
  v_exp_f32 v10, v10
  v_exp_f32 v11, v11
  v_sub_f32 v216, 0, v236
  v_mfma_f32_16x16x32_bf16 v[76:79], a[28:31], v[64:67], v[76:79]
  ds_read_b128 a[4:7], v239 offset:23552
  v_exp_f32 v12, v12
  v_exp_f32 v13, v13
  v_exp_f32 v14, v14
  v_exp_f32 v15, v15
  v_sub_f32 v217, 0, v236
  v_mfma_f32_16x16x32_bf16 v[80:83], a[32:35], v[64:67], v[80:83]
  ds_read_b128 a[16:19], v238 offset:49152
  v_exp_f32 v16, v16
  v_exp_f32 v17, v17
  v_exp_f32 v18, v18
  v_exp_f32 v19, v19
  v_sub_f32 v218, 0, v236
  v_sub_f32 v219, 0, v236
  s_add_u32 m0, s94, 32768
  s_add_u32 s93, s83, 12566528
  buffer_load_dwordx4 v1, s[28:31], s93 offen offset:0 sc1 lds
  v_mfma_f32_16x16x32_bf16 v[84:87], a[24:27], v[68:71], v[84:87]
  ds_read_b128 a[20:23], v238 offset:50176
  v_exp_f32 v20, v20
  v_exp_f32 v21, v21
  v_exp_f32 v22, v22
  v_exp_f32 v23, v23
  v_sub_f32 v220, 0, v237
  v_mfma_f32_16x16x32_bf16 v[88:91], a[28:31], v[68:71], v[88:91]
  v_cvt_pk_bf16_f32 v56, v8, v9
  v_cvt_pk_bf16_f32 v57, v10, v11
  v_cvt_pk_bf16_f32 v58, v12, v13
  v_cvt_pk_bf16_f32 v59, v14, v15
  v_sub_f32 v221, 0, v237
  v_mfma_f32_16x16x32_bf16 v[92:95], a[32:35], v[68:71], v[92:95]
  v_cvt_pk_bf16_f32 v60, v16, v17
  v_cvt_pk_bf16_f32 v61, v18, v19
  v_cvt_pk_bf16_f32 v62, v20, v21
  v_cvt_pk_bf16_f32 v63, v22, v23
  v_sub_f32 v222, 0, v237
  v_sub_f32 v223, 0, v237
  buffer_load_dwordx4 v1, s[28:31], s93 offen offset:1024 sc1 lds
  s_waitcnt lgkmcnt(0)
  v_mfma_f32_16x16x32_bf16 v[8:11], a[0:3], a[88:91], v[216:219]
  ds_read_b128 a[8:11], v239 offset:20480
  v_exp_f32 v40, v40
  v_exp_f32 v41, v41
  v_mfma_f32_16x16x32_bf16 v[12:15], a[4:7], a[88:91], v[216:219]
  ds_read_b128 a[12:15], v239 offset:21504
  v_exp_f32 v42, v42
  v_exp_f32 v43, v43
  v_mfma_f32_16x16x32_bf16 v[16:19], a[0:3], a[92:95], v[220:223]
  ds_read_b128 a[24:27], v239 offset:57344
  v_exp_f32 v48, v48
  v_exp_f32 v49, v49
  v_mfma_f32_16x16x32_bf16 v[20:23], a[4:7], a[92:95], v[220:223]
  ds_read_b128 a[28:31], v239 offset:58368
  v_exp_f32 v50, v50
  v_exp_f32 v51, v51
  v_mfma_f32_16x16x32_bf16 v[72:75], a[16:19], v[56:59], v[72:75]
  v_exp_f32 v52, v52
  v_exp_f32 v53, v53
  s_add_u32 m0, s94, 38912
  s_nop 0
  buffer_load_dwordx4 v1, s[28:31], s93 offen offset:2048 sc1 lds
  v_mfma_f32_16x16x32_bf16 v[76:79], a[20:23], v[56:59], v[76:79]
  v_exp_f32 v54, v54
  v_exp_f32 v55, v55
  v_mfma_f32_16x16x32_bf16 v[80:83], a[32:35], v[56:59], v[80:83]
  v_cvt_pk_bf16_f32 v64, v40, v41
  v_cvt_pk_bf16_f32 v65, v42, v43
  v_mfma_f32_16x16x32_bf16 v[84:87], a[16:19], v[60:63], v[84:87]
  v_mov_b32 v66, 0
  v_mov_b32 v67, 0
  v_mfma_f32_16x16x32_bf16 v[88:91], a[20:23], v[60:63], v[88:91]
  v_cvt_pk_bf16_f32 v68, v48, v49
  v_cvt_pk_bf16_f32 v69, v50, v51
  v_mfma_f32_16x16x32_bf16 v[92:95], a[32:35], v[60:63], v[92:95]
  v_cvt_pk_bf16_f32 v70, v52, v53
  v_cvt_pk_bf16_f32 v71, v54, v55
  buffer_load_dwordx4 v1, s[28:31], s93 offen offset:3072 sc1 lds
  buffer_load_dword v0, v2, s[84:87], s99 offen offset:2048 sc1
  s_waitcnt lgkmcnt(0)
  v_mfma_f32_16x16x32_bf16 v[24:27], a[8:11], a[88:91], v[216:219]
  ds_read_b128 a[0:3], v239 offset:18432
  v_exp_f32 v8, v8
  v_exp_f32 v9, v9
  v_mfma_f32_16x16x32_bf16 v[28:31], a[12:15], a[88:91], v[216:219]
  ds_read_b128 a[4:7], v239 offset:19456
  v_exp_f32 v10, v10
  v_exp_f32 v11, v11
  v_mfma_f32_16x16x32_bf16 v[32:35], a[8:11], a[92:95], v[220:223]
  ds_read_b128 a[16:19], v239 offset:55296
  v_exp_f32 v12, v12
  v_exp_f32 v13, v13
  v_exp_f32 v14, v14
  v_mfma_f32_16x16x32_bf16 v[36:39], a[12:15], a[92:95], v[220:223]
  ds_read_b128 a[20:23], v239 offset:56320
  v_exp_f32 v15, v15
  v_exp_f32 v16, v16
  v_mfma_f32_16x16x32_bf16 v[136:139], a[24:27], v[64:67], 0
  v_exp_f32 v17, v17
  v_exp_f32 v18, v18
  v_exp_f32 v19, v19
  v_mfma_f32_16x16x32_bf16 v[140:143], a[28:31], v[64:67], 0
  v_exp_f32 v20, v20
  v_exp_f32 v21, v21
  v_mfma_f32_16x16x32_bf16 v[144:147], a[32:35], v[64:67], 0
  v_exp_f32 v22, v22
  v_exp_f32 v23, v23
  v_mfma_f32_16x16x32_bf16 v[148:151], a[24:27], v[68:71], 0
  v_cvt_pk_bf16_f32 v56, v8, v9
  v_cvt_pk_bf16_f32 v57, v10, v11
  v_cvt_pk_bf16_f32 v58, v12, v13
  v_mfma_f32_16x16x32_bf16 v[152:155], a[28:31], v[68:71], 0
  v_cvt_pk_bf16_f32 v59, v14, v15
  v_cvt_pk_bf16_f32 v60, v16, v17
  v_mfma_f32_16x16x32_bf16 v[156:159], a[32:35], v[68:71], 0
  v_cvt_pk_bf16_f32 v61, v18, v19
  v_cvt_pk_bf16_f32 v62, v20, v21
  v_cvt_pk_bf16_f32 v63, v22, v23
  s_waitcnt lgkmcnt(0)
  v_mfma_f32_16x16x32_bf16 v[8:11], a[0:3], a[88:91], v[216:219]
  ds_read_b128 a[8:11], v239 offset:16384
  v_exp_f32 v24, v24
  v_exp_f32 v25, v25
  v_mfma_f32_16x16x32_bf16 v[12:15], a[4:7], a[88:91], v[216:219]
  ds_read_b128 a[12:15], v239 offset:17408
  v_exp_f32 v26, v26
  v_exp_f32 v27, v27
  v_mfma_f32_16x16x32_bf16 v[16:19], a[0:3], a[92:95], v[220:223]
  ds_read_b128 a[24:27], v239 offset:53248
  v_exp_f32 v28, v28
  v_exp_f32 v29, v29
  v_exp_f32 v30, v30
  v_mfma_f32_16x16x32_bf16 v[20:23], a[4:7], a[92:95], v[220:223]
  ds_read_b128 a[28:31], v239 offset:54272
  v_exp_f32 v31, v31
  v_exp_f32 v32, v32
  v_mfma_f32_16x16x32_bf16 v[136:139], a[16:19], v[56:59], v[136:139]
  v_exp_f32 v33, v33
  v_exp_f32 v34, v34
  v_exp_f32 v35, v35
  v_mfma_f32_16x16x32_bf16 v[140:143], a[20:23], v[56:59], v[140:143]
  v_exp_f32 v36, v36
  v_exp_f32 v37, v37
  v_mfma_f32_16x16x32_bf16 v[144:147], a[32:35], v[56:59], v[144:147]
  v_exp_f32 v38, v38
  v_exp_f32 v39, v39
  v_mfma_f32_16x16x32_bf16 v[148:151], a[16:19], v[60:63], v[148:151]
  v_cvt_pk_bf16_f32 v64, v24, v25
  v_cvt_pk_bf16_f32 v65, v26, v27
  v_cvt_pk_bf16_f32 v66, v28, v29
  v_mfma_f32_16x16x32_bf16 v[152:155], a[20:23], v[60:63], v[152:155]
  v_cvt_pk_bf16_f32 v67, v30, v31
  v_cvt_pk_bf16_f32 v68, v32, v33
  v_mfma_f32_16x16x32_bf16 v[156:159], a[32:35], v[60:63], v[156:159]
  v_cvt_pk_bf16_f32 v69, v34, v35
  v_cvt_pk_bf16_f32 v70, v36, v37
  v_cvt_pk_bf16_f32 v71, v38, v39
  s_cmp_eq_u32 s30, 0
  s_cbranch_scc1 AT_qa
AT_qa_ret:
  s_waitcnt vmcnt(1)
  s_barrier
  s_waitcnt vmcnt(0)
  v_cmp_ne_u32 vcc, s3, v0
  s_nop 1
  s_and_b64 vcc, vcc, s[96:97]
  s_cbranch_scc1 AT_qb
AT_qb_ret:
  s_waitcnt lgkmcnt(0)
  v_mfma_f32_16x16x32_bf16 v[24:27], a[8:11], a[88:91], v[216:219]
  ds_read_b128 a[0:3], v238 offset:14336
  v_exp_f32 v8, v8
  v_exp_f32 v9, v9
  v_mfma_f32_16x16x32_bf16 v[28:31], a[12:15], a[88:91], v[216:219]
  ds_read_b128 a[4:7], v238 offset:15360
  v_exp_f32 v10, v10
  v_exp_f32 v11, v11
  v_mfma_f32_16x16x32_bf16 v[32:35], a[8:11], a[92:95], v[220:223]
  ds_read_b128 a[16:19], v239 offset:51200
  v_exp_f32 v12, v12
  v_exp_f32 v13, v13
  v_exp_f32 v14, v14
  v_mfma_f32_16x16x32_bf16 v[36:39], a[12:15], a[92:95], v[220:223]
  ds_read_b128 a[20:23], v239 offset:52224
  v_exp_f32 v15, v15
  v_exp_f32 v16, v16
  s_add_u32 m0, s94, 81920
  s_add_u32 s93, s83, 8503296
  buffer_load_dwordx4 v1, s[84:87], s93 offen offset:0 sc1 lds
  v_mfma_f32_16x16x32_bf16 v[136:139], a[24:27], v[64:67], v[136:139]
  v_exp_f32 v17, v17
  v_exp_f32 v18, v18
  v_exp_f32 v19, v19
  v_mfma_f32_16x16x32_bf16 v[140:143], a[28:31], v[64:67], v[140:143]
  v_exp_f32 v20, v20
  v_exp_f32 v21, v21
  v_mfma_f32_16x16x32_bf16 v[144:147], a[32:35], v[64:67], v[144:147]
  v_exp_f32 v22, v22
  v_exp_f32 v23, v23
  buffer_load_dwordx4 v1, s[84:87], s93 offen offset:1024 sc1 lds
  v_mfma_f32_16x16x32_bf16 v[148:151], a[24:27], v[68:71], v[148:151]
  v_cvt_pk_bf16_f32 v56, v8, v9
  v_cvt_pk_bf16_f32 v57, v10, v11
  v_cvt_pk_bf16_f32 v58, v12, v13
  v_mfma_f32_16x16x32_bf16 v[152:155], a[28:31], v[68:71], v[152:155]
  v_cvt_pk_bf16_f32 v59, v14, v15
  v_cvt_pk_bf16_f32 v60, v16, v17
  v_mfma_f32_16x16x32_bf16 v[156:159], a[32:35], v[68:71], v[156:159]
  v_cvt_pk_bf16_f32 v61, v18, v19
  v_cvt_pk_bf16_f32 v62, v20, v21
  v_cvt_pk_bf16_f32 v63, v22, v23
  s_add_u32 m0, s94, 88064
  s_nop 0
  buffer_load_dwordx4 v1, s[84:87], s93 offen offset:2048 sc1 lds
  s_cmp_eq_u32 s92, 1
  s_cbranch_scc1 AT_inv9
AT_inv9_ret:
  s_waitcnt lgkmcnt(0)
  v_mfma_f32_16x16x32_bf16 v[8:11], a[0:3], a[72:75], v[104:107]
  ds_read_b128 a[8:11], v238 offset:12288
  v_exp_f32 v24, v24
  v_exp_f32 v25, v25
  v_mfma_f32_16x16x32_bf16 v[12:15], a[4:7], a[72:75], v[104:107]
  ds_read_b128 a[12:15], v238 offset:13312
  v_exp_f32 v26, v26
  v_exp_f32 v27, v27
  v_mfma_f32_16x16x32_bf16 v[16:19], a[0:3], a[76:79], v[108:111]
  ds_read_b128 a[24:27], v239 offset:49152
  v_exp_f32 v28, v28
  v_exp_f32 v29, v29
  v_exp_f32 v30, v30
  v_mfma_f32_16x16x32_bf16 v[20:23], a[4:7], a[76:79], v[108:111]
  ds_read_b128 a[28:31], v239 offset:50176
  v_exp_f32 v31, v31
  v_exp_f32 v32, v32
  buffer_load_dwordx4 v1, s[84:87], s93 offen offset:3072 sc1 lds
  v_mfma_f32_16x16x32_bf16 v[136:139], a[16:19], v[56:59], v[136:139]
  v_exp_f32 v33, v33
  v_exp_f32 v34, v34
  v_exp_f32 v35, v35
  v_mfma_f32_16x16x32_bf16 v[140:143], a[20:23], v[56:59], v[140:143]
  v_exp_f32 v36, v36
  v_exp_f32 v37, v37
  v_mfma_f32_16x16x32_bf16 v[144:147], a[32:35], v[56:59], v[144:147]
  v_exp_f32 v38, v38
  v_exp_f32 v39, v39
  s_add_u32 m0, s94, 114688
  s_add_u32 s93, s83, 12697600
  buffer_load_dwordx4 v1, s[84:87], s93 offen offset:0 sc1 lds
  v_mfma_f32_16x16x32_bf16 v[148:151], a[16:19], v[60:63], v[148:151]
  v_cvt_pk_bf16_f32 v64, v24, v25
  v_cvt_pk_bf16_f32 v65, v26, v27
  v_cvt_pk_bf16_f32 v66, v28, v29
  v_mfma_f32_16x16x32_bf16 v[152:155], a[20:23], v[60:63], v[152:155]
  v_cvt_pk_bf16_f32 v67, v30, v31
  v_cvt_pk_bf16_f32 v68, v32, v33
  v_mfma_f32_16x16x32_bf16 v[156:159], a[32:35], v[60:63], v[156:159]
  v_cvt_pk_bf16_f32 v69, v34, v35
  v_cvt_pk_bf16_f32 v70, v36, v37
  v_cvt_pk_bf16_f32 v71, v38, v39
  buffer_load_dwordx4 v1, s[84:87], s93 offen offset:1024 sc1 lds
  s_cmp_eq_u32 s92, 2
  s_cbranch_scc1 AT_inv10
AT_inv10_ret:
  s_waitcnt lgkmcnt(0)
  v_mfma_f32_16x16x32_bf16 v[24:27], a[8:11], a[72:75], v[104:107]
  ds_read_b128 a[0:3], v238 offset:10240
  v_exp_f32 v8, v8
  v_exp_f32 v9, v9
  v_mfma_f32_16x16x32_bf16 v[28:31], a[12:15], a[72:75], v[104:107]
  ds_read_b128 a[4:7], v238 offset:11264
  v_exp_f32 v10, v10
  v_exp_f32 v11, v11
  v_mfma_f32_16x16x32_bf16 v[32:35], a[8:11], a[76:79], v[108:111]
  ds_read_b128 a[16:19], v238 offset:47104
  v_exp_f32 v12, v12
  v_exp_f32 v13, v13
  v_exp_f32 v14, v14
  v_mfma_f32_16x16x32_bf16 v[36:39], a[12:15], a[76:79], v[108:111]
  ds_read_b128 a[20:23], v238 offset:48128
  v_exp_f32 v15, v15
  v_exp_f32 v16, v16
  v_mfma_f32_16x16x32_bf16 v[136:139], a[24:27], v[64:67], v[136:139]
  v_exp_f32 v17, v17
  v_exp_f32 v18, v18
  v_exp_f32 v19, v19
  s_add_u32 m0, s94, 120832
  s_nop 0
  buffer_load_dwordx4 v1, s[84:87], s93 offen offset:2048 sc1 lds
  v_mfma_f32_16x16x32_bf16 v[140:143], a[28:31], v[64:67], v[140:143]
  v_exp_f32 v20, v20
  v_exp_f32 v21, v21
  v_mfma_f32_16x16x32_bf16 v[144:147], a[32:35], v[64:67], v[144:147]
  v_exp_f32 v22, v22
  v_exp_f32 v23, v23
  v_mfma_f32_16x16x32_bf16 v[148:151], a[24:27], v[68:71], v[148:151]
  v_cvt_pk_bf16_f32 v56, v8, v9
  v_cvt_pk_bf16_f32 v57, v10, v11
  v_cvt_pk_bf16_f32 v58, v12, v13
  v_mfma_f32_16x16x32_bf16 v[152:155], a[28:31], v[68:71], v[152:155]
  v_cvt_pk_bf16_f32 v59, v14, v15
  v_cvt_pk_bf16_f32 v60, v16, v17
  v_mfma_f32_16x16x32_bf16 v[156:159], a[32:35], v[68:71], v[156:159]
  v_cvt_pk_bf16_f32 v61, v18, v19
  v_cvt_pk_bf16_f32 v62, v20, v21
  v_cvt_pk_bf16_f32 v63, v22, v23
  buffer_load_dwordx4 v1, s[84:87], s93 offen offset:3072 sc1 lds
  s_cmp_eq_u32 s92, 3
  s_cbranch_scc1 AT_inv11
AT_inv11_ret:
  s_waitcnt lgkmcnt(0)
  v_mfma_f32_16x16x32_bf16 v[8:11], a[0:3], a[72:75], v[104:107]
  ds_read_b128 a[8:11], v238 offset:8192
  v_exp_f32 v24, v24
  v_exp_f32 v25, v25
  v_mfma_f32_16x16x32_bf16 v[12:15], a[4:7], a[72:75], v[104:107]
  ds_read_b128 a[12:15], v238 offset:9216
  v_exp_f32 v26, v26
  v_exp_f32 v27, v27
  v_add_f32 v128, v100, v104
  v_mfma_f32_16x16x32_bf16 v[16:19], a[0:3], a[76:79], v[108:111]
  ds_read_b128 a[24:27], v238 offset:45056
  v_exp_f32 v28, v28
  v_exp_f32 v29, v29
  v_exp_f32 v30, v30
  v_add_f32 v129, v101, v105
  v_mfma_f32_16x16x32_bf16 v[20:23], a[4:7], a[76:79], v[108:111]
  ds_read_b128 a[28:31], v238 offset:46080
  v_exp_f32 v31, v31
  v_exp_f32 v32, v32
  v_add_f32 v130, v102, v106
  v_mfma_f32_16x16x32_bf16 v[72:75], a[16:19], v[56:59], v[72:75]
  v_exp_f32 v33, v33
  v_exp_f32 v34, v34
  v_exp_f32 v35, v35
  v_add_f32 v131, v103, v107
  v_mfma_f32_16x16x32_bf16 v[76:79], a[20:23], v[56:59], v[76:79]
  v_exp_f32 v36, v36
  v_exp_f32 v37, v37
  v_mfma_f32_16x16x32_bf16 v[80:83], a[32:35], v[56:59], v[80:83]
  v_exp_f32 v38, v38
  v_exp_f32 v39, v39
  v_add_f32 v132, v100, v108
  v_mfma_f32_16x16x32_bf16 v[84:87], a[16:19], v[60:63], v[84:87]
  v_cvt_pk_bf16_f32 v64, v24, v25
  v_cvt_pk_bf16_f32 v65, v26, v27
  v_cvt_pk_bf16_f32 v66, v28, v29
  v_add_f32 v133, v101, v109
  v_mfma_f32_16x16x32_bf16 v[88:91], a[20:23], v[60:63], v[88:91]
  v_cvt_pk_bf16_f32 v67, v30, v31
  v_cvt_pk_bf16_f32 v68, v32, v33
  v_add_f32 v134, v102, v110
  v_mfma_f32_16x16x32_bf16 v[92:95], a[32:35], v[60:63], v[92:95]
  v_cvt_pk_bf16_f32 v69, v34, v35
  v_cvt_pk_bf16_f32 v70, v36, v37
  v_cvt_pk_bf16_f32 v71, v38, v39
  v_add_f32 v135, v103, v111
  s_cmp_eq_u32 s92, 4
  s_cbranch_scc1 AT_inv12
AT_inv12_ret:
  s_waitcnt vmcnt(0)
  s_barrier
  s_waitcnt lgkmcnt(0)
  v_mfma_f32_16x16x32_bf16 v[24:27], a[8:11], a[72:75], v[128:131]
  ds_read_b128 a[0:3], v239 offset:14336
  v_exp_f32 v8, v8
  v_exp_f32 v9, v9
  v_mfma_f32_16x16x32_bf16 v[28:31], a[12:15], a[72:75], v[104:107]
  ds_read_b128 a[4:7], v239 offset:15360
  v_exp_f32 v10, v10
  v_exp_f32 v11, v11
  v_exp_f32 v12, v12
  v_mfma_f32_16x16x32_bf16 v[36:39], a[12:15], a[76:79], v[132:135]
  ds_read_b128 a[16:19], v238 offset:43008
  v_exp_f32 v13, v13
  v_exp_f32 v14, v14
  v_exp_f32 v15, v15
  v_mfma_f32_16x16x32_bf16 v[72:75], a[24:27], v[64:67], v[72:75]
  ds_read_b128 a[20:23], v238 offset:44032
  v_exp_f32 v16, v16
  v_exp_f32 v17, v17
  v_mfma_f32_16x16x32_bf16 v[76:79], a[28:31], v[64:67], v[76:79]
  v_exp_f32 v18, v18
  v_exp_f32 v19, v19
  v_exp_f32 v20, v20
  v_mfma_f32_16x16x32_bf16 v[80:83], a[32:35], v[64:67], v[80:83]
  v_exp_f32 v21, v21
  v_exp_f32 v22, v22
  v_exp_f32 v23, v23
  v_mfma_f32_16x16x32_bf16 v[84:87], a[24:27], v[68:71], v[84:87]
  v_cvt_pk_bf16_f32 v56, v8, v9
  v_cvt_pk_bf16_f32 v57, v10, v11
  v_mfma_f32_16x16x32_bf16 v[88:91], a[28:31], v[68:71], v[88:91]
  v_cvt_pk_bf16_f32 v58, v12, v13
  v_cvt_pk_bf16_f32 v59, v14, v15
  v_cvt_pk_bf16_f32 v60, v16, v17
  v_mfma_f32_16x16x32_bf16 v[92:95], a[32:35], v[68:71], v[92:95]
  v_cvt_pk_bf16_f32 v61, v18, v19
  v_cvt_pk_bf16_f32 v62, v20, v21
  v_cvt_pk_bf16_f32 v63, v22, v23
  s_cmp_eq_u32 s92, 1
  s_cbranch_scc1 AT_inv13
AT_inv13_ret:
  s_waitcnt lgkmcnt(0)
  v_mfma_f32_16x16x32_bf16 v[8:11], a[0:3], a[88:91], v[216:219]
  ds_read_b128 a[8:11], v239 offset:12288
  v_exp_f32 v24, v24
  v_exp_f32 v25, v25
  v_mfma_f32_16x16x32_bf16 v[12:15], a[4:7], a[88:91], v[216:219]
  ds_read_b128 a[12:15], v239 offset:13312
  v_exp_f32 v26, v26
  v_exp_f32 v27, v27
  v_mfma_f32_16x16x32_bf16 v[16:19], a[0:3], a[92:95], v[220:223]
  ds_read_b128 a[24:27], v238 offset:40960
  v_exp_f32 v28, v28
  v_exp_f32 v29, v29
  v_mfma_f32_16x16x32_bf16 v[20:23], a[4:7], a[92:95], v[220:223]
  ds_read_b128 a[28:31], v238 offset:41984
  v_exp_f32 v30, v30
  v_exp_f32 v31, v31
  v_mfma_f32_16x16x32_bf16 v[72:75], a[16:19], v[56:59], v[72:75]
  ds_read_b128 a[36:39], v238 offset:16384
  v_exp_f32 v36, v36
  v_exp_f32 v37, v37
  v_mfma_f32_16x16x32_bf16 v[76:79], a[20:23], v[56:59], v[76:79]
  ds_read_b128 a[40:43], v238 offset:17408
  v_exp_f32 v38, v38
  v_exp_f32 v39, v39
  v_mfma_f32_16x16x32_bf16 v[80:83], a[32:35], v[56:59], v[80:83]
  v_cvt_pk_bf16_f32 v64, v24, v25
  v_cvt_pk_bf16_f32 v65, v26, v27
  v_mfma_f32_16x16x32_bf16 v[84:87], a[16:19], v[60:63], v[84:87]
  v_cvt_pk_bf16_f32 v66, v28, v29
  v_cvt_pk_bf16_f32 v67, v30, v31
  v_mfma_f32_16x16x32_bf16 v[88:91], a[20:23], v[60:63], v[88:91]
  v_mov_b32 v68, 0
  v_mov_b32 v69, 0
  v_mfma_f32_16x16x32_bf16 v[92:95], a[32:35], v[60:63], v[92:95]
  v_cvt_pk_bf16_f32 v70, v36, v37
  v_cvt_pk_bf16_f32 v71, v38, v39
  s_cmp_eq_u32 s92, 2
  s_cbranch_scc1 AT_inv14
AT_inv14_ret:
  s_waitcnt lgkmcnt(0)
  v_mfma_f32_16x16x32_bf16 v[24:27], a[8:11], a[88:91], v[216:219]
  ds_read_b128 a[0:3], v239 offset:10240
  v_exp_f32 v8, v8
  v_mfma_f32_16x16x32_bf16 v[28:31], a[12:15], a[88:91], v[216:219]
  ds_read_b128 a[4:7], v239 offset:11264
  v_exp_f32 v9, v9
  v_exp_f32 v10, v10
  v_mfma_f32_16x16x32_bf16 v[32:35], a[8:11], a[92:95], v[220:223]
  ds_read_b128 a[16:19], v239 offset:47104
  v_exp_f32 v11, v11
  v_exp_f32 v12, v12
  v_mfma_f32_16x16x32_bf16 v[36:39], a[12:15], a[92:95], v[220:223]
  ds_read_b128 a[20:23], v239 offset:48128
  v_exp_f32 v13, v13
  v_exp_f32 v14, v14
  v_mfma_f32_16x16x32_bf16 v[40:43], a[36:39], a[64:67], v[96:99]
  v_exp_f32 v15, v15
  v_exp_f32 v16, v16
  v_mfma_f32_16x16x32_bf16 v[48:51], a[36:39], a[68:71], 0
  v_exp_f32 v17, v17
  v_exp_f32 v18, v18
  v_mfma_f32_16x16x32_bf16 v[52:55], a[40:43], a[68:71], v[96:99]
  v_exp_f32 v19, v19
  v_mfma_f32_16x16x32_bf16 v[72:75], a[24:27], v[64:67], v[72:75]
  v_exp_f32 v20, v20
  v_exp_f32 v21, v21
  v_mfma_f32_16x16x32_bf16 v[76:79], a[28:31], v[64:67], v[76:79]
  v_exp_f32 v22, v22
  v_exp_f32 v23, v23
  v_mfma_f32_16x16x32_bf16 v[80:83], a[32:35], v[64:67], v[80:83]
  v_cvt_pk_bf16_f32 v56, v8, v9
  v_cvt_pk_bf16_f32 v57, v10, v11
  v_mfma_f32_16x16x32_bf16 v[84:87], a[24:27], v[68:71], v[84:87]
  v_cvt_pk_bf16_f32 v58, v12, v13
  v_cvt_pk_bf16_f32 v59, v14, v15
  v_mfma_f32_16x16x32_bf16 v[88:91], a[28:31], v[68:71], v[88:91]
  v_cvt_pk_bf16_f32 v60, v16, v17
  v_cvt_pk_bf16_f32 v61, v18, v19
  v_mfma_f32_16x16x32_bf16 v[92:95], a[32:35], v[68:71], v[92:95]
  v_cvt_pk_bf16_f32 v62, v20, v21
  v_cvt_pk_bf16_f32 v63, v22, v23
  s_cmp_eq_u32 s92, 3
  s_cbranch_scc1 AT_inv15
AT_inv15_ret:
  s_waitcnt lgkmcnt(0)
  v_mfma_f32_16x16x32_bf16 v[8:11], a[0:3], a[88:91], v[216:219]
  ds_read_b128 a[8:11], v239 offset:8192
  v_exp_f32 v24, v24
  v_exp_f32 v25, v25
  s_nop 1
  v_rcp_f32 v4, v80
  v_rcp_f32 v5, v92
  v_max_f32 v7, v80, v92
  v_cmp_ngt_f32 vcc, s18, v7
  s_nop 1
  s_cmp_lg_u64 vcc, 0
  s_cselect_b32 s95, 1, s95
  v_mul_f32 v72, v72, v4
  v_mul_f32 v73, v73, v4
  v_mul_f32 v74, v74, v4
  v_mfma_f32_16x16x32_bf16 v[12:15], a[4:7], a[88:91], v[216:219]
  ds_read_b128 a[12:15], v239 offset:9216
  v_exp_f32 v26, v26
  v_exp_f32 v27, v27
  v_mul_f32 v75, v75, v4
  v_mul_f32 v76, v76, v4
  v_mul_f32 v77, v77, v4
  v_mul_f32 v78, v78, v4
  v_mfma_f32_16x16x32_bf16 v[16:19], a[0:3], a[92:95], v[220:223]
  ds_read_b128 a[24:27], v239 offset:45056
  v_exp_f32 v28, v28
  v_exp_f32 v29, v29
  v_exp_f32 v30, v30
  v_mul_f32 v79, v79, v4
  v_cvt_pk_bf16_f32 v72, v72, v73
  v_cvt_pk_bf16_f32 v73, v74, v75
  v_cvt_pk_bf16_f32 v74, v76, v77
  v_mfma_f32_16x16x32_bf16 v[20:23], a[4:7], a[92:95], v[220:223]
  ds_read_b128 a[28:31], v239 offset:46080
  v_exp_f32 v31, v31
  v_exp_f32 v32, v32
  v_cvt_pk_bf16_f32 v75, v78, v79
  buffer_store_dwordx4 v[72:75], v1, s[84:87], s90 offen offset:2048 sc1
  v_mul_f32 v84, v84, v5
  v_mul_f32 v85, v85, v5
  v_mfma_f32_16x16x32_bf16 v[136:139], a[16:19], v[56:59], v[136:139]
  v_exp_f32 v33, v33
  v_exp_f32 v34, v34
  v_exp_f32 v35, v35
  v_mul_f32 v86, v86, v5
  v_mul_f32 v87, v87, v5
  v_mul_f32 v88, v88, v5
  v_mul_f32 v89, v89, v5
  v_mfma_f32_16x16x32_bf16 v[140:143], a[20:23], v[56:59], v[140:143]
  v_exp_f32 v36, v36
  v_exp_f32 v37, v37
  v_mul_f32 v90, v90, v5
  v_mul_f32 v91, v91, v5
  v_cvt_pk_bf16_f32 v84, v84, v85
  v_cvt_pk_bf16_f32 v85, v86, v87
  v_mfma_f32_16x16x32_bf16 v[144:147], a[32:35], v[56:59], v[144:147]
  v_exp_f32 v38, v38
  v_exp_f32 v39, v39
  v_cvt_pk_bf16_f32 v86, v88, v89
  v_cvt_pk_bf16_f32 v87, v90, v91
  buffer_store_dwordx4 v[84:87], v1, s[84:87], s90 offen offset:3072 sc1
  v_add_f32 v128, v100, v216
  v_mfma_f32_16x16x32_bf16 v[148:151], a[16:19], v[60:63], v[148:151]
  v_cvt_pk_bf16_f32 v64, v24, v25
  v_cvt_pk_bf16_f32 v65, v26, v27
  v_cvt_pk_bf16_f32 v66, v28, v29
  v_add_f32 v129, v101, v217
  v_add_f32 v130, v102, v218
  v_add_f32 v131, v103, v219
  v_add_f32 v132, v100, v220
  v_mfma_f32_16x16x32_bf16 v[152:155], a[20:23], v[60:63], v[152:155]
  v_cvt_pk_bf16_f32 v67, v30, v31
  v_cvt_pk_bf16_f32 v68, v32, v33
  v_add_f32 v133, v101, v221
  v_add_f32 v134, v102, v222
  v_add_f32 v135, v103, v223
  v_max3_f32 v236, v40, v41, v42
  v_mfma_f32_16x16x32_bf16 v[156:159], a[32:35], v[60:63], v[156:159]
  v_cvt_pk_bf16_f32 v69, v34, v35
  v_cvt_pk_bf16_f32 v70, v36, v37
  v_cvt_pk_bf16_f32 v71, v38, v39
  v_max3_f32 v237, v48, v49, v50
  v_max_f32 v236, v236, v43
  v_max3_f32 v237, v237, v51, v52
  v_max3_f32 v237, v237, v53, v54
  v_max_f32 v237, v237, v55
  s_cmp_eq_u32 s92, 4
  s_cbranch_scc1 AT_inv16
AT_inv16_ret:
  s_waitcnt lgkmcnt(0)
  v_mfma_f32_16x16x32_bf16 v[24:27], a[8:11], a[88:91], v[128:131]
  ds_read_b128 a[16:19], v239 offset:43008
  v_exp_f32 v8, v8
  v_exp_f32 v9, v9
  v_mov_b32 v4, v236
  v_mov_b32 v5, v237
  s_nop 0
  v_permlane16_swap_b32 v236, v4
  v_permlane16_swap_b32 v237, v5
  v_mfma_f32_16x16x32_bf16 v[28:31], a[12:15], a[88:91], v[216:219]
  ds_read_b128 a[20:23], v239 offset:44032
  v_exp_f32 v10, v10
  v_exp_f32 v11, v11
  v_exp_f32 v12, v12
  v_max_f32 v236, v236, v4
  v_max_f32 v237, v237, v5
  v_mov_b32 v4, v236
  v_mov_b32 v5, v237
  s_nop 0
  v_permlane32_swap_b32 v236, v4
  v_permlane32_swap_b32 v237, v5
  v_mfma_f32_16x16x32_bf16 v[36:39], a[12:15], a[92:95], v[132:135]
  v_exp_f32 v13, v13
  v_exp_f32 v14, v14
  v_exp_f32 v15, v15
  v_max_f32 v236, v236, v4
  v_max_f32 v237, v237, v5
  v_sub_f32 v40, v40, v236
  v_mfma_f32_16x16x32_bf16 v[136:139], a[24:27], v[64:67], v[136:139]
  v_exp_f32 v16, v16
  v_exp_f32 v17, v17
  v_sub_f32 v41, v41, v236
  v_sub_f32 v42, v42, v236
  v_mfma_f32_16x16x32_bf16 v[140:143], a[28:31], v[64:67], v[140:143]
  v_exp_f32 v18, v18
  v_exp_f32 v19, v19
  v_exp_f32 v20, v20
  v_sub_f32 v43, v43, v236
  v_mfma_f32_16x16x32_bf16 v[144:147], a[32:35], v[64:67], v[144:147]
  v_exp_f32 v21, v21
  v_exp_f32 v22, v22
  v_exp_f32 v23, v23
  v_sub_f32 v48, v48, v237
  v_sub_f32 v49, v49, v237
  v_mfma_f32_16x16x32_bf16 v[148:151], a[24:27], v[68:71], v[148:151]
  v_cvt_pk_bf16_f32 v56, v8, v9
  v_cvt_pk_bf16_f32 v57, v10, v11
  v_sub_f32 v50, v50, v237
  v_sub_f32 v51, v51, v237
  v_mfma_f32_16x16x32_bf16 v[152:155], a[28:31], v[68:71], v[152:155]
  v_cvt_pk_bf16_f32 v58, v12, v13
  v_cvt_pk_bf16_f32 v59, v14, v15
  v_cvt_pk_bf16_f32 v60, v16, v17
  v_sub_f32 v52, v52, v237
  v_sub_f32 v53, v53, v237
  v_mfma_f32_16x16x32_bf16 v[156:159], a[32:35], v[68:71], v[156:159]
  v_cvt_pk_bf16_f32 v61, v18, v19
  v_cvt_pk_bf16_f32 v62, v20, v21
  v_cvt_pk_bf16_f32 v63, v22, v23
  v_sub_f32 v54, v54, v237
  v_sub_f32 v55, v55, v237
  s_waitcnt lgkmcnt(0)
  s_nop 0
  v_mfma_f32_16x16x32_bf16 v[136:139], a[16:19], v[56:59], v[136:139]
  ds_read_b128 a[8:11], v238 offset:14336
  v_exp_f32 v24, v24
  v_exp_f32 v25, v25
  v_exp_f32 v26, v26
  v_sub_f32 v104, 0, v236
  v_mfma_f32_16x16x32_bf16 v[140:143], a[20:23], v[56:59], v[140:143]
  ds_read_b128 a[12:15], v238 offset:15360
  v_exp_f32 v27, v27
  v_exp_f32 v28, v28
  v_exp_f32 v29, v29
  v_sub_f32 v105, 0, v236
  v_mfma_f32_16x16x32_bf16 v[144:147], a[32:35], v[56:59], v[144:147]
  ds_read_b128 a[24:27], v239 offset:40960
  v_exp_f32 v30, v30
  v_exp_f32 v31, v31
  v_exp_f32 v36, v36
  v_exp_f32 v37, v37
  v_sub_f32 v106, 0, v236
  v_sub_f32 v107, 0, v236
  v_mfma_f32_16x16x32_bf16 v[148:151], a[16:19], v[60:63], v[148:151]
  ds_read_b128 a[28:31], v239 offset:41984
  v_exp_f32 v38, v38
  v_exp_f32 v39, v39
  v_cvt_pk_bf16_f32 v64, v24, v25
  v_sub_f32 v108, 0, v237
  v_mfma_f32_16x16x32_bf16 v[152:155], a[20:23], v[60:63], v[152:155]
  v_cvt_pk_bf16_f32 v65, v26, v27
  v_cvt_pk_bf16_f32 v66, v28, v29
  v_cvt_pk_bf16_f32 v67, v30, v31
  v_sub_f32 v109, 0, v237
  v_mfma_f32_16x16x32_bf16 v[156:159], a[32:35], v[60:63], v[156:159]
  v_mov_b32 v68, 0
  v_mov_b32 v69, 0
  v_cvt_pk_bf16_f32 v70, v36, v37
  v_cvt_pk_bf16_f32 v71, v38, v39
  v_sub_f32 v110, 0, v237
  v_sub_f32 v111, 0, v237
  s_cmp_eq_u32 s92, 1
  s_cbranch_scc1 AT_inv18
AT_inv18_ret:
  s_waitcnt lgkmcnt(0)
  v_mfma_f32_16x16x32_bf16 v[24:27], a[8:11], a[64:67], v[104:107]
  ds_read_b128 a[0:3], v238 offset:12288
  v_exp_f32 v40, v40
  v_exp_f32 v41, v41
  v_mfma_f32_16x16x32_bf16 v[28:31], a[12:15], a[64:67], v[104:107]
  ds_read_b128 a[4:7], v238 offset:13312
  v_exp_f32 v42, v42
  v_exp_f32 v43, v43
  v_mfma_f32_16x16x32_bf16 v[32:35], a[8:11], a[68:71], v[108:111]
  ds_read_b128 a[16:19], v238 offset:49152
  v_exp_f32 v48, v48
  v_exp_f32 v49, v49
  v_mfma_f32_16x16x32_bf16 v[36:39], a[12:15], a[68:71], v[108:111]
  ds_read_b128 a[20:23], v238 offset:50176
  v_exp_f32 v50, v50
  v_exp_f32 v51, v51
  v_mfma_f32_16x16x32_bf16 v[136:139], a[24:27], v[64:67], v[136:139]
  v_exp_f32 v52, v52
  v_exp_f32 v53, v53
  v_mfma_f32_16x16x32_bf16 v[140:143], a[28:31], v[64:67], v[140:143]
  v_exp_f32 v54, v54
  v_exp_f32 v55, v55
  v_mfma_f32_16x16x32_bf16 v[144:147], a[32:35], v[64:67], v[144:147]
  v_cvt_pk_bf16_f32 v56, v40, v41
  v_cvt_pk_bf16_f32 v57, v42, v43
  v_mfma_f32_16x16x32_bf16 v[148:151], a[24:27], v[68:71], v[148:151]
  v_mov_b32 v58, 0
  v_mov_b32 v59, 0
  v_mfma_f32_16x16x32_bf16 v[152:155], a[28:31], v[68:71], v[152:155]
  v_cvt_pk_bf16_f32 v60, v48, v49
  v_cvt_pk_bf16_f32 v61, v50, v51
  v_mfma_f32_16x16x32_bf16 v[156:159], a[32:35], v[68:71], v[156:159]
  v_cvt_pk_bf16_f32 v62, v52, v53
  v_cvt_pk_bf16_f32 v63, v54, v55
  s_cmp_eq_u32 s92, 2
  s_cbranch_scc1 AT_inv19
AT_inv19_ret:
  s_waitcnt lgkmcnt(0)
  v_mfma_f32_16x16x32_bf16 v[8:11], a[0:3], a[64:67], v[104:107]
  ds_read_b128 a[8:11], v238 offset:10240
  v_exp_f32 v24, v24
  v_exp_f32 v25, v25
  s_nop 1
  v_rcp_f32 v4, v144
  v_rcp_f32 v5, v156
  v_max_f32 v7, v144, v156
  v_cmp_ngt_f32 vcc, s18, v7
  s_nop 1
  s_cmp_lg_u64 vcc, 0
  s_cselect_b32 s95, 1, s95
  v_mul_f32 v136, v136, v4
  v_mfma_f32_16x16x32_bf16 v[12:15], a[4:7], a[64:67], v[104:107]
  ds_read_b128 a[12:15], v238 offset:11264
  v_exp_f32 v26, v26
  v_exp_f32 v27, v27
  v_mul_f32 v137, v137, v4
  v_mul_f32 v138, v138, v4
  v_mul_f32 v139, v139, v4
  v_mfma_f32_16x16x32_bf16 v[16:19], a[0:3], a[68:71], v[108:111]
  ds_read_b128 a[24:27], v238 offset:47104
  v_exp_f32 v28, v28
  v_exp_f32 v29, v29
  v_exp_f32 v30, v30
  v_mul_f32 v140, v140, v4
  v_mul_f32 v141, v141, v4
  v_mul_f32 v142, v142, v4
  v_mfma_f32_16x16x32_bf16 v[20:23], a[4:7], a[68:71], v[108:111]
  ds_read_b128 a[28:31], v238 offset:48128
  v_exp_f32 v31, v31
  v_exp_f32 v32, v32
  v_mul_f32 v143, v143, v4
  v_cvt_pk_bf16_f32 v136, v136, v137
  v_mfma_f32_16x16x32_bf16 v[72:75], a[16:19], v[56:59], 0
  v_exp_f32 v33, v33
  v_exp_f32 v34, v34
  v_exp_f32 v35, v35
  v_cvt_pk_bf16_f32 v137, v138, v139
  v_cvt_pk_bf16_f32 v138, v140, v141
  v_cvt_pk_bf16_f32 v139, v142, v143
  v_mfma_f32_16x16x32_bf16 v[76:79], a[20:23], v[56:59], 0
  v_exp_f32 v36, v36
  v_exp_f32 v37, v37
  buffer_store_dwordx4 v[136:139], v1, s[84:87], s91 offen offset:2048 sc1
  v_mul_f32 v148, v148, v5
  v_mul_f32 v149, v149, v5
  v_mfma_f32_16x16x32_bf16 v[80:83], a[32:35], v[56:59], 0
  v_exp_f32 v38, v38
  v_exp_f32 v39, v39
  v_mul_f32 v150, v150, v5
  v_mul_f32 v151, v151, v5
  v_mfma_f32_16x16x32_bf16 v[84:87], a[16:19], v[60:63], 0
  v_cvt_pk_bf16_f32 v64, v24, v25
  v_cvt_pk_bf16_f32 v65, v26, v27
  v_cvt_pk_bf16_f32 v66, v28, v29
  v_mul_f32 v152, v152, v5
  v_mul_f32 v153, v153, v5
  v_mul_f32 v154, v154, v5
  v_mfma_f32_16x16x32_bf16 v[88:91], a[20:23], v[60:63], 0
  v_cvt_pk_bf16_f32 v67, v30, v31
  v_cvt_pk_bf16_f32 v68, v32, v33
  v_mul_f32 v155, v155, v5
  v_cvt_pk_bf16_f32 v148, v148, v149
  v_cvt_pk_bf16_f32 v149, v150, v151
  v_mfma_f32_16x16x32_bf16 v[92:95], a[32:35], v[60:63], 0
  v_cvt_pk_bf16_f32 v69, v34, v35
  v_cvt_pk_bf16_f32 v70, v36, v37
  v_cvt_pk_bf16_f32 v71, v38, v39
  v_cvt_pk_bf16_f32 v150, v152, v153
  v_cvt_pk_bf16_f32 v151, v154, v155
  buffer_store_dwordx4 v[148:151], v1, s[84:87], s91 offen offset:3072 sc1
  s_cmp_eq_u32 s92, 3
  s_cbranch_scc1 AT_inv20
AT_inv20_ret:
  s_waitcnt lgkmcnt(0)
  v_mfma_f32_16x16x32_bf16 v[24:27], a[8:11], a[64:67], v[104:107]
  ds_read_b128 a[0:3], v238 offset:8192
  v_exp_f32 v8, v8
  v_exp_f32 v9, v9
  v_mfma_f32_16x16x32_bf16 v[28:31], a[12:15], a[64:67], v[104:107]
  ds_read_b128 a[4:7], v238 offset:9216
  v_exp_f32 v10, v10
  v_exp_f32 v11, v11
  v_mfma_f32_16x16x32_bf16 v[32:35], a[8:11], a[68:71], v[108:111]
  ds_read_b128 a[16:19], v238 offset:45056
  v_exp_f32 v12, v12
  v_exp_f32 v13, v13
  v_exp_f32 v14, v14
  v_mfma_f32_16x16x32_bf16 v[36:39], a[12:15], a[68:71], v[108:111]
  ds_read_b128 a[20:23], v238 offset:46080
  v_exp_f32 v15, v15
  v_exp_f32 v16, v16
  v_mfma_f32_16x16x32_bf16 v[72:75], a[24:27], v[64:67], v[72:75]
  v_exp_f32 v17, v17
  v_exp_f32 v18, v18
  v_exp_f32 v19, v19
  v_mfma_f32_16x16x32_bf16 v[76:79], a[28:31], v[64:67], v[76:79]
  v_exp_f32 v20, v20
  v_exp_f32 v21, v21
  v_mfma_f32_16x16x32_bf16 v[80:83], a[32:35], v[64:67], v[80:83]
  v_exp_f32 v22, v22
  v_exp_f32 v23, v23
  v_mfma_f32_16x16x32_bf16 v[84:87], a[24:27], v[68:71], v[84:87]
  v_cvt_pk_bf16_f32 v56, v8, v9
  v_cvt_pk_bf16_f32 v57, v10, v11
  v_cvt_pk_bf16_f32 v58, v12, v13
  v_mfma_f32_16x16x32_bf16 v[88:91], a[28:31], v[68:71], v[88:91]
  v_cvt_pk_bf16_f32 v59, v14, v15
  v_cvt_pk_bf16_f32 v60, v16, v17
  v_mfma_f32_16x16x32_bf16 v[92:95], a[32:35], v[68:71], v[92:95]
  v_cvt_pk_bf16_f32 v61, v18, v19
  v_cvt_pk_bf16_f32 v62, v20, v21
  v_cvt_pk_bf16_f32 v63, v22, v23
  s_cmp_eq_u32 s92, 4
  s_cbranch_scc1 AT_inv21
AT_inv21_ret:
  s_waitcnt lgkmcnt(0)
  v_mfma_f32_16x16x32_bf16 v[8:11], a[0:3], a[64:67], v[104:107]
  ds_read_b128 a[8:11], v238 offset:6144
  v_exp_f32 v24, v24
  v_exp_f32 v25, v25
  v_mfma_f32_16x16x32_bf16 v[12:15], a[4:7], a[64:67], v[104:107]
  ds_read_b128 a[12:15], v238 offset:7168
  v_exp_f32 v26, v26
  v_exp_f32 v27, v27
  v_mfma_f32_16x16x32_bf16 v[16:19], a[0:3], a[68:71], v[108:111]
  ds_read_b128 a[24:27], v238 offset:43008
  v_exp_f32 v28, v28
  v_exp_f32 v29, v29
  v_exp_f32 v30, v30
  v_mfma_f32_16x16x32_bf16 v[20:23], a[4:7], a[68:71], v[108:111]
  ds_read_b128 a[28:31], v238 offset:44032
  v_exp_f32 v31, v31
  v_exp_f32 v32, v32
  v_mfma_f32_16x16x32_bf16 v[72:75], a[16:19], v[56:59], v[72:75]
  v_exp_f32 v33, v33
  v_exp_f32 v34, v34
  v_exp_f32 v35, v35
  v_mfma_f32_16x16x32_bf16 v[76:79], a[20:23], v[56:59], v[76:79]
  v_exp_f32 v36, v36
  v_exp_f32 v37, v37
  v_mfma_f32_16x16x32_bf16 v[80:83], a[32:35], v[56:59], v[80:83]
  v_exp_f32 v38, v38
  v_exp_f32 v39, v39
  v_mfma_f32_16x16x32_bf16 v[84:87], a[16:19], v[60:63], v[84:87]
  v_cvt_pk_bf16_f32 v64, v24, v25
  v_cvt_pk_bf16_f32 v65, v26, v27
  v_cvt_pk_bf16_f32 v66, v28, v29
  v_mfma_f32_16x16x32_bf16 v[88:91], a[20:23], v[60:63], v[88:91]
  v_cvt_pk_bf16_f32 v67, v30, v31
  v_cvt_pk_bf16_f32 v68, v32, v33
  v_mfma_f32_16x16x32_bf16 v[92:95], a[32:35], v[60:63], v[92:95]
  v_cvt_pk_bf16_f32 v69, v34, v35
  v_cvt_pk_bf16_f32 v70, v36, v37
  v_cvt_pk_bf16_f32 v71, v38, v39
  s_cmp_eq_u32 s92, 5
  s_cbranch_scc1 AT_inv22
AT_inv22_ret:
  s_waitcnt lgkmcnt(0)
  v_mfma_f32_16x16x32_bf16 v[24:27], a[8:11], a[64:67], v[104:107]
  ds_read_b128 a[0:3], v238 offset:4096
  v_exp_f32 v8, v8
  v_exp_f32 v9, v9
  v_mfma_f32_16x16x32_bf16 v[28:31], a[12:15], a[64:67], v[104:107]
  ds_read_b128 a[4:7], v238 offset:5120
  v_exp_f32 v10, v10
  v_exp_f32 v11, v11
  v_mfma_f32_16x16x32_bf16 v[32:35], a[8:11], a[68:71], v[108:111]
  ds_read_b128 a[16:19], v238 offset:40960
  v_exp_f32 v12, v12
  v_exp_f32 v13, v13
  v_exp_f32 v14, v14
  v_mfma_f32_16x16x32_bf16 v[36:39], a[12:15], a[68:71], v[108:111]
  ds_read_b128 a[20:23], v238 offset:41984
  v_exp_f32 v15, v15
  v_exp_f32 v16, v16
  v_mfma_f32_16x16x32_bf16 v[72:75], a[24:27], v[64:67], v[72:75]
  ds_read_b128 a[36:39], v239 offset:16384
  v_exp_f32 v17, v17
  v_exp_f32 v18, v18
  v_exp_f32 v19, v19
  v_mfma_f32_16x16x32_bf16 v[76:79], a[28:31], v[64:67], v[76:79]
  ds_read_b128 a[40:43], v239 offset:17408
  v_exp_f32 v20, v20
  v_exp_f32 v21, v21
  v_mfma_f32_16x16x32_bf16 v[80:83], a[32:35], v[64:67], v[80:83]
  v_exp_f32 v22, v22
  v_exp_f32 v23, v23
  v_mfma_f32_16x16x32_bf16 v[84:87], a[24:27], v[68:71], v[84:87]
  v_cvt_pk_bf16_f32 v56, v8, v9
  v_cvt_pk_bf16_f32 v57, v10, v11
  v_cvt_pk_bf16_f32 v58, v12, v13
  v_mfma_f32_16x16x32_bf16 v[88:91], a[28:31], v[68:71], v[88:91]
  v_cvt_pk_bf16_f32 v59, v14, v15
  v_cvt_pk_bf16_f32 v60, v16, v17
  v_mfma_f32_16x16x32_bf16 v[92:95], a[32:35], v[68:71], v[92:95]
  v_cvt_pk_bf16_f32 v61, v18, v19
  v_cvt_pk_bf16_f32 v62, v20, v21
  v_cvt_pk_bf16_f32 v63, v22, v23
  s_cmp_eq_u32 s92, 6
  s_cbranch_scc1 AT_inv23
AT_inv23_ret:
  s_waitcnt lgkmcnt(0)
  v_mfma_f32_16x16x32_bf16 v[8:11], a[0:3], a[64:67], v[104:107]
  ds_read_b128 a[8:11], v238 offset:2048
  v_exp_f32 v24, v24
  v_mfma_f32_16x16x32_bf16 v[12:15], a[4:7], a[64:67], v[104:107]
  ds_read_b128 a[12:15], v238 offset:3072
  v_exp_f32 v25, v25
  v_exp_f32 v26, v26
  v_mfma_f32_16x16x32_bf16 v[16:19], a[0:3], a[68:71], v[108:111]
  ds_read_b128 a[24:27], v238 offset:38912
  v_exp_f32 v27, v27
  v_exp_f32 v28, v28
  v_mfma_f32_16x16x32_bf16 v[20:23], a[4:7], a[68:71], v[108:111]
  ds_read_b128 a[28:31], v238 offset:39936
  v_exp_f32 v29, v29
  v_exp_f32 v30, v30
  v_mfma_f32_16x16x32_bf16 v[40:43], a[36:39], a[80:83], v[96:99]
  v_exp_f32 v31, v31
  v_exp_f32 v32, v32
  v_mfma_f32_16x16x32_bf16 v[48:51], a[36:39], a[84:87], 0
  v_exp_f32 v33, v33
  v_exp_f32 v34, v34
  v_mfma_f32_16x16x32_bf16 v[52:55], a[40:43], a[84:87], v[96:99]
  v_exp_f32 v35, v35
  v_mfma_f32_16x16x32_bf16 v[72:75], a[16:19], v[56:59], v[72:75]
  v_exp_f32 v36, v36
  v_exp_f32 v37, v37
  v_mfma_f32_16x16x32_bf16 v[76:79], a[20:23], v[56:59], v[76:79]
  v_exp_f32 v38, v38
  v_exp_f32 v39, v39
  v_mfma_f32_16x16x32_bf16 v[80:83], a[32:35], v[56:59], v[80:83]
  v_cvt_pk_bf16_f32 v64, v24, v25
  v_cvt_pk_bf16_f32 v65, v26, v27
  v_mfma_f32_16x16x32_bf16 v[84:87], a[16:19], v[60:63], v[84:87]
  v_cvt_pk_bf16_f32 v66, v28, v29
  v_cvt_pk_bf16_f32 v67, v30, v31
  v_mfma_f32_16x16x32_bf16 v[88:91], a[20:23], v[60:63], v[88:91]
  v_cvt_pk_bf16_f32 v68, v32, v33
  v_cvt_pk_bf16_f32 v69, v34, v35
  v_mfma_f32_16x16x32_bf16 v[92:95], a[32:35], v[60:63], v[92:95]
  v_cvt_pk_bf16_f32 v70, v36, v37
  v_cvt_pk_bf16_f32 v71, v38, v39
  s_cmp_eq_u32 s92, 7
  s_cbranch_scc1 AT_inv24
AT_inv24_ret:
  s_waitcnt lgkmcnt(0)
  v_mfma_f32_16x16x32_bf16 v[24:27], a[8:11], a[64:67], v[104:107]
  ds_read_b128 a[0:3], v238 offset:0
  v_exp_f32 v8, v8
  v_exp_f32 v9, v9
  v_add_f32 v128, v100, v104
  v_mfma_f32_16x16x32_bf16 v[28:31], a[12:15], a[64:67], v[104:107]
  ds_read_b128 a[4:7], v238 offset:1024
  v_exp_f32 v10, v10
  v_exp_f32 v11, v11
  v_add_f32 v129, v101, v105
  v_mfma_f32_16x16x32_bf16 v[32:35], a[8:11], a[68:71], v[108:111]
  ds_read_b128 a[16:19], v238 offset:36864
  v_exp_f32 v12, v12
  v_exp_f32 v13, v13
  v_exp_f32 v14, v14
  v_add_f32 v130, v102, v106
  v_add_f32 v131, v103, v107
  v_mfma_f32_16x16x32_bf16 v[36:39], a[12:15], a[68:71], v[108:111]
  ds_read_b128 a[20:23], v238 offset:37888
  v_exp_f32 v15, v15
  v_exp_f32 v16, v16
  v_add_f32 v132, v100, v108
  v_mfma_f32_16x16x32_bf16 v[72:75], a[24:27], v[64:67], v[72:75]
  v_exp_f32 v17, v17
  v_exp_f32 v18, v18
  v_exp_f32 v19, v19
  v_add_f32 v133, v101, v109
  v_add_f32 v134, v102, v110
  v_mfma_f32_16x16x32_bf16 v[76:79], a[28:31], v[64:67], v[76:79]
  v_exp_f32 v20, v20
  v_exp_f32 v21, v21
  v_add_f32 v135, v103, v111
  v_mfma_f32_16x16x32_bf16 v[80:83], a[32:35], v[64:67], v[80:83]
  v_exp_f32 v22, v22
  v_exp_f32 v23, v23
  v_max3_f32 v236, v40, v41, v42
  v_mfma_f32_16x16x32_bf16 v[84:87], a[24:27], v[68:71], v[84:87]
  v_cvt_pk_bf16_f32 v56, v8, v9
  v_cvt_pk_bf16_f32 v57, v10, v11
  v_cvt_pk_bf16_f32 v58, v12, v13
  v_max3_f32 v237, v48, v49, v50
  v_max_f32 v236, v236, v43
  v_mfma_f32_16x16x32_bf16 v[88:91], a[28:31], v[68:71], v[88:91]
  v_cvt_pk_bf16_f32 v59, v14, v15
  v_cvt_pk_bf16_f32 v60, v16, v17
  v_max3_f32 v237, v237, v51, v52
  v_mfma_f32_16x16x32_bf16 v[92:95], a[32:35], v[68:71], v[92:95]
  v_cvt_pk_bf16_f32 v61, v18, v19
  v_cvt_pk_bf16_f32 v62, v20, v21
  v_cvt_pk_bf16_f32 v63, v22, v23
  v_max3_f32 v237, v237, v53, v54
  v_max_f32 v237, v237, v55
  s_cmp_eq_u32 s92, 8
  s_cbranch_scc1 AT_inv25
AT_inv25_ret:
  s_waitcnt lgkmcnt(0)
  v_mfma_f32_16x16x32_bf16 v[8:11], a[0:3], a[64:67], v[128:131]
  ds_read_b128 a[24:27], v238 offset:34816
  v_exp_f32 v24, v24
  v_exp_f32 v25, v25
  v_mov_b32 v4, v236
  v_mov_b32 v5, v237
  s_nop 0
  v_permlane16_swap_b32 v236, v4
  v_permlane16_swap_b32 v237, v5
  v_mfma_f32_16x16x32_bf16 v[12:15], a[4:7], a[64:67], v[104:107]
  ds_read_b128 a[28:31], v238 offset:35840
  v_exp_f32 v26, v26
  v_exp_f32 v27, v27
  v_exp_f32 v28, v28
  v_max_f32 v236, v236, v4
  v_max_f32 v237, v237, v5
  v_mov_b32 v4, v236
  v_mov_b32 v5, v237
  s_nop 0
  v_permlane32_swap_b32 v236, v4
  v_permlane32_swap_b32 v237, v5
  v_mfma_f32_16x16x32_bf16 v[20:23], a[4:7], a[68:71], v[132:135]
  v_exp_f32 v29, v29
  v_exp_f32 v30, v30
  v_exp_f32 v31, v31
  v_max_f32 v236, v236, v4
  v_max_f32 v237, v237, v5
  v_sub_f32 v40, v40, v236
  v_mfma_f32_16x16x32_bf16 v[72:75], a[16:19], v[56:59], v[72:75]
  v_exp_f32 v32, v32
  v_exp_f32 v33, v33
  v_sub_f32 v41, v41, v236
  v_sub_f32 v42, v42, v236
  v_mfma_f32_16x16x32_bf16 v[76:79], a[20:23], v[56:59], v[76:79]
  v_exp_f32 v34, v34
  v_exp_f32 v35, v35
  v_exp_f32 v36, v36
  v_sub_f32 v43, v43, v236
  v_mfma_f32_16x16x32_bf16 v[80:83], a[32:35], v[56:59], v[80:83]
  v_exp_f32 v37, v37
  v_exp_f32 v38, v38
  v_exp_f32 v39, v39
  v_sub_f32 v48, v48, v237
  v_sub_f32 v49, v49, v237
  v_mfma_f32_16x16x32_bf16 v[84:87], a[16:19], v[60:63], v[84:87]
  v_cvt_pk_bf16_f32 v64, v24, v25
  v_cvt_pk_bf16_f32 v65, v26, v27
  v_sub_f32 v50, v50, v237
  v_sub_f32 v51, v51, v237
  v_mfma_f32_16x16x32_bf16 v[88:91], a[20:23], v[60:63], v[88:91]
  v_cvt_pk_bf16_f32 v66, v28, v29
  v_cvt_pk_bf16_f32 v67, v30, v31
  v_cvt_pk_bf16_f32 v68, v32, v33
  v_sub_f32 v52, v52, v237
  v_sub_f32 v53, v53, v237
  v_mfma_f32_16x16x32_bf16 v[92:95], a[32:35], v[60:63], v[92:95]
  v_cvt_pk_bf16_f32 v69, v34, v35
  v_cvt_pk_bf16_f32 v70, v36, v37
  v_cvt_pk_bf16_f32 v71, v38, v39
  v_sub_f32 v54, v54, v237
  v_sub_f32 v55, v55, v237
  s_waitcnt lgkmcnt(0)
  s_nop 0
  v_mfma_f32_16x16x32_bf16 v[72:75], a[24:27], v[64:67], v[72:75]
  ds_read_b128 a[0:3], v239 offset:14336
  v_exp_f32 v8, v8
  v_exp_f32 v9, v9
  v_exp_f32 v10, v10
  v_sub_f32 v216, 0, v236
  v_mfma_f32_16x16x32_bf16 v[76:79], a[28:31], v[64:67], v[76:79]
  ds_read_b128 a[4:7], v239 offset:15360
  v_exp_f32 v11, v11
  v_exp_f32 v12, v12
  v_exp_f32 v13, v13
  v_sub_f32 v217, 0, v236
  v_mfma_f32_16x16x32_bf16 v[80:83], a[32:35], v[64:67], v[80:83]
  ds_read_b128 a[16:19], v238 offset:32768
  v_exp_f32 v14, v14
  v_exp_f32 v15, v15
  v_exp_f32 v20, v20
  v_exp_f32 v21, v21
  v_sub_f32 v218, 0, v236
  v_sub_f32 v219, 0, v236
  v_mfma_f32_16x16x32_bf16 v[84:87], a[24:27], v[68:71], v[84:87]
  ds_read_b128 a[20:23], v238 offset:33792
  v_exp_f32 v22, v22
  v_exp_f32 v23, v23
  v_cvt_pk_bf16_f32 v56, v8, v9
  v_sub_f32 v220, 0, v237
  v_mfma_f32_16x16x32_bf16 v[88:91], a[28:31], v[68:71], v[88:91]
  v_cvt_pk_bf16_f32 v57, v10, v11
  v_cvt_pk_bf16_f32 v58, v12, v13
  v_cvt_pk_bf16_f32 v59, v14, v15
  v_sub_f32 v221, 0, v237
  v_mfma_f32_16x16x32_bf16 v[92:95], a[32:35], v[68:71], v[92:95]
  v_mov_b32 v60, 0
  v_mov_b32 v61, 0
  v_cvt_pk_bf16_f32 v62, v20, v21
  v_cvt_pk_bf16_f32 v63, v22, v23
  v_sub_f32 v222, 0, v237
  v_sub_f32 v223, 0, v237
  s_cmp_eq_u32 s92, 1
  s_cbranch_scc1 AT_inv27
AT_inv27_ret:
  buffer_load_dword v231, v232, s[84:87], s76 offen sc1
  s_waitcnt lgkmcnt(0)
  v_mfma_f32_16x16x32_bf16 v[8:11], a[0:3], a[80:83], v[216:219]
  ds_read_b128 a[8:11], v239 offset:12288
  v_exp_f32 v40, v40
  v_exp_f32 v41, v41
  v_mfma_f32_16x16x32_bf16 v[12:15], a[4:7], a[80:83], v[216:219]
  ds_read_b128 a[12:15], v239 offset:13312
  v_exp_f32 v42, v42
  v_exp_f32 v43, v43
  v_mfma_f32_16x16x32_bf16 v[16:19], a[0:3], a[84:87], v[220:223]
  ds_read_b128 a[24:27], v239 offset:49152
  v_exp_f32 v48, v48
  v_exp_f32 v49, v49
  v_mfma_f32_16x16x32_bf16 v[20:23], a[4:7], a[84:87], v[220:223]
  ds_read_b128 a[28:31], v239 offset:50176
  v_exp_f32 v50, v50
  v_exp_f32 v51, v51
  v_mfma_f32_16x16x32_bf16 v[72:75], a[16:19], v[56:59], v[72:75]
  v_exp_f32 v52, v52
  v_exp_f32 v53, v53
  v_mfma_f32_16x16x32_bf16 v[76:79], a[20:23], v[56:59], v[76:79]
  v_exp_f32 v54, v54
  v_exp_f32 v55, v55
  v_mfma_f32_16x16x32_bf16 v[80:83], a[32:35], v[56:59], v[80:83]
  v_cvt_pk_bf16_f32 v64, v40, v41
  v_cvt_pk_bf16_f32 v65, v42, v43
  v_mfma_f32_16x16x32_bf16 v[84:87], a[16:19], v[60:63], v[84:87]
  v_mov_b32 v66, 0
  v_mov_b32 v67, 0
  v_mfma_f32_16x16x32_bf16 v[88:91], a[20:23], v[60:63], v[88:91]
  v_cvt_pk_bf16_f32 v68, v48, v49
  v_cvt_pk_bf16_f32 v69, v50, v51
  v_mfma_f32_16x16x32_bf16 v[92:95], a[32:35], v[60:63], v[92:95]
  v_cvt_pk_bf16_f32 v70, v52, v53
  v_cvt_pk_bf16_f32 v71, v54, v55
  s_cmp_eq_u32 s92, 2
  s_cbranch_scc1 AT_inv28
AT_inv28_ret:
  s_waitcnt lgkmcnt(0)
  s_barrier
  s_waitcnt lgkmcnt(0)
  v_mfma_f32_16x16x32_bf16 v[24:27], a[8:11], a[80:83], v[216:219]
  ds_read_b128 a[0:3], v239 offset:10240
  v_exp_f32 v8, v8
  v_exp_f32 v9, v9
  s_nop 1
  v_rcp_f32 v4, v80
  v_rcp_f32 v5, v92
  v_max_f32 v7, v80, v92
  v_cmp_ngt_f32 vcc, s18, v7
  s_nop 1
  s_cmp_lg_u64 vcc, 0
  s_cselect_b32 s95, 1, s95
  v_mul_f32 v72, v72, v4
  v_mfma_f32_16x16x32_bf16 v[28:31], a[12:15], a[80:83], v[216:219]
  ds_read_b128 a[4:7], v239 offset:11264
  v_exp_f32 v10, v10
  v_exp_f32 v11, v11
  v_mul_f32 v73, v73, v4
  v_mul_f32 v74, v74, v4
  v_mul_f32 v75, v75, v4
  v_mfma_f32_16x16x32_bf16 v[32:35], a[8:11], a[84:87], v[220:223]
  ds_read_b128 a[16:19], v239 offset:47104
  v_exp_f32 v12, v12
  v_exp_f32 v13, v13
  v_exp_f32 v14, v14
  v_mul_f32 v76, v76, v4
  v_mul_f32 v77, v77, v4
  v_mul_f32 v78, v78, v4
  v_mfma_f32_16x16x32_bf16 v[36:39], a[12:15], a[84:87], v[220:223]
  ds_read_b128 a[20:23], v239 offset:48128
  v_exp_f32 v15, v15
  v_exp_f32 v16, v16
  v_mul_f32 v79, v79, v4
  v_cvt_pk_bf16_f32 v72, v72, v73
  v_mfma_f32_16x16x32_bf16 v[136:139], a[24:27], v[64:67], 0
  v_exp_f32 v17, v17
  v_exp_f32 v18, v18
  v_exp_f32 v19, v19
  v_cvt_pk_bf16_f32 v73, v74, v75
  v_cvt_pk_bf16_f32 v74, v76, v77
  v_cvt_pk_bf16_f32 v75, v78, v79
  v_mfma_f32_16x16x32_bf16 v[140:143], a[28:31], v[64:67], 0
  v_exp_f32 v20, v20
  v_exp_f32 v21, v21
  buffer_store_dwordx4 v[72:75], v1, s[84:87], s90 offen offset:0 sc1
  v_mul_f32 v84, v84, v5
  v_mul_f32 v85, v85, v5
  v_mfma_f32_16x16x32_bf16 v[144:147], a[32:35], v[64:67], 0
  v_exp_f32 v22, v22
  v_exp_f32 v23, v23
  v_mul_f32 v86, v86, v5
  v_mul_f32 v87, v87, v5
  v_mfma_f32_16x16x32_bf16 v[148:151], a[24:27], v[68:71], 0
  v_cvt_pk_bf16_f32 v56, v8, v9
  v_cvt_pk_bf16_f32 v57, v10, v11
  v_cvt_pk_bf16_f32 v58, v12, v13
  v_mul_f32 v88, v88, v5
  v_mul_f32 v89, v89, v5
  v_mul_f32 v90, v90, v5
  v_mfma_f32_16x16x32_bf16 v[152:155], a[28:31], v[68:71], 0
  v_cvt_pk_bf16_f32 v59, v14, v15
  v_cvt_pk_bf16_f32 v60, v16, v17
  v_mul_f32 v91, v91, v5
  v_cvt_pk_bf16_f32 v84, v84, v85
  v_cvt_pk_bf16_f32 v85, v86, v87
  v_mfma_f32_16x16x32_bf16 v[156:159], a[32:35], v[68:71], 0
  v_cvt_pk_bf16_f32 v61, v18, v19
  v_cvt_pk_bf16_f32 v62, v20, v21
  v_cvt_pk_bf16_f32 v63, v22, v23
  v_cvt_pk_bf16_f32 v86, v88, v89
  v_cvt_pk_bf16_f32 v87, v90, v91
  buffer_store_dwordx4 v[84:87], v1, s[84:87], s90 offen offset:1024 sc1
  s_cmp_eq_u32 s92, 3
  s_cbranch_scc1 AT_inv29
AT_inv29_ret:
  s_waitcnt lgkmcnt(0)
  v_mfma_f32_16x16x32_bf16 v[8:11], a[0:3], a[80:83], v[216:219]
  ds_read_b128 a[8:11], v239 offset:8192
  v_exp_f32 v24, v24
  v_exp_f32 v25, v25
  v_mfma_f32_16x16x32_bf16 v[12:15], a[4:7], a[80:83], v[216:219]
  ds_read_b128 a[12:15], v239 offset:9216
  v_exp_f32 v26, v26
  v_exp_f32 v27, v27
  v_mfma_f32_16x16x32_bf16 v[16:19], a[0:3], a[84:87], v[220:223]
  ds_read_b128 a[24:27], v239 offset:45056
  v_exp_f32 v28, v28
  v_exp_f32 v29, v29
  v_exp_f32 v30, v30
  v_mfma_f32_16x16x32_bf16 v[20:23], a[4:7], a[84:87], v[220:223]
  ds_read_b128 a[28:31], v239 offset:46080
  v_exp_f32 v31, v31
  v_exp_f32 v32, v32
  s_add_u32 m0, s43, 0
  s_nop 0
  buffer_load_dwordx4 v228, s[20:23], s41 offen lds
  v_mfma_f32_16x16x32_bf16 v[136:139], a[16:19], v[56:59], v[136:139]
  v_exp_f32 v33, v33
  v_exp_f32 v34, v34
  v_exp_f32 v35, v35
  v_mfma_f32_16x16x32_bf16 v[140:143], a[20:23], v[56:59], v[140:143]
  v_exp_f32 v36, v36
  v_exp_f32 v37, v37
  v_mfma_f32_16x16x32_bf16 v[144:147], a[32:35], v[56:59], v[144:147]
  v_exp_f32 v38, v38
  v_exp_f32 v39, v39
  s_add_u32 m0, s43, 1024
  s_nop 0
  buffer_load_dwordx4 v229, s[20:23], s41 offen lds
  s_add_u32 s41, s41, 65536
  v_mfma_f32_16x16x32_bf16 v[148:151], a[16:19], v[60:63], v[148:151]
  v_cvt_pk_bf16_f32 v64, v24, v25
  v_cvt_pk_bf16_f32 v65, v26, v27
  v_cvt_pk_bf16_f32 v66, v28, v29
  v_mfma_f32_16x16x32_bf16 v[152:155], a[20:23], v[60:63], v[152:155]
  v_cvt_pk_bf16_f32 v67, v30, v31
  v_cvt_pk_bf16_f32 v68, v32, v33
  v_mfma_f32_16x16x32_bf16 v[156:159], a[32:35], v[60:63], v[156:159]
  v_cvt_pk_bf16_f32 v69, v34, v35
  v_cvt_pk_bf16_f32 v70, v36, v37
  v_cvt_pk_bf16_f32 v71, v38, v39
  s_add_u32 m0, s43, 8192
  s_nop 0
  buffer_load_dwordx4 v228, s[20:23], s41 offen lds
  s_cmp_eq_u32 s92, 4
  s_cbranch_scc1 AT_inv30
AT_inv30_ret:
  s_waitcnt vmcnt(5)
  v_cmp_ne_u32 vcc, s3, v231
  s_nop 1
  s_and_b64 vcc, vcc, 0xffff
  s_cbranch_scc1 G2_hspin
G2_hgo:
  s_waitcnt lgkmcnt(0)
  v_mfma_f32_16x16x32_bf16 v[24:27], a[8:11], a[80:83], v[216:219]
  ds_read_b128 a[0:3], v239 offset:6144
  v_exp_f32 v8, v8
  v_exp_f32 v9, v9
  v_mfma_f32_16x16x32_bf16 v[28:31], a[12:15], a[80:83], v[216:219]
  ds_read_b128 a[4:7], v239 offset:7168
  v_exp_f32 v10, v10
  v_exp_f32 v11, v11
  buffer_load_dwordx4 v[160:163], v233, s[24:27], s42 offen offset:0 sc1
  v_mfma_f32_16x16x32_bf16 v[32:35], a[8:11], a[84:87], v[220:223]
  ds_read_b128 a[16:19], v239 offset:43008
  v_exp_f32 v12, v12
  v_exp_f32 v13, v13
  v_exp_f32 v14, v14
  v_mfma_f32_16x16x32_bf16 v[36:39], a[12:15], a[84:87], v[220:223]
  ds_read_b128 a[20:23], v239 offset:44032
  v_exp_f32 v15, v15
  v_exp_f32 v16, v16
  buffer_load_dwordx4 v[164:167], v233, s[24:27], s42 offen offset:1024 sc1
  s_add_u32 s42, s42, 4096
  v_mfma_f32_16x16x32_bf16 v[136:139], a[24:27], v[64:67], v[136:139]
  v_exp_f32 v17, v17
  v_exp_f32 v18, v18
  v_exp_f32 v19, v19
  buffer_load_dwordx4 v[168:171], v233, s[24:27], s42 offen offset:0 sc1
  v_mfma_f32_16x16x32_bf16 v[140:143], a[28:31], v[64:67], v[140:143]
  v_exp_f32 v20, v20
  v_exp_f32 v21, v21
  v_mfma_f32_16x16x32_bf16 v[144:147], a[32:35], v[64:67], v[144:147]
  v_exp_f32 v22, v22
  v_exp_f32 v23, v23
  s_add_u32 m0, s43, 9216
  s_nop 0
  buffer_load_dwordx4 v229, s[20:23], s41 offen lds
  s_add_u32 s41, s41, s64
  v_mfma_f32_16x16x32_bf16 v[148:151], a[24:27], v[68:71], v[148:151]
  v_cvt_pk_bf16_f32 v56, v8, v9
  v_cvt_pk_bf16_f32 v57, v10, v11
  v_cvt_pk_bf16_f32 v58, v12, v13
  v_mfma_f32_16x16x32_bf16 v[152:155], a[28:31], v[68:71], v[152:155]
  v_cvt_pk_bf16_f32 v59, v14, v15
  v_cvt_pk_bf16_f32 v60, v16, v17
  s_add_u32 m0, s43, 16384
  s_nop 0
  buffer_load_dwordx4 v228, s[20:23], s41 offen lds
  v_mfma_f32_16x16x32_bf16 v[156:159], a[32:35], v[68:71], v[156:159]
  v_cvt_pk_bf16_f32 v61, v18, v19
  v_cvt_pk_bf16_f32 v62, v20, v21
  v_cvt_pk_bf16_f32 v63, v22, v23
  s_add_u32 m0, s43, 17408
  s_nop 0
  buffer_load_dwordx4 v229, s[20:23], s41 offen lds
  s_add_u32 s41, s41, 65536
  s_cmp_eq_u32 s92, 5
  s_cbranch_scc1 AT_inv31
AT_inv31_ret:
  s_waitcnt lgkmcnt(0)
  v_mfma_f32_16x16x32_bf16 v[8:11], a[0:3], a[80:83], v[216:219]
  ds_read_b128 a[8:11], v239 offset:4096
  v_exp_f32 v24, v24
  v_exp_f32 v25, v25
  v_mfma_f32_16x16x32_bf16 v[12:15], a[4:7], a[80:83], v[216:219]
  ds_read_b128 a[12:15], v239 offset:5120
  v_exp_f32 v26, v26
  v_exp_f32 v27, v27
  buffer_load_dwordx4 v[172:175], v233, s[24:27], s42 offen offset:1024 sc1
  s_add_u32 s42, s42, 4096
  v_mfma_f32_16x16x32_bf16 v[16:19], a[0:3], a[84:87], v[220:223]
  ds_read_b128 a[24:27], v239 offset:40960
  v_exp_f32 v28, v28
  v_exp_f32 v29, v29
  v_exp_f32 v30, v30
  v_mfma_f32_16x16x32_bf16 v[20:23], a[4:7], a[84:87], v[220:223]
  ds_read_b128 a[28:31], v239 offset:41984
  v_exp_f32 v31, v31
  v_exp_f32 v32, v32
  buffer_load_dwordx4 v[176:179], v233, s[24:27], s42 offen offset:0 sc1
  v_mfma_f32_16x16x32_bf16 v[136:139], a[16:19], v[56:59], v[136:139]
  v_exp_f32 v33, v33
  v_exp_f32 v34, v34
  v_exp_f32 v35, v35
  buffer_load_dwordx4 v[180:183], v233, s[24:27], s42 offen offset:1024 sc1
  s_add_u32 s42, s42, 4096
  v_mfma_f32_16x16x32_bf16 v[140:143], a[20:23], v[56:59], v[140:143]
  v_exp_f32 v36, v36
  v_exp_f32 v37, v37
  v_mfma_f32_16x16x32_bf16 v[144:147], a[32:35], v[56:59], v[144:147]
  v_exp_f32 v38, v38
  v_exp_f32 v39, v39
  s_add_u32 m0, s43, 24576
  s_nop 0
  buffer_load_dwordx4 v228, s[20:23], s41 offen lds
  v_mfma_f32_16x16x32_bf16 v[148:151], a[16:19], v[60:63], v[148:151]
  v_cvt_pk_bf16_f32 v64, v24, v25
  v_cvt_pk_bf16_f32 v65, v26, v27
  v_cvt_pk_bf16_f32 v66, v28, v29
  v_mfma_f32_16x16x32_bf16 v[152:155], a[20:23], v[60:63], v[152:155]
  v_cvt_pk_bf16_f32 v67, v30, v31
  v_cvt_pk_bf16_f32 v68, v32, v33
  s_add_u32 m0, s43, 25600
  s_nop 0
  buffer_load_dwordx4 v229, s[20:23], s41 offen lds
  s_add_u32 s41, s41, s65
  v_mfma_f32_16x16x32_bf16 v[156:159], a[32:35], v[60:63], v[156:159]
  v_cvt_pk_bf16_f32 v69, v34, v35
  v_cvt_pk_bf16_f32 v70, v36, v37
  v_cvt_pk_bf16_f32 v71, v38, v39
  s_add_u32 m0, s43, 32768
  s_nop 0
  buffer_load_dwordx4 v228, s[20:23], s41 offen lds
  s_cmp_eq_u32 s92, 6
  s_cbranch_scc1 AT_inv32
AT_inv32_ret:
  s_waitcnt lgkmcnt(0)
  v_mfma_f32_16x16x32_bf16 v[24:27], a[8:11], a[80:83], v[216:219]
  ds_read_b128 a[0:3], v239 offset:2048
  v_exp_f32 v8, v8
  v_exp_f32 v9, v9
  v_mfma_f32_16x16x32_bf16 v[28:31], a[12:15], a[80:83], v[216:219]
  ds_read_b128 a[4:7], v239 offset:3072
  v_exp_f32 v10, v10
  v_exp_f32 v11, v11
  buffer_load_dwordx4 v[184:187], v233, s[24:27], s42 offen offset:0 sc1
  v_mfma_f32_16x16x32_bf16 v[32:35], a[8:11], a[84:87], v[220:223]
  ds_read_b128 a[16:19], v239 offset:38912
  v_exp_f32 v12, v12
  v_exp_f32 v13, v13
  v_exp_f32 v14, v14
  v_mfma_f32_16x16x32_bf16 v[36:39], a[12:15], a[84:87], v[220:223]
  ds_read_b128 a[20:23], v239 offset:39936
  v_exp_f32 v15, v15
  v_exp_f32 v16, v16
  buffer_load_dwordx4 v[188:191], v233, s[24:27], s42 offen offset:1024 sc1
  s_add_u32 s42, s42, 4096
  v_mfma_f32_16x16x32_bf16 v[136:139], a[24:27], v[64:67], v[136:139]
  v_exp_f32 v17, v17
  v_exp_f32 v18, v18
  v_exp_f32 v19, v19
  buffer_load_dwordx4 v[192:195], v233, s[24:27], s42 offen offset:0 sc1
  v_mfma_f32_16x16x32_bf16 v[140:143], a[28:31], v[64:67], v[140:143]
  v_exp_f32 v20, v20
  v_exp_f32 v21, v21
  v_mfma_f32_16x16x32_bf16 v[144:147], a[32:35], v[64:67], v[144:147]
  v_exp_f32 v22, v22
  v_exp_f32 v23, v23
  s_add_u32 m0, s43, 33792
  s_nop 0
  buffer_load_dwordx4 v229, s[20:23], s41 offen lds
  s_add_u32 s41, s41, 65536
  v_mfma_f32_16x16x32_bf16 v[148:151], a[24:27], v[68:71], v[148:151]
  v_cvt_pk_bf16_f32 v56, v8, v9
  v_cvt_pk_bf16_f32 v57, v10, v11
  v_cvt_pk_bf16_f32 v58, v12, v13
  v_mfma_f32_16x16x32_bf16 v[152:155], a[28:31], v[68:71], v[152:155]
  v_cvt_pk_bf16_f32 v59, v14, v15
  v_cvt_pk_bf16_f32 v60, v16, v17
  s_add_u32 m0, s43, 40960
  s_nop 0
  buffer_load_dwordx4 v228, s[20:23], s41 offen lds
  v_mfma_f32_16x16x32_bf16 v[156:159], a[32:35], v[68:71], v[156:159]
  v_cvt_pk_bf16_f32 v61, v18, v19
  v_cvt_pk_bf16_f32 v62, v20, v21
  v_cvt_pk_bf16_f32 v63, v22, v23
  s_add_u32 m0, s43, 41984
  s_nop 0
  buffer_load_dwordx4 v229, s[20:23], s41 offen lds
  s_add_u32 s41, s41, s66
  s_cmp_eq_u32 s92, 7
  s_cbranch_scc1 AT_inv33
AT_inv33_ret:
  s_waitcnt lgkmcnt(0)
  v_mfma_f32_16x16x32_bf16 v[8:11], a[0:3], a[80:83], v[216:219]
  ds_read_b128 a[8:11], v239 offset:0
  v_exp_f32 v24, v24
  v_exp_f32 v25, v25
  v_mfma_f32_16x16x32_bf16 v[12:15], a[4:7], a[80:83], v[216:219]
  ds_read_b128 a[12:15], v239 offset:1024
  v_exp_f32 v26, v26
  v_exp_f32 v27, v27
  v_add_f32 v128, v100, v216
  buffer_load_dwordx4 v[196:199], v233, s[24:27], s42 offen offset:1024 sc1
  s_add_u32 s42, s42, 4096
  v_mfma_f32_16x16x32_bf16 v[16:19], a[0:3], a[84:87], v[220:223]
  ds_read_b128 a[24:27], v239 offset:36864
  v_exp_f32 v28, v28
  v_exp_f32 v29, v29
  v_exp_f32 v30, v30
  v_add_f32 v129, v101, v217
  v_mfma_f32_16x16x32_bf16 v[20:23], a[4:7], a[84:87], v[220:223]
  ds_read_b128 a[28:31], v239 offset:37888
  v_exp_f32 v31, v31
  v_exp_f32 v32, v32
  v_add_f32 v130, v102, v218
  buffer_load_dwordx4 v[200:203], v233, s[24:27], s42 offen offset:0 sc1
  v_mfma_f32_16x16x32_bf16 v[136:139], a[16:19], v[56:59], v[136:139]
  v_exp_f32 v33, v33
  v_exp_f32 v34, v34
  v_exp_f32 v35, v35
  v_add_f32 v131, v103, v219
  v_mfma_f32_16x16x32_bf16 v[140:143], a[20:23], v[56:59], v[140:143]
  v_exp_f32 v36, v36
  v_exp_f32 v37, v37
  buffer_load_dwordx4 v[204:207], v233, s[24:27], s42 offen offset:1024 sc1
  s_add_u32 s42, s42, 4096
  v_mfma_f32_16x16x32_bf16 v[144:147], a[32:35], v[56:59], v[144:147]
  v_exp_f32 v38, v38
  v_exp_f32 v39, v39
  v_add_f32 v132, v100, v220
  v_mfma_f32_16x16x32_bf16 v[148:151], a[16:19], v[60:63], v[148:151]
  v_cvt_pk_bf16_f32 v64, v24, v25
  v_cvt_pk_bf16_f32 v65, v26, v27
  v_cvt_pk_bf16_f32 v66, v28, v29
  v_add_f32 v133, v101, v221
  s_add_u32 m0, s43, 49152
  s_nop 0
  buffer_load_dwordx4 v228, s[20:23], s41 offen lds
  v_mfma_f32_16x16x32_bf16 v[152:155], a[20:23], v[60:63], v[152:155]
  v_cvt_pk_bf16_f32 v67, v30, v31
  v_cvt_pk_bf16_f32 v68, v32, v33
  v_add_f32 v134, v102, v222
  v_mfma_f32_16x16x32_bf16 v[156:159], a[32:35], v[60:63], v[156:159]
  v_cvt_pk_bf16_f32 v69, v34, v35
  v_cvt_pk_bf16_f32 v70, v36, v37
  v_cvt_pk_bf16_f32 v71, v38, v39
  v_add_f32 v135, v103, v223
  s_add_u32 m0, s43, 50176
  s_nop 0
  buffer_load_dwordx4 v229, s[20:23], s41 offen lds
  s_add_u32 s41, s41, 65536
  s_cmp_eq_u32 s92, 8
  s_cbranch_scc1 AT_inv34
AT_inv34_ret:
  s_waitcnt lgkmcnt(0)
  v_mfma_f32_16x16x32_bf16 v[24:27], a[8:11], a[80:83], v[128:131]
  ds_read_b128 a[16:19], v239 offset:34816
  v_exp_f32 v8, v8
  v_exp_f32 v9, v9
  v_mfma_f32_16x16x32_bf16 v[28:31], a[12:15], a[80:83], v[216:219]
  ds_read_b128 a[20:23], v239 offset:35840
  v_exp_f32 v10, v10
  v_exp_f32 v11, v11
  v_exp_f32 v12, v12
  v_mfma_f32_16x16x32_bf16 v[36:39], a[12:15], a[84:87], v[132:135]
  v_exp_f32 v13, v13
  v_exp_f32 v14, v14
  v_exp_f32 v15, v15
  v_mfma_f32_16x16x32_bf16 v[136:139], a[24:27], v[64:67], v[136:139]
  v_exp_f32 v16, v16
  v_exp_f32 v17, v17
  v_mfma_f32_16x16x32_bf16 v[140:143], a[28:31], v[64:67], v[140:143]
  v_exp_f32 v18, v18
  v_exp_f32 v19, v19
  v_exp_f32 v20, v20
  buffer_load_dwordx4 v[208:211], v233, s[24:27], s42 offen offset:0 sc1
  v_mfma_f32_16x16x32_bf16 v[144:147], a[32:35], v[64:67], v[144:147]
  v_exp_f32 v21, v21
  v_exp_f32 v22, v22
  v_exp_f32 v23, v23
  v_mfma_f32_16x16x32_bf16 v[148:151], a[24:27], v[68:71], v[148:151]
  v_cvt_pk_bf16_f32 v56, v8, v9
  v_cvt_pk_bf16_f32 v57, v10, v11
  v_mfma_f32_16x16x32_bf16 v[152:155], a[28:31], v[68:71], v[152:155]
  v_cvt_pk_bf16_f32 v58, v12, v13
  v_cvt_pk_bf16_f32 v59, v14, v15
  v_cvt_pk_bf16_f32 v60, v16, v17
  v_mfma_f32_16x16x32_bf16 v[156:159], a[32:35], v[68:71], v[156:159]
  v_cvt_pk_bf16_f32 v61, v18, v19
  v_cvt_pk_bf16_f32 v62, v20, v21
  v_cvt_pk_bf16_f32 v63, v22, v23
  buffer_load_dwordx4 v[212:215], v233, s[24:27], s42 offen offset:1024 sc1
  s_add_u32 s42, s42, 4096
  s_waitcnt lgkmcnt(0)
  s_nop 0
  v_mfma_f32_16x16x32_bf16 v[136:139], a[16:19], v[56:59], v[136:139]
  ds_read_b128 a[24:27], v239 offset:32768
  v_exp_f32 v24, v24
  v_exp_f32 v25, v25
  v_exp_f32 v26, v26
  v_mfma_f32_16x16x32_bf16 v[140:143], a[20:23], v[56:59], v[140:143]
  ds_read_b128 a[28:31], v239 offset:33792
  v_exp_f32 v27, v27
  v_exp_f32 v28, v28
  v_exp_f32 v29, v29
  v_mfma_f32_16x16x32_bf16 v[144:147], a[32:35], v[56:59], v[144:147]
  v_exp_f32 v30, v30
  v_exp_f32 v31, v31
  v_exp_f32 v36, v36
  v_exp_f32 v37, v37
  v_mfma_f32_16x16x32_bf16 v[148:151], a[16:19], v[60:63], v[148:151]
  v_exp_f32 v38, v38
  v_exp_f32 v39, v39
  v_cvt_pk_bf16_f32 v64, v24, v25
  v_mfma_f32_16x16x32_bf16 v[152:155], a[20:23], v[60:63], v[152:155]
  v_cvt_pk_bf16_f32 v65, v26, v27
  v_cvt_pk_bf16_f32 v66, v28, v29
  v_cvt_pk_bf16_f32 v67, v30, v31
  v_mfma_f32_16x16x32_bf16 v[156:159], a[32:35], v[60:63], v[156:159]
  v_mov_b32 v68, 0
  v_mov_b32 v69, 0
  v_cvt_pk_bf16_f32 v70, v36, v37
  v_cvt_pk_bf16_f32 v71, v38, v39
  s_waitcnt lgkmcnt(0)
  s_nop 0
  v_mfma_f32_16x16x32_bf16 v[136:139], a[24:27], v[64:67], v[136:139]
  v_mfma_f32_16x16x32_bf16 v[140:143], a[28:31], v[64:67], v[140:143]
  v_mfma_f32_16x16x32_bf16 v[144:147], a[32:35], v[64:67], v[144:147]
  v_mfma_f32_16x16x32_bf16 v[148:151], a[24:27], v[68:71], v[148:151]
  v_mfma_f32_16x16x32_bf16 v[152:155], a[28:31], v[68:71], v[152:155]
  v_mfma_f32_16x16x32_bf16 v[156:159], a[32:35], v[68:71], v[156:159]
  s_nop 7
  s_nop 1
  v_rcp_f32 v4, v144
  v_rcp_f32 v5, v156
  v_max_f32 v7, v144, v156
  v_cmp_ngt_f32 vcc, s18, v7
  s_nop 1
  s_cmp_lg_u64 vcc, 0
  s_cselect_b32 s95, 1, s95
  v_mul_f32 v136, v136, v4
  v_mul_f32 v137, v137, v4
  v_mul_f32 v138, v138, v4
  v_mul_f32 v139, v139, v4
  v_mul_f32 v140, v140, v4
  v_mul_f32 v141, v141, v4
  v_mul_f32 v142, v142, v4
  v_mul_f32 v143, v143, v4
  v_cvt_pk_bf16_f32 v136, v136, v137
  v_cvt_pk_bf16_f32 v137, v138, v139
  v_cvt_pk_bf16_f32 v138, v140, v141
  v_cvt_pk_bf16_f32 v139, v142, v143
  buffer_store_dwordx4 v[136:139], v1, s[84:87], s91 offen offset:0 sc1
  v_mul_f32 v148, v148, v5
  v_mul_f32 v149, v149, v5
  v_mul_f32 v150, v150, v5
  v_mul_f32 v151, v151, v5
  v_mul_f32 v152, v152, v5
  v_mul_f32 v153, v153, v5
  v_mul_f32 v154, v154, v5
  v_mul_f32 v155, v155, v5
  v_cvt_pk_bf16_f32 v148, v148, v149
  v_cvt_pk_bf16_f32 v149, v150, v151
  v_cvt_pk_bf16_f32 v150, v152, v153
  v_cvt_pk_bf16_f32 v151, v154, v155
  buffer_store_dwordx4 v[148:151], v1, s[84:87], s91 offen offset:1024 sc1
  s_cmp_lg_u32 s95, 0
  s_cbranch_scc1 AT_slow
AT_done:
  s_waitcnt vmcnt(2)
  s_branch G2_entry
MG_w1:
  s_waitcnt lgkmcnt(0)
  v_mbcnt_lo_u32_b32 v255, -1, 0
  v_mbcnt_hi_u32_b32 v255, -1, v255
  s_mov_b32 s52, s42
  s_bfe_u32 s46, s2, 0x10007
  v_lshrrev_b32 v236, 3, v255
  v_and_b32 v237, 6, v236
  v_and_b32 v238, 7, v255
  v_xor_b32 v237, v237, v238
  v_lshlrev_b32 v236, 11, v236
  v_lshl_add_u32 v228, v237, 4, v236
  s_lshl_b32 s41, s40, 14
  s_add_u32 s41, s41, s38
  v_add_u32 v228, s41, v228
  v_xor_b32 v229, 128, v228
  s_cmp_eq_u32 s46, 0
  s_cselect_b32 s41, 4, 11
  s_cselect_b32 s65, 11, 5
  s_cselect_b32 s67, 11, 3
  s_cselect_b32 s73, 3, 31
  s_mov_b32 s64, 65536
  s_mov_b32 s66, 65536
  s_lshl_b32 s65, s65, 16
  s_lshl_b32 s67, s67, 16
  s_lshl_b32 s43, s40, 11
  s_lshl_b32 s41, s41, 16
  s_mov_b32 s20, s4
  s_and_b32 s21, s5, 0xffff
  s_mov_b32 s22, 0x700000
  s_mov_b32 s23, 0x20000
  s_mul_i32 s42, s46, 196608
  s_lshl_b32 s58, s52, 1
  s_lshr_b32 s59, s40, 1
  s_add_u32 s58, s58, s59
  s_mul_i32 s58, s58, 589824
  s_and_b32 s57, s40, 1
  s_lshl_b32 s57, s57, 11
  s_add_u32 s58, s58, s57
  s_add_u32 s58, s58, 16777216
  s_add_u32 s60, s10, s58
  s_addc_u32 s61, s11, 0
  s_mov_b32 s24, s60
  s_and_b32 s25, s61, 0xffff
  s_mov_b32 s26, 0x8f800
  s_mov_b32 s27, 0x20000
  v_bfe_u32 v236, v255, 2, 3
  v_and_b32 v237, 6, v236
  v_bfe_u32 v238, v255, 1, 1
  v_or_b32 v237, v237, v238
  v_lshlrev_b32 v236, 7, v236
  v_lshl_add_u32 v236, v237, 4, v236
  v_lshrrev_b32 v238, 5, v255
  v_lshl_add_u32 v236, v238, 11, v236
  v_and_b32 v238, 1, v255
  v_lshl_add_u32 v224, v238, 3, v236
  v_xor_b32 v225, 32, v224
  v_xor_b32 v226, 64, v224
  v_xor_b32 v227, 96, v224
  s_mov_b32 s32, s16
  s_and_b32 s33, s17, 0xffff
  s_mov_b32 s34, 0x400000
  s_mov_b32 s35, 0x20000
  v_and_b32 v232, 15, v255
  v_lshlrev_b32 v232, 8, v232
  v_lshrrev_b32 v236, 3, v255
  v_and_b32 v230, 7, v255
  v_xor_b32 v230, v230, v236
  v_lshlrev_b32 v236, 11, v236
  v_lshl_add_u32 v230, v230, 4, v236
  v_lshrrev_b32 v234, 4, v255
  v_lshlrev_b32 v234, 3, v234
  v_lshlrev_b32 v233, 4, v255
  v_and_b32 v236, 0x70, v233
  v_xor_b32 v236, v236, v234
  v_and_b32 v237, 15, v255
  v_lshl_add_u32 v236, v237, 7, v236
  s_lshl_b32 s57, s40, 12
  s_add_u32 s45, s57, 147456
  v_add_u32 v235, s45, v236
  s_lshr_b32 s57, s52, 1
  s_lshl_b32 s63, s57, 12
  s_add_u32 s63, s63, 46301184
  s_lshl_b32 s76, s57, 12
  s_add_u32 s76, s76, 46333952
  s_lshl_b32 s57, s89, 12
  s_lshl_b32 s58, s88, 8
  s_add_u32 s57, s57, s58
  s_mul_i32 s58, s46, 32768
  s_add_u32 s57, s57, s58
  s_add_u32 s74, s57, 46301184
  s_lshl_b32 s57, s47, 1
  s_add_u32 s57, s57, s46
  s_lshl_b32 s62, s57, 8
  s_add_u32 s62, s62, 46137344
  s_xor_b32 s75, s62, 256
  s_lshl_b32 s57, s57, 15
  s_lshl_b32 s58, s40, 13
  s_add_u32 s57, s57, s58
  s_add_u32 s80, s57, 37748736
  s_xor_b32 s81, s80, 32768
  s_cmp_eq_u32 s46, 0
  s_cselect_b32 s77, 6, 8
  s_waitcnt vmcnt(0)
  v_cmp_ne_u32 vcc, s3, v247
  s_nop 1
  s_and_b64 vcc, vcc, 0xffff
  s_cbranch_scc1 W1_spin
W1_go:
  buffer_load_dwordx4 v[160:163], v233, s[24:27], s42 offen offset:0 sc1
  buffer_load_dwordx4 v[164:167], v233, s[24:27], s42 offen offset:1024 sc1
  s_add_u32 s42, s42, 4096
  buffer_load_dwordx4 v[168:171], v233, s[24:27], s42 offen offset:0 sc1
  buffer_load_dwordx4 v[172:175], v233, s[24:27], s42 offen offset:1024 sc1
  s_add_u32 s42, s42, 4096
  buffer_load_dwordx4 v[176:179], v233, s[24:27], s42 offen offset:0 sc1
  buffer_load_dwordx4 v[180:183], v233, s[24:27], s42 offen offset:1024 sc1
  s_add_u32 s42, s42, 4096
  buffer_load_dwordx4 v[184:187], v233, s[24:27], s42 offen offset:0 sc1
  buffer_load_dwordx4 v[188:191], v233, s[24:27], s42 offen offset:1024 sc1
  s_add_u32 s42, s42, 4096
  buffer_load_dwordx4 v[192:195], v233, s[24:27], s42 offen offset:0 sc1
  buffer_load_dwordx4 v[196:199], v233, s[24:27], s42 offen offset:1024 sc1
  s_add_u32 s42, s42, 4096
  buffer_load_dwordx4 v[200:203], v233, s[24:27], s42 offen offset:0 sc1
  buffer_load_dwordx4 v[204:207], v233, s[24:27], s42 offen offset:1024 sc1
  s_add_u32 s42, s42, 4096
  buffer_load_dwordx4 v[208:211], v233, s[24:27], s42 offen offset:0 sc1
  buffer_load_dwordx4 v[212:215], v233, s[24:27], s42 offen offset:1024 sc1
  s_add_u32 s42, s42, 4096
  s_barrier
  s_cmp_lg_u32 s40, 0
  s_cbranch_scc1 W1_nofl
  v_mov_b32 v7, s3
  s_mov_b64 exec, 1
  buffer_store_dword v7, v232, s[84:87], s74 offen sc1
  s_mov_b64 exec, -1
W1_nofl:
  s_branch G2_entry2
G2_entry:
  s_barrier
G2_entry2:
  ds_read_b64_tr_b16 v[128:129], v224 offset:0
  ds_read_b64_tr_b16 v[130:131], v224 offset:4096
  ds_read_b64_tr_b16 v[132:133], v225 offset:0
  ds_read_b64_tr_b16 v[134:135], v225 offset:4096
  ds_read_b64_tr_b16 v[136:137], v226 offset:0
  ds_read_b64_tr_b16 v[138:139], v226 offset:4096
  ds_read_b64_tr_b16 v[140:141], v227 offset:0
  ds_read_b64_tr_b16 v[142:143], v227 offset:4096
  s_waitcnt lgkmcnt(2)
  ds_read_b64_tr_b16 v[144:145], v224 offset:1024
  ds_read_b64_tr_b16 v[146:147], v224 offset:5120
  ds_read_b64_tr_b16 v[148:149], v225 offset:1024
  ds_read_b64_tr_b16 v[150:151], v225 offset:5120
  ds_read_b64_tr_b16 v[152:153], v226 offset:1024
  ds_read_b64_tr_b16 v[154:155], v226 offset:5120
  ds_read_b64_tr_b16 v[156:157], v227 offset:1024
  ds_read_b64_tr_b16 v[158:159], v227 offset:5120
  v_pk_mov_b32 v[0:1], 0, 0
  v_pk_mov_b32 v[2:3], 0, 0
  v_pk_mov_b32 v[4:5], 0, 0
  v_pk_mov_b32 v[6:7], 0, 0
  v_pk_mov_b32 v[8:9], 0, 0
  v_pk_mov_b32 v[10:11], 0, 0
  v_pk_mov_b32 v[12:13], 0, 0
  v_pk_mov_b32 v[14:15], 0, 0
  v_pk_mov_b32 v[16:17], 0, 0
  v_pk_mov_b32 v[18:19], 0, 0
  v_pk_mov_b32 v[20:21], 0, 0
  v_pk_mov_b32 v[22:23], 0, 0
  v_pk_mov_b32 v[24:25], 0, 0
  v_pk_mov_b32 v[26:27], 0, 0
  v_pk_mov_b32 v[28:29], 0, 0
  v_pk_mov_b32 v[30:31], 0, 0
  v_pk_mov_b32 v[32:33], 0, 0
  v_pk_mov_b32 v[34:35], 0, 0
  v_pk_mov_b32 v[36:37], 0, 0
  v_pk_mov_b32 v[38:39], 0, 0
  v_pk_mov_b32 v[40:41], 0, 0
  v_pk_mov_b32 v[42:43], 0, 0
  v_pk_mov_b32 v[44:45], 0, 0
  v_pk_mov_b32 v[46:47], 0, 0
  v_pk_mov_b32 v[48:49], 0, 0
  v_pk_mov_b32 v[50:51], 0, 0
  v_pk_mov_b32 v[52:53], 0, 0
  v_pk_mov_b32 v[54:55], 0, 0
  v_pk_mov_b32 v[56:57], 0, 0
  v_pk_mov_b32 v[58:59], 0, 0
  v_pk_mov_b32 v[60:61], 0, 0
  v_pk_mov_b32 v[62:63], 0, 0
  s_mov_b32 s44, 0
  s_sub_u32 s78, s77, 1
  s_sub_u32 s79, s77, 2
  s_mov_b32 s50, s63
  s_lshl_b32 s70, 1, s78
  s_bitset1_b32 s70, s73
  s_lshl_b32 s71, 1, s79
  s_or_b32 s71, s71, 9
  s_waitcnt vmcnt(8) lgkmcnt(0)
.p2align 4
G2_loop:
  v_mfma_f32_16x16x32_bf16 v[0:3], v[128:131], v[160:163], v[0:3]
  s_add_u32 m0, s43, 57344
  v_mfma_f32_16x16x32_bf16 v[4:7], v[128:131], v[164:167], v[4:7]
  ds_read_b64_tr_b16 v[128:129], v224 offset:8192
  ds_read_b64_tr_b16 v[130:131], v224 offset:12288
  v_mfma_f32_16x16x32_bf16 v[12:15], v[132:135], v[164:167], v[12:15]
  buffer_load_dwordx4 v228, s[20:23], s41 offen lds
  v_mfma_f32_16x16x32_bf16 v[8:11], v[132:135], v[160:163], v[8:11]
  ds_read_b64_tr_b16 v[132:133], v225 offset:8192
  ds_read_b64_tr_b16 v[134:135], v225 offset:12288
  v_mfma_f32_16x16x32_bf16 v[16:19], v[136:139], v[160:163], v[16:19]
  s_add_u32 m0, s43, 58368
  v_mfma_f32_16x16x32_bf16 v[20:23], v[136:139], v[164:167], v[20:23]
  ds_read_b64_tr_b16 v[136:137], v226 offset:8192
  ds_read_b64_tr_b16 v[138:139], v226 offset:12288
  v_mfma_f32_16x16x32_bf16 v[28:31], v[140:143], v[164:167], v[28:31]
  buffer_load_dwordx4 v229, s[20:23], s41 offen lds
  s_waitcnt lgkmcnt(6)
  v_mfma_f32_16x16x32_bf16 v[24:27], v[140:143], v[160:163], v[24:27]
  ds_read_b64_tr_b16 v[140:141], v227 offset:8192
  ds_read_b64_tr_b16 v[142:143], v227 offset:12288
  v_mfma_f32_16x16x32_bf16 v[32:35], v[144:147], v[160:163], v[32:35]
  s_add_u32 s41, s41, s67
  s_xor_b32 s43, s43, 0x10000
  v_mfma_f32_16x16x32_bf16 v[36:39], v[144:147], v[164:167], v[36:39]
  ds_read_b64_tr_b16 v[144:145], v224 offset:9216
  ds_read_b64_tr_b16 v[146:147], v224 offset:13312
  v_mfma_f32_16x16x32_bf16 v[44:47], v[148:151], v[164:167], v[44:47]
  buffer_load_dwordx4 v[216:219], v233, s[24:27], s42 offen offset:0 sc1
  v_mfma_f32_16x16x32_bf16 v[40:43], v[148:151], v[160:163], v[40:43]
  ds_read_b64_tr_b16 v[148:149], v225 offset:9216
  ds_read_b64_tr_b16 v[150:151], v225 offset:13312
  v_mfma_f32_16x16x32_bf16 v[48:51], v[152:155], v[160:163], v[48:51]
  buffer_load_dwordx4 v[220:223], v233, s[24:27], s42 offen offset:1024 sc1
  v_mfma_f32_16x16x32_bf16 v[52:55], v[152:155], v[164:167], v[52:55]
  ds_read_b64_tr_b16 v[152:153], v226 offset:9216
  ds_read_b64_tr_b16 v[154:155], v226 offset:13312
  v_mfma_f32_16x16x32_bf16 v[60:63], v[156:159], v[164:167], v[60:63]
  s_add_u32 s42, s42, 4096
  s_waitcnt lgkmcnt(6)
  v_mfma_f32_16x16x32_bf16 v[56:59], v[156:159], v[160:163], v[56:59]
  ds_read_b64_tr_b16 v[156:157], v227 offset:9216
  ds_read_b64_tr_b16 v[158:159], v227 offset:13312
  s_waitcnt vmcnt(16)
  s_barrier
  s_bitcmp1_b32 s70, s44
  s_cbranch_scc1 G2_h1
G2_h1_ret:
  v_mfma_f32_16x16x32_bf16 v[0:3], v[128:131], v[168:171], v[0:3]
  s_add_u32 m0, s43, 0
  v_mfma_f32_16x16x32_bf16 v[4:7], v[128:131], v[172:175], v[4:7]
  ds_read_b64_tr_b16 v[128:129], v224 offset:16384
  ds_read_b64_tr_b16 v[130:131], v224 offset:20480
  v_mfma_f32_16x16x32_bf16 v[12:15], v[132:135], v[172:175], v[12:15]
  buffer_load_dwordx4 v228, s[20:23], s41 offen lds
  v_mfma_f32_16x16x32_bf16 v[8:11], v[132:135], v[168:171], v[8:11]
  ds_read_b64_tr_b16 v[132:133], v225 offset:16384
  ds_read_b64_tr_b16 v[134:135], v225 offset:20480
  v_mfma_f32_16x16x32_bf16 v[16:19], v[136:139], v[168:171], v[16:19]
  s_add_u32 m0, s43, 1024
  v_mfma_f32_16x16x32_bf16 v[20:23], v[136:139], v[172:175], v[20:23]
  ds_read_b64_tr_b16 v[136:137], v226 offset:16384
  ds_read_b64_tr_b16 v[138:139], v226 offset:20480
  v_mfma_f32_16x16x32_bf16 v[28:31], v[140:143], v[172:175], v[28:31]
  buffer_load_dwordx4 v229, s[20:23], s41 offen lds
  s_waitcnt lgkmcnt(6)
  v_mfma_f32_16x16x32_bf16 v[24:27], v[140:143], v[168:171], v[24:27]
  ds_read_b64_tr_b16 v[140:141], v227 offset:16384
  ds_read_b64_tr_b16 v[142:143], v227 offset:20480
  v_mfma_f32_16x16x32_bf16 v[32:35], v[144:147], v[168:171], v[32:35]
  s_add_u32 s41, s41, 65536
  v_mfma_f32_16x16x32_bf16 v[36:39], v[144:147], v[172:175], v[36:39]
  ds_read_b64_tr_b16 v[144:145], v224 offset:17408
  ds_read_b64_tr_b16 v[146:147], v224 offset:21504
  v_mfma_f32_16x16x32_bf16 v[44:47], v[148:151], v[172:175], v[44:47]
  buffer_load_dwordx4 v[160:163], v233, s[24:27], s42 offen offset:0 sc1
  v_mfma_f32_16x16x32_bf16 v[40:43], v[148:151], v[168:171], v[40:43]
  ds_read_b64_tr_b16 v[148:149], v225 offset:17408
  ds_read_b64_tr_b16 v[150:151], v225 offset:21504
  v_mfma_f32_16x16x32_bf16 v[48:51], v[152:155], v[168:171], v[48:51]
  buffer_load_dwordx4 v[164:167], v233, s[24:27], s42 offen offset:1024 sc1
  v_mfma_f32_16x16x32_bf16 v[52:55], v[152:155], v[172:175], v[52:55]
  ds_read_b64_tr_b16 v[152:153], v226 offset:17408
  ds_read_b64_tr_b16 v[154:155], v226 offset:21504
  v_mfma_f32_16x16x32_bf16 v[60:63], v[156:159], v[172:175], v[60:63]
  s_add_u32 s42, s42, 4096
  s_waitcnt lgkmcnt(6)
  v_mfma_f32_16x16x32_bf16 v[56:59], v[156:159], v[168:171], v[56:59]
  ds_read_b64_tr_b16 v[156:157], v227 offset:17408
  ds_read_b64_tr_b16 v[158:159], v227 offset:21504
  v_mfma_f32_16x16x32_bf16 v[0:3], v[128:131], v[176:179], v[0:3]
  s_add_u32 m0, s43, 8192
  v_mfma_f32_16x16x32_bf16 v[4:7], v[128:131], v[180:183], v[4:7]
  ds_read_b64_tr_b16 v[128:129], v224 offset:24576
  ds_read_b64_tr_b16 v[130:131], v224 offset:28672
  v_mfma_f32_16x16x32_bf16 v[12:15], v[132:135], v[180:183], v[12:15]
  buffer_load_dwordx4 v228, s[20:23], s41 offen lds
  v_mfma_f32_16x16x32_bf16 v[8:11], v[132:135], v[176:179], v[8:11]
  ds_read_b64_tr_b16 v[132:133], v225 offset:24576
  ds_read_b64_tr_b16 v[134:135], v225 offset:28672
  v_mfma_f32_16x16x32_bf16 v[16:19], v[136:139], v[176:179], v[16:19]
  s_add_u32 m0, s43, 9216
  v_mfma_f32_16x16x32_bf16 v[20:23], v[136:139], v[180:183], v[20:23]
  ds_read_b64_tr_b16 v[136:137], v226 offset:24576
  ds_read_b64_tr_b16 v[138:139], v226 offset:28672
  v_mfma_f32_16x16x32_bf16 v[28:31], v[140:143], v[180:183], v[28:31]
  buffer_load_dwordx4 v229, s[20:23], s41 offen lds
  s_waitcnt lgkmcnt(6)
  v_mfma_f32_16x16x32_bf16 v[24:27], v[140:143], v[176:179], v[24:27]
  ds_read_b64_tr_b16 v[140:141], v227 offset:24576
  ds_read_b64_tr_b16 v[142:143], v227 offset:28672
  v_mfma_f32_16x16x32_bf16 v[32:35], v[144:147], v[176:179], v[32:35]
  s_add_u32 s41, s41, s64
  v_mfma_f32_16x16x32_bf16 v[36:39], v[144:147], v[180:183], v[36:39]
  ds_read_b64_tr_b16 v[144:145], v224 offset:25600
  ds_read_b64_tr_b16 v[146:147], v224 offset:29696
  v_mfma_f32_16x16x32_bf16 v[44:47], v[148:151], v[180:183], v[44:47]
  buffer_load_dwordx4 v[168:171], v233, s[24:27], s42 offen offset:0 sc1
  v_mfma_f32_16x16x32_bf16 v[40:43], v[148:151], v[176:179], v[40:43]
  ds_read_b64_tr_b16 v[148:149], v225 offset:25600
  ds_read_b64_tr_b16 v[150:151], v225 offset:29696
  v_mfma_f32_16x16x32_bf16 v[48:51], v[152:155], v[176:179], v[48:51]
  buffer_load_dwordx4 v[172:175], v233, s[24:27], s42 offen offset:1024 sc1
  v_mfma_f32_16x16x32_bf16 v[52:55], v[152:155], v[180:183], v[52:55]
  ds_read_b64_tr_b16 v[152:153], v226 offset:25600
  ds_read_b64_tr_b16 v[154:155], v226 offset:29696
  v_mfma_f32_16x16x32_bf16 v[60:63], v[156:159], v[180:183], v[60:63]
  s_add_u32 s42, s42, 4096
  s_waitcnt lgkmcnt(6)
  v_mfma_f32_16x16x32_bf16 v[56:59], v[156:159], v[176:179], v[56:59]
  ds_read_b64_tr_b16 v[156:157], v227 offset:25600
  ds_read_b64_tr_b16 v[158:159], v227 offset:29696
  s_waitcnt vmcnt(16)
  s_barrier
  v_mfma_f32_16x16x32_bf16 v[0:3], v[128:131], v[184:187], v[0:3]
  s_add_u32 m0, s43, 16384
  v_mfma_f32_16x16x32_bf16 v[4:7], v[128:131], v[188:191], v[4:7]
  ds_read_b64_tr_b16 v[128:129], v224 offset:32768
  ds_read_b64_tr_b16 v[130:131], v224 offset:36864
  v_mfma_f32_16x16x32_bf16 v[12:15], v[132:135], v[188:191], v[12:15]
  buffer_load_dwordx4 v228, s[20:23], s41 offen lds
  v_mfma_f32_16x16x32_bf16 v[8:11], v[132:135], v[184:187], v[8:11]
  ds_read_b64_tr_b16 v[132:133], v225 offset:32768
  ds_read_b64_tr_b16 v[134:135], v225 offset:36864
  v_mfma_f32_16x16x32_bf16 v[16:19], v[136:139], v[184:187], v[16:19]
  s_add_u32 m0, s43, 17408
  v_mfma_f32_16x16x32_bf16 v[20:23], v[136:139], v[188:191], v[20:23]
  ds_read_b64_tr_b16 v[136:137], v226 offset:32768
  ds_read_b64_tr_b16 v[138:139], v226 offset:36864
  v_mfma_f32_16x16x32_bf16 v[28:31], v[140:143], v[188:191], v[28:31]
  buffer_load_dwordx4 v229, s[20:23], s41 offen lds
  s_waitcnt lgkmcnt(6)
  v_mfma_f32_16x16x32_bf16 v[24:27], v[140:143], v[184:187], v[24:27]
  ds_read_b64_tr_b16 v[140:141], v227 offset:32768
  ds_read_b64_tr_b16 v[142:143], v227 offset:36864
  v_mfma_f32_16x16x32_bf16 v[32:35], v[144:147], v[184:187], v[32:35]
  s_add_u32 s41, s41, 65536
  v_mfma_f32_16x16x32_bf16 v[36:39], v[144:147], v[188:191], v[36:39]
  ds_read_b64_tr_b16 v[144:145], v224 offset:33792
  ds_read_b64_tr_b16 v[146:147], v224 offset:37888
  v_mfma_f32_16x16x32_bf16 v[44:47], v[148:151], v[188:191], v[44:47]
  buffer_load_dwordx4 v[176:179], v233, s[24:27], s42 offen offset:0 sc1
  v_mfma_f32_16x16x32_bf16 v[40:43], v[148:151], v[184:187], v[40:43]
  ds_read_b64_tr_b16 v[148:149], v225 offset:33792
  ds_read_b64_tr_b16 v[150:151], v225 offset:37888
  v_mfma_f32_16x16x32_bf16 v[48:51], v[152:155], v[184:187], v[48:51]
  buffer_load_dwordx4 v[180:183], v233, s[24:27], s42 offen offset:1024 sc1
  v_mfma_f32_16x16x32_bf16 v[52:55], v[152:155], v[188:191], v[52:55]
  ds_read_b64_tr_b16 v[152:153], v226 offset:33792
  ds_read_b64_tr_b16 v[154:155], v226 offset:37888
  v_mfma_f32_16x16x32_bf16 v[60:63], v[156:159], v[188:191], v[60:63]
  s_add_u32 s42, s42, 4096
  s_waitcnt lgkmcnt(6)
  v_mfma_f32_16x16x32_bf16 v[56:59], v[156:159], v[184:187], v[56:59]
  ds_read_b64_tr_b16 v[156:157], v227 offset:33792
  ds_read_b64_tr_b16 v[158:159], v227 offset:37888
  v_mfma_f32_16x16x32_bf16 v[0:3], v[128:131], v[192:195], v[0:3]
  s_add_u32 m0, s43, 24576
  v_mfma_f32_16x16x32_bf16 v[4:7], v[128:131], v[196:199], v[4:7]
  ds_read_b64_tr_b16 v[128:129], v224 offset:40960
  ds_read_b64_tr_b16 v[130:131], v224 offset:45056
  v_mfma_f32_16x16x32_bf16 v[12:15], v[132:135], v[196:199], v[12:15]
  buffer_load_dwordx4 v228, s[20:23], s41 offen lds
  v_mfma_f32_16x16x32_bf16 v[8:11], v[132:135], v[192:195], v[8:11]
  ds_read_b64_tr_b16 v[132:133], v225 offset:40960
  ds_read_b64_tr_b16 v[134:135], v225 offset:45056
  v_mfma_f32_16x16x32_bf16 v[16:19], v[136:139], v[192:195], v[16:19]
  s_add_u32 m0, s43, 25600
  v_mfma_f32_16x16x32_bf16 v[20:23], v[136:139], v[196:199], v[20:23]
  ds_read_b64_tr_b16 v[136:137], v226 offset:40960
  ds_read_b64_tr_b16 v[138:139], v226 offset:45056
  v_mfma_f32_16x16x32_bf16 v[28:31], v[140:143], v[196:199], v[28:31]
  buffer_load_dwordx4 v229, s[20:23], s41 offen lds
  s_waitcnt lgkmcnt(6)
  v_mfma_f32_16x16x32_bf16 v[24:27], v[140:143], v[192:195], v[24:27]
  ds_read_b64_tr_b16 v[140:141], v227 offset:40960
  ds_read_b64_tr_b16 v[142:143], v227 offset:45056
  v_mfma_f32_16x16x32_bf16 v[32:35], v[144:147], v[192:195], v[32:35]
  s_add_u32 s41, s41, s65
  v_mfma_f32_16x16x32_bf16 v[36:39], v[144:147], v[196:199], v[36:39]
  ds_read_b64_tr_b16 v[144:145], v224 offset:41984
  ds_read_b64_tr_b16 v[146:147], v224 offset:46080
  v_mfma_f32_16x16x32_bf16 v[44:47], v[148:151], v[196:199], v[44:47]
  buffer_load_dwordx4 v[184:187], v233, s[24:27], s42 offen offset:0 sc1
  v_mfma_f32_16x16x32_bf16 v[40:43], v[148:151], v[192:195], v[40:43]
  ds_read_b64_tr_b16 v[148:149], v225 offset:41984
  ds_read_b64_tr_b16 v[150:151], v225 offset:46080
  v_mfma_f32_16x16x32_bf16 v[48:51], v[152:155], v[192:195], v[48:51]
  buffer_load_dwordx4 v[188:191], v233, s[24:27], s42 offen offset:1024 sc1
  v_mfma_f32_16x16x32_bf16 v[52:55], v[152:155], v[196:199], v[52:55]
  ds_read_b64_tr_b16 v[152:153], v226 offset:41984
  ds_read_b64_tr_b16 v[154:155], v226 offset:46080
  v_mfma_f32_16x16x32_bf16 v[60:63], v[156:159], v[196:199], v[60:63]
  s_add_u32 s42, s42, 4096
  s_waitcnt lgkmcnt(6)
  v_mfma_f32_16x16x32_bf16 v[56:59], v[156:159], v[192:195], v[56:59]
  ds_read_b64_tr_b16 v[156:157], v227 offset:41984
  ds_read_b64_tr_b16 v[158:159], v227 offset:46080
  s_waitcnt vmcnt(16)
  s_barrier
  v_mfma_f32_16x16x32_bf16 v[0:3], v[128:131], v[200:203], v[0:3]
  s_add_u32 m0, s43, 32768
  v_mfma_f32_16x16x32_bf16 v[4:7], v[128:131], v[204:207], v[4:7]
  ds_read_b64_tr_b16 v[128:129], v224 offset:49152
  ds_read_b64_tr_b16 v[130:131], v224 offset:53248
  v_mfma_f32_16x16x32_bf16 v[12:15], v[132:135], v[204:207], v[12:15]
  buffer_load_dwordx4 v228, s[20:23], s41 offen lds
  v_mfma_f32_16x16x32_bf16 v[8:11], v[132:135], v[200:203], v[8:11]
  ds_read_b64_tr_b16 v[132:133], v225 offset:49152
  ds_read_b64_tr_b16 v[134:135], v225 offset:53248
  v_mfma_f32_16x16x32_bf16 v[16:19], v[136:139], v[200:203], v[16:19]
  s_add_u32 m0, s43, 33792
  v_mfma_f32_16x16x32_bf16 v[20:23], v[136:139], v[204:207], v[20:23]
  ds_read_b64_tr_b16 v[136:137], v226 offset:49152
  ds_read_b64_tr_b16 v[138:139], v226 offset:53248
  v_mfma_f32_16x16x32_bf16 v[28:31], v[140:143], v[204:207], v[28:31]
  buffer_load_dwordx4 v229, s[20:23], s41 offen lds
  s_waitcnt lgkmcnt(6)
  v_mfma_f32_16x16x32_bf16 v[24:27], v[140:143], v[200:203], v[24:27]
  ds_read_b64_tr_b16 v[140:141], v227 offset:49152
  ds_read_b64_tr_b16 v[142:143], v227 offset:53248
  v_mfma_f32_16x16x32_bf16 v[32:35], v[144:147], v[200:203], v[32:35]
  s_add_u32 s41, s41, 65536
  v_mfma_f32_16x16x32_bf16 v[36:39], v[144:147], v[204:207], v[36:39]
  ds_read_b64_tr_b16 v[144:145], v224 offset:50176
  ds_read_b64_tr_b16 v[146:147], v224 offset:54272
  v_mfma_f32_16x16x32_bf16 v[44:47], v[148:151], v[204:207], v[44:47]
  buffer_load_dwordx4 v[192:195], v233, s[24:27], s42 offen offset:0 sc1
  v_mfma_f32_16x16x32_bf16 v[40:43], v[148:151], v[200:203], v[40:43]
  ds_read_b64_tr_b16 v[148:149], v225 offset:50176
  ds_read_b64_tr_b16 v[150:151], v225 offset:54272
  v_mfma_f32_16x16x32_bf16 v[48:51], v[152:155], v[200:203], v[48:51]
  buffer_load_dwordx4 v[196:199], v233, s[24:27], s42 offen offset:1024 sc1
  v_mfma_f32_16x16x32_bf16 v[52:55], v[152:155], v[204:207], v[52:55]
  ds_read_b64_tr_b16 v[152:153], v226 offset:50176
  ds_read_b64_tr_b16 v[154:155], v226 offset:54272
  v_mfma_f32_16x16x32_bf16 v[60:63], v[156:159], v[204:207], v[60:63]
  s_add_u32 s42, s42, 4096
  s_waitcnt lgkmcnt(6)
  v_mfma_f32_16x16x32_bf16 v[56:59], v[156:159], v[200:203], v[56:59]
  ds_read_b64_tr_b16 v[156:157], v227 offset:50176
  ds_read_b64_tr_b16 v[158:159], v227 offset:54272
  s_bitcmp1_b32 s71, s44
  s_cbranch_scc1 G2_h6
G2_h6_ret:
  v_mfma_f32_16x16x32_bf16 v[0:3], v[128:131], v[208:211], v[0:3]
  s_add_u32 m0, s43, 40960
  v_mfma_f32_16x16x32_bf16 v[4:7], v[128:131], v[212:215], v[4:7]
  ds_read_b64_tr_b16 v[128:129], v224 offset:57344
  ds_read_b64_tr_b16 v[130:131], v224 offset:61440
  v_mfma_f32_16x16x32_bf16 v[12:15], v[132:135], v[212:215], v[12:15]
  buffer_load_dwordx4 v228, s[20:23], s41 offen lds
  v_mfma_f32_16x16x32_bf16 v[8:11], v[132:135], v[208:211], v[8:11]
  ds_read_b64_tr_b16 v[132:133], v225 offset:57344
  ds_read_b64_tr_b16 v[134:135], v225 offset:61440
  v_mfma_f32_16x16x32_bf16 v[16:19], v[136:139], v[208:211], v[16:19]
  s_add_u32 m0, s43, 41984
  v_mfma_f32_16x16x32_bf16 v[20:23], v[136:139], v[212:215], v[20:23]
  ds_read_b64_tr_b16 v[136:137], v226 offset:57344
  ds_read_b64_tr_b16 v[138:139], v226 offset:61440
  v_mfma_f32_16x16x32_bf16 v[28:31], v[140:143], v[212:215], v[28:31]
  buffer_load_dwordx4 v229, s[20:23], s41 offen lds
  s_waitcnt lgkmcnt(6)
  v_mfma_f32_16x16x32_bf16 v[24:27], v[140:143], v[208:211], v[24:27]
  ds_read_b64_tr_b16 v[140:141], v227 offset:57344
  ds_read_b64_tr_b16 v[142:143], v227 offset:61440
  v_mfma_f32_16x16x32_bf16 v[32:35], v[144:147], v[208:211], v[32:35]
  s_add_u32 s41, s41, s66
  v_mfma_f32_16x16x32_bf16 v[36:39], v[144:147], v[212:215], v[36:39]
  ds_read_b64_tr_b16 v[144:145], v224 offset:58368
  ds_read_b64_tr_b16 v[146:147], v224 offset:62464
  v_mfma_f32_16x16x32_bf16 v[44:47], v[148:151], v[212:215], v[44:47]
  buffer_load_dwordx4 v[200:203], v233, s[24:27], s42 offen offset:0 sc1
  v_xor_b32 v224, 0x10000, v224
  v_mfma_f32_16x16x32_bf16 v[40:43], v[148:151], v[208:211], v[40:43]
  ds_read_b64_tr_b16 v[148:149], v225 offset:58368
  ds_read_b64_tr_b16 v[150:151], v225 offset:62464
  v_mfma_f32_16x16x32_bf16 v[48:51], v[152:155], v[208:211], v[48:51]
  buffer_load_dwordx4 v[204:207], v233, s[24:27], s42 offen offset:1024 sc1
  v_xor_b32 v225, 0x10000, v225
  v_mfma_f32_16x16x32_bf16 v[52:55], v[152:155], v[212:215], v[52:55]
  ds_read_b64_tr_b16 v[152:153], v226 offset:58368
  ds_read_b64_tr_b16 v[154:155], v226 offset:62464
  v_mfma_f32_16x16x32_bf16 v[60:63], v[156:159], v[212:215], v[60:63]
  s_add_u32 s42, s42, 4096
  s_waitcnt lgkmcnt(6)
  v_mfma_f32_16x16x32_bf16 v[56:59], v[156:159], v[208:211], v[56:59]
  ds_read_b64_tr_b16 v[156:157], v227 offset:58368
  ds_read_b64_tr_b16 v[158:159], v227 offset:62464
  s_waitcnt vmcnt(16)
  s_barrier
  v_mfma_f32_16x16x32_bf16 v[0:3], v[128:131], v[216:219], v[0:3]
  s_add_u32 m0, s43, 49152
  v_xor_b32 v226, 0x10000, v226
  v_mfma_f32_16x16x32_bf16 v[4:7], v[128:131], v[220:223], v[4:7]
  ds_read_b64_tr_b16 v[128:129], v224 offset:0
  ds_read_b64_tr_b16 v[130:131], v224 offset:4096
  v_mfma_f32_16x16x32_bf16 v[12:15], v[132:135], v[220:223], v[12:15]
  buffer_load_dwordx4 v228, s[20:23], s41 offen lds
  v_mfma_f32_16x16x32_bf16 v[8:11], v[132:135], v[216:219], v[8:11]
  ds_read_b64_tr_b16 v[132:133], v225 offset:0
  ds_read_b64_tr_b16 v[134:135], v225 offset:4096
  v_mfma_f32_16x16x32_bf16 v[16:19], v[136:139], v[216:219], v[16:19]
  s_add_u32 m0, s43, 50176
  v_xor_b32 v227, 0x10000, v227
  v_mfma_f32_16x16x32_bf16 v[20:23], v[136:139], v[220:223], v[20:23]
  ds_read_b64_tr_b16 v[136:137], v226 offset:0
  ds_read_b64_tr_b16 v[138:139], v226 offset:4096
  v_mfma_f32_16x16x32_bf16 v[28:31], v[140:143], v[220:223], v[28:31]
  buffer_load_dwordx4 v229, s[20:23], s41 offen lds
  s_waitcnt lgkmcnt(6)
  v_mfma_f32_16x16x32_bf16 v[24:27], v[140:143], v[216:219], v[24:27]
  ds_read_b64_tr_b16 v[140:141], v227 offset:0
  ds_read_b64_tr_b16 v[142:143], v227 offset:4096
  v_mfma_f32_16x16x32_bf16 v[32:35], v[144:147], v[216:219], v[32:35]
  s_add_u32 s41, s41, 65536
  v_mfma_f32_16x16x32_bf16 v[36:39], v[144:147], v[220:223], v[36:39]
  ds_read_b64_tr_b16 v[144:145], v224 offset:1024
  ds_read_b64_tr_b16 v[146:147], v224 offset:5120
  v_mfma_f32_16x16x32_bf16 v[44:47], v[148:151], v[220:223], v[44:47]
  buffer_load_dwordx4 v[208:211], v233, s[24:27], s42 offen offset:0 sc1
  v_mfma_f32_16x16x32_bf16 v[40:43], v[148:151], v[216:219], v[40:43]
  ds_read_b64_tr_b16 v[148:149], v225 offset:1024
  ds_read_b64_tr_b16 v[150:151], v225 offset:5120
  v_mfma_f32_16x16x32_bf16 v[48:51], v[152:155], v[216:219], v[48:51]
  buffer_load_dwordx4 v[212:215], v233, s[24:27], s42 offen offset:1024 sc1
  v_mfma_f32_16x16x32_bf16 v[52:55], v[152:155], v[220:223], v[52:55]
  ds_read_b64_tr_b16 v[152:153], v226 offset:1024
  ds_read_b64_tr_b16 v[154:155], v226 offset:5120
  v_mfma_f32_16x16x32_bf16 v[60:63], v[156:159], v[220:223], v[60:63]
  s_add_u32 s42, s42, 4096
  s_waitcnt lgkmcnt(6)
  v_mfma_f32_16x16x32_bf16 v[56:59], v[156:159], v[216:219], v[56:59]
  ds_read_b64_tr_b16 v[156:157], v227 offset:1024
  ds_read_b64_tr_b16 v[158:159], v227 offset:5120
  s_add_u32 s44, s44, 1
  s_cmp_lt_u32 s44, s77
  s_cbranch_scc1 G2_loop
G2_oph:
  s_mov_b32 s72, 0xbfb8aa3b
  v_mov_b32 v232, 0
  s_mov_b32 s48, s43
  s_waitcnt lgkmcnt(14)
  v_mfma_f32_16x16x32_bf16 v[64:67], v[128:131], v[160:163], 0
  ds_read_b64_tr_b16 v[144:145], v224 offset:8192
  ds_read_b64_tr_b16 v[146:147], v224 offset:12288
  v_mfma_f32_16x16x32_bf16 v[68:71], v[128:131], v[164:167], 0
  ds_read_b64_tr_b16 v[148:149], v225 offset:8192
  ds_read_b64_tr_b16 v[150:151], v225 offset:12288
  s_waitcnt lgkmcnt(15)
  v_mfma_f32_16x16x32_bf16 v[76:79], v[132:135], v[164:167], 0
  ds_read_b64_tr_b16 v[152:153], v226 offset:8192
  ds_read_b64_tr_b16 v[154:155], v226 offset:12288
  v_cvt_pk_bf16_f32 v32, v32, v33
  v_cvt_pk_bf16_f32 v33, v34, v35
  v_cvt_pk_bf16_f32 v34, v36, v37
  v_cvt_pk_bf16_f32 v35, v38, v39
  buffer_store_dwordx4 v[32:35], v233, s[84:87], s80 offen offset:0 sc1
  v_mfma_f32_16x16x32_bf16 v[72:75], v[132:135], v[160:163], 0
  ds_read_b64_tr_b16 v[156:157], v227 offset:8192
  ds_read_b64_tr_b16 v[158:159], v227 offset:12288
  v_cvt_pk_bf16_f32 v36, v40, v41
  v_cvt_pk_bf16_f32 v37, v42, v43
  v_cvt_pk_bf16_f32 v38, v44, v45
  v_cvt_pk_bf16_f32 v39, v46, v47
  buffer_store_dwordx4 v[36:39], v233, s[84:87], s80 offen offset:1024 sc1
  s_waitcnt lgkmcnt(15)
  v_mfma_f32_16x16x32_bf16 v[80:83], v[136:139], v[160:163], 0
  s_add_u32 m0, s43, 57344
  v_cvt_pk_bf16_f32 v40, v48, v49
  v_cvt_pk_bf16_f32 v41, v50, v51
  v_cvt_pk_bf16_f32 v42, v52, v53
  v_cvt_pk_bf16_f32 v43, v54, v55
  buffer_store_dwordx4 v[40:43], v233, s[84:87], s80 offen offset:2048 sc1
  v_mfma_f32_16x16x32_bf16 v[84:87], v[136:139], v[164:167], 0
  buffer_load_dwordx4 v228, s[20:23], s41 offen lds
  s_add_u32 s41, s41, 65536
  s_xor_b32 s43, s43, 0x10000
  v_cvt_pk_bf16_f32 v44, v56, v57
  v_cvt_pk_bf16_f32 v45, v58, v59
  v_cvt_pk_bf16_f32 v46, v60, v61
  v_cvt_pk_bf16_f32 v47, v62, v63
  buffer_store_dwordx4 v[44:47], v233, s[84:87], s80 offen offset:3072 sc1
  v_mfma_f32_16x16x32_bf16 v[92:95], v[140:143], v[164:167], 0
  buffer_load_dwordx4 v[216:219], v233, s[24:27], s42 offen offset:0 sc1
  v_mfma_f32_16x16x32_bf16 v[88:91], v[140:143], v[160:163], 0
  buffer_load_dwordx4 v[220:223], v233, s[24:27], s42 offen offset:1024 sc1
  s_add_u32 s42, s42, 4096
  s_waitcnt vmcnt(21)
  s_barrier
  s_waitcnt lgkmcnt(6)
  v_mfma_f32_16x16x32_bf16 v[64:67], v[144:147], v[168:171], v[64:67]
  ds_read_b64_tr_b16 v[128:129], v224 offset:16384
  ds_read_b64_tr_b16 v[130:131], v224 offset:20480
  v_accvgpr_read_b32 v238, a56
  v_mfma_f32_16x16x32_bf16 v[68:71], v[144:147], v[172:175], v[68:71]
  ds_read_b64_tr_b16 v[132:133], v225 offset:16384
  ds_read_b64_tr_b16 v[134:135], v225 offset:20480
  ds_bpermute_b32 v112, v234, v238 offset:0
  ds_bpermute_b32 v113, v234, v238 offset:4
  s_waitcnt lgkmcnt(10)
  v_mfma_f32_16x16x32_bf16 v[76:79], v[148:151], v[172:175], v[76:79]
  ds_read_b64_tr_b16 v[136:137], v226 offset:16384
  ds_read_b64_tr_b16 v[138:139], v226 offset:20480
  v_xor_b32 v239, 0, v235
  ds_read_b64 v[240:241], v239 offset:0
  ds_read_b64 v[242:243], v239 offset:2048
  v_mfma_f32_16x16x32_bf16 v[72:75], v[148:151], v[168:171], v[72:75]
  ds_read_b64_tr_b16 v[140:141], v227 offset:16384
  ds_read_b64_tr_b16 v[142:143], v227 offset:20480
  s_waitcnt lgkmcnt(12)
  v_mfma_f32_16x16x32_bf16 v[80:83], v[152:155], v[168:171], v[80:83]
  s_add_u32 m0, s43, 0
  v_mfma_f32_16x16x32_bf16 v[84:87], v[152:155], v[172:175], v[84:87]
  buffer_load_dwordx4 v228, s[20:23], s41 offen lds
  s_add_u32 s41, s41, 65536
  v_mfma_f32_16x16x32_bf16 v[92:95], v[156:159], v[172:175], v[92:95]
  buffer_load_dwordx4 v[160:163], v233, s[24:27], s42 offen offset:0 sc1
  v_mfma_f32_16x16x32_bf16 v[88:91], v[156:159], v[168:171], v[88:91]
  buffer_load_dwordx4 v[164:167], v233, s[24:27], s42 offen offset:1024 sc1
  s_add_u32 s42, s42, 4096
  s_waitcnt lgkmcnt(10)
  v_mfma_f32_16x16x32_bf16 v[64:67], v[128:131], v[176:179], v[64:67]
  ds_read_b64_tr_b16 v[144:145], v224 offset:24576
  ds_read_b64_tr_b16 v[146:147], v224 offset:28672
  v_mfma_f32_16x16x32_bf16 v[68:71], v[128:131], v[180:183], v[68:71]
  ds_read_b64_tr_b16 v[148:149], v225 offset:24576
  ds_read_b64_tr_b16 v[150:151], v225 offset:28672
  ds_bpermute_b32 v114, v234, v238 offset:32
  ds_bpermute_b32 v115, v234, v238 offset:36
  s_waitcnt lgkmcnt(14)
  v_mfma_f32_16x16x32_bf16 v[76:79], v[132:135], v[180:183], v[76:79]
  ds_read_b64_tr_b16 v[152:153], v226 offset:24576
  ds_read_b64_tr_b16 v[154:155], v226 offset:28672
  v_xor_b32 v239, 32, v235
  ds_read_b64 v[244:245], v239 offset:0
  ds_read_b64 v[246:247], v239 offset:2048
  v_mfma_f32_16x16x32_bf16 v[72:75], v[132:135], v[176:179], v[72:75]
  ds_read_b64_tr_b16 v[156:157], v227 offset:24576
  ds_read_b64_tr_b16 v[158:159], v227 offset:28672
  s_waitcnt lgkmcnt(12)
  v_mfma_f32_16x16x32_bf16 v[80:83], v[136:139], v[176:179], v[80:83]
  s_add_u32 m0, s43, 8192
  v_mfma_f32_16x16x32_bf16 v[84:87], v[136:139], v[180:183], v[84:87]
  buffer_load_dwordx4 v228, s[20:23], s41 offen lds
  s_add_u32 s41, s41, 65536
  v_mfma_f32_16x16x32_bf16 v[92:95], v[140:143], v[180:183], v[92:95]
  buffer_load_dwordx4 v[168:171], v233, s[24:27], s42 offen offset:0 sc1
  v_mfma_f32_16x16x32_bf16 v[88:91], v[140:143], v[176:179], v[88:91]
  buffer_load_dwordx4 v[172:175], v233, s[24:27], s42 offen offset:1024 sc1
  s_add_u32 s42, s42, 4096
  s_waitcnt vmcnt(19)
  s_barrier
  s_waitcnt lgkmcnt(10)
  v_mfma_f32_16x16x32_bf16 v[64:67], v[144:147], v[184:187], v[64:67]
  ds_read_b64_tr_b16 v[128:129], v224 offset:32768
  ds_read_b64_tr_b16 v[130:131], v224 offset:36864
  v_mfma_f32_16x16x32_bf16 v[68:71], v[144:147], v[188:191], v[68:71]
  ds_read_b64_tr_b16 v[132:133], v225 offset:32768
  ds_read_b64_tr_b16 v[134:135], v225 offset:36864
  ds_bpermute_b32 v116, v234, v238 offset:64
  ds_bpermute_b32 v117, v234, v238 offset:68
  s_waitcnt lgkmcnt(14)
  v_mfma_f32_16x16x32_bf16 v[76:79], v[148:151], v[188:191], v[76:79]
  ds_read_b64_tr_b16 v[136:137], v226 offset:32768
  ds_read_b64_tr_b16 v[138:139], v226 offset:36864
  v_xor_b32 v239, 64, v235
  ds_read_b64 v[248:249], v239 offset:0
  ds_read_b64 v[250:251], v239 offset:2048
  v_mfma_f32_16x16x32_bf16 v[72:75], v[148:151], v[184:187], v[72:75]
  ds_read_b64_tr_b16 v[140:141], v227 offset:32768
  ds_read_b64_tr_b16 v[142:143], v227 offset:36864
  s_waitcnt lgkmcnt(12)
  v_mfma_f32_16x16x32_bf16 v[80:83], v[152:155], v[184:187], v[80:83]
  s_add_u32 m0, s43, 16384
  v_mfma_f32_16x16x32_bf16 v[84:87], v[152:155], v[188:191], v[84:87]
  buffer_load_dwordx4 v228, s[20:23], s41 offen lds
  s_add_u32 s41, s41, 65536
  v_mfma_f32_16x16x32_bf16 v[92:95], v[156:159], v[188:191], v[92:95]
  buffer_load_dwordx4 v[176:179], v233, s[24:27], s42 offen offset:0 sc1
  v_mfma_f32_16x16x32_bf16 v[88:91], v[156:159], v[184:187], v[88:91]
  buffer_load_dwordx4 v[180:183], v233, s[24:27], s42 offen offset:1024 sc1
  s_add_u32 s42, s42, 4096
  s_waitcnt lgkmcnt(10)
  v_mfma_f32_16x16x32_bf16 v[64:67], v[128:131], v[192:195], v[64:67]
  ds_read_b64_tr_b16 v[144:145], v224 offset:40960
  ds_read_b64_tr_b16 v[146:147], v224 offset:45056
  v_mfma_f32_16x16x32_bf16 v[68:71], v[128:131], v[196:199], v[68:71]
  ds_read_b64_tr_b16 v[148:149], v225 offset:40960
  ds_read_b64_tr_b16 v[150:151], v225 offset:45056
  ds_bpermute_b32 v118, v234, v238 offset:96
  ds_bpermute_b32 v119, v234, v238 offset:100
  s_waitcnt lgkmcnt(14)
  v_mfma_f32_16x16x32_bf16 v[76:79], v[132:135], v[196:199], v[76:79]
  ds_read_b64_tr_b16 v[152:153], v226 offset:40960
  ds_read_b64_tr_b16 v[154:155], v226 offset:45056
  v_xor_b32 v239, 96, v235
  ds_read_b64 v[252:253], v239 offset:0
  ds_read_b64 v[254:255], v239 offset:2048
  v_mfma_f32_16x16x32_bf16 v[72:75], v[132:135], v[192:195], v[72:75]
  ds_read_b64_tr_b16 v[156:157], v227 offset:40960
  ds_read_b64_tr_b16 v[158:159], v227 offset:45056
  s_waitcnt lgkmcnt(12)
  v_mfma_f32_16x16x32_bf16 v[80:83], v[136:139], v[192:195], v[80:83]
  s_add_u32 m0, s43, 24576
  v_mfma_f32_16x16x32_bf16 v[84:87], v[136:139], v[196:199], v[84:87]
  buffer_load_dwordx4 v228, s[20:23], s41 offen lds
  s_add_u32 s41, s41, 65536
  v_mfma_f32_16x16x32_bf16 v[92:95], v[140:143], v[196:199], v[92:95]
  buffer_load_dwordx4 v[184:187], v233, s[24:27], s42 offen offset:0 sc1
  v_mfma_f32_16x16x32_bf16 v[88:91], v[140:143], v[192:195], v[88:91]
  buffer_load_dwordx4 v[188:191], v233, s[24:27], s42 offen offset:1024 sc1
  s_add_u32 s42, s42, 4096
  s_waitcnt vmcnt(14)
  s_barrier
  s_cmp_lg_u32 s40, 0
  s_cbranch_scc1 G2_nofl
  v_mov_b32 v236, s3
  s_mov_b64 exec, 1
  buffer_store_dword v236, v232, s[84:87], s62 offen sc1
  s_mov_b64 exec, -1
G2_nofl:
  s_waitcnt lgkmcnt(10)
  v_mfma_f32_16x16x32_bf16 v[64:67], v[144:147], v[200:203], v[64:67]
  ds_read_b64_tr_b16 v[128:129], v224 offset:49152
  ds_read_b64_tr_b16 v[130:131], v224 offset:53248
  v_mfma_f32_16x16x32_bf16 v[68:71], v[144:147], v[204:207], v[68:71]
  ds_read_b64_tr_b16 v[132:133], v225 offset:49152
  ds_read_b64_tr_b16 v[134:135], v225 offset:53248
  s_waitcnt lgkmcnt(12)
  v_mfma_f32_16x16x32_bf16 v[76:79], v[148:151], v[204:207], v[76:79]
  ds_read_b64_tr_b16 v[136:137], v226 offset:49152
  ds_read_b64_tr_b16 v[138:139], v226 offset:53248
  v_mfma_f32_16x16x32_bf16 v[72:75], v[148:151], v[200:203], v[72:75]
  ds_read_b64_tr_b16 v[140:141], v227 offset:49152
  ds_read_b64_tr_b16 v[142:143], v227 offset:53248
  s_waitcnt lgkmcnt(8)
  v_mfma_f32_16x16x32_bf16 v[80:83], v[152:155], v[200:203], v[80:83]
  s_add_u32 m0, s43, 32768
  v_mfma_f32_16x16x32_bf16 v[84:87], v[152:155], v[204:207], v[84:87]
  buffer_load_dwordx4 v228, s[20:23], s41 offen lds
  s_add_u32 s41, s41, 65536
  v_mfma_f32_16x16x32_bf16 v[92:95], v[156:159], v[204:207], v[92:95]
  buffer_load_dwordx4 v[192:195], v233, s[24:27], s42 offen offset:0 sc1
  v_mfma_f32_16x16x32_bf16 v[88:91], v[156:159], v[200:203], v[88:91]
  buffer_load_dwordx4 v[196:199], v233, s[24:27], s42 offen offset:1024 sc1
  s_add_u32 s42, s42, 4096
  s_waitcnt lgkmcnt(10)
  s_waitcnt lgkmcnt(6)
  v_mfma_f32_16x16x32_bf16 v[64:67], v[128:131], v[208:211], v[64:67]
  ds_read_b64_tr_b16 v[144:145], v224 offset:57344
  ds_read_b64_tr_b16 v[146:147], v224 offset:61440
  v_lshlrev_b32 v236, 16, v112
  v_mfma_f32_16x16x32_bf16 v[68:71], v[128:131], v[212:215], v[68:71]
  ds_read_b64_tr_b16 v[148:149], v225 offset:57344
  ds_read_b64_tr_b16 v[150:151], v225 offset:61440
  v_and_b32 v237, 0xffff0000, v112
  s_waitcnt lgkmcnt(8)
  v_mfma_f32_16x16x32_bf16 v[76:79], v[132:135], v[212:215], v[76:79]
  ds_read_b64_tr_b16 v[152:153], v226 offset:57344
  ds_read_b64_tr_b16 v[154:155], v226 offset:61440
  v_add_f32 v0, v0, v236
  v_mfma_f32_16x16x32_bf16 v[72:75], v[132:135], v[208:211], v[72:75]
  ds_read_b64_tr_b16 v[156:157], v227 offset:57344
  ds_read_b64_tr_b16 v[158:159], v227 offset:61440
  v_add_f32 v1, v1, v237
  v_add_f32 v4, v4, v236
  s_waitcnt lgkmcnt(8)
  v_mfma_f32_16x16x32_bf16 v[80:83], v[136:139], v[208:211], v[80:83]
  v_xor_b32 v224, 0x10000, v224
  s_add_u32 m0, s43, 40960
  v_add_f32 v5, v5, v237
  v_mfma_f32_16x16x32_bf16 v[84:87], v[136:139], v[212:215], v[84:87]
  v_xor_b32 v225, 0x10000, v225
  buffer_load_dwordx4 v228, s[20:23], s41 offen lds
  s_add_u32 s41, s41, 65536
  v_lshlrev_b32 v236, 16, v113
  v_mfma_f32_16x16x32_bf16 v[92:95], v[140:143], v[212:215], v[92:95]
  v_xor_b32 v226, 0x10000, v226
  buffer_load_dwordx4 v[200:203], v233, s[24:27], s42 offen offset:0 sc1
  v_and_b32 v237, 0xffff0000, v113
  v_mfma_f32_16x16x32_bf16 v[88:91], v[140:143], v[208:211], v[88:91]
  v_xor_b32 v227, 0x10000, v227
  buffer_load_dwordx4 v[204:207], v233, s[24:27], s42 offen offset:1024 sc1
  s_add_u32 s42, s42, 4096
  v_add_f32 v2, v2, v236
  v_add_f32 v3, v3, v237
  s_waitcnt vmcnt(14)
  s_barrier
  s_waitcnt lgkmcnt(6)
  v_mfma_f32_16x16x32_bf16 v[64:67], v[144:147], v[216:219], v[64:67]
  ds_read_b64_tr_b16 v[128:129], v224 offset:0
  ds_read_b64_tr_b16 v[130:131], v224 offset:4096
  v_add_f32 v6, v6, v236
  v_mfma_f32_16x16x32_bf16 v[68:71], v[144:147], v[220:223], v[68:71]
  ds_read_b64_tr_b16 v[132:133], v225 offset:0
  ds_read_b64_tr_b16 v[134:135], v225 offset:4096
  v_add_f32 v7, v7, v237
  s_waitcnt lgkmcnt(8)
  v_mfma_f32_16x16x32_bf16 v[76:79], v[148:151], v[220:223], v[76:79]
  ds_read_b64_tr_b16 v[136:137], v226 offset:0
  ds_read_b64_tr_b16 v[138:139], v226 offset:4096
  v_lshlrev_b32 v236, 16, v114
  v_mfma_f32_16x16x32_bf16 v[72:75], v[148:151], v[216:219], v[72:75]
  ds_read_b64_tr_b16 v[140:141], v227 offset:0
  ds_read_b64_tr_b16 v[142:143], v227 offset:4096
  v_and_b32 v237, 0xffff0000, v114
  v_add_f32 v8, v8, v236
  s_waitcnt lgkmcnt(8)
  v_mfma_f32_16x16x32_bf16 v[80:83], v[152:155], v[216:219], v[80:83]
  s_add_u32 m0, s43, 49152
  v_add_f32 v9, v9, v237
  v_mfma_f32_16x16x32_bf16 v[84:87], v[152:155], v[220:223], v[84:87]
  buffer_load_dwordx4 v228, s[20:23], s41 offen lds
  s_add_u32 s41, s41, 65536
  v_add_f32 v12, v12, v236
  v_mfma_f32_16x16x32_bf16 v[92:95], v[156:159], v[220:223], v[92:95]
  buffer_load_dwordx4 v[208:211], v233, s[24:27], s42 offen offset:0 sc1
  v_add_f32 v13, v13, v237
  v_mfma_f32_16x16x32_bf16 v[88:91], v[156:159], v[216:219], v[88:91]
  buffer_load_dwordx4 v[212:215], v233, s[24:27], s42 offen offset:1024 sc1
  s_add_u32 s42, s42, 4096
  v_lshlrev_b32 v236, 16, v115
  v_and_b32 v237, 0xffff0000, v115
  s_waitcnt lgkmcnt(6)
  v_mfma_f32_16x16x32_bf16 v[64:67], v[128:131], v[160:163], v[64:67]
  ds_read_b64_tr_b16 v[144:145], v224 offset:8192
  ds_read_b64_tr_b16 v[146:147], v224 offset:12288
  v_add_f32 v10, v10, v236
  v_mfma_f32_16x16x32_bf16 v[68:71], v[128:131], v[164:167], v[68:71]
  ds_read_b64_tr_b16 v[148:149], v225 offset:8192
  ds_read_b64_tr_b16 v[150:151], v225 offset:12288
  v_add_f32 v11, v11, v237
  s_waitcnt lgkmcnt(8)
  v_mfma_f32_16x16x32_bf16 v[76:79], v[132:135], v[164:167], v[76:79]
  ds_read_b64_tr_b16 v[152:153], v226 offset:8192
  ds_read_b64_tr_b16 v[154:155], v226 offset:12288
  v_add_f32 v14, v14, v236
  v_mfma_f32_16x16x32_bf16 v[72:75], v[132:135], v[160:163], v[72:75]
  ds_read_b64_tr_b16 v[156:157], v227 offset:8192
  ds_read_b64_tr_b16 v[158:159], v227 offset:12288
  v_add_f32 v15, v15, v237
  v_lshlrev_b32 v236, 16, v116
  s_waitcnt lgkmcnt(8)
  v_mfma_f32_16x16x32_bf16 v[80:83], v[136:139], v[160:163], v[80:83]
  s_add_u32 m0, s43, 57344
  v_and_b32 v237, 0xffff0000, v116
  v_mfma_f32_16x16x32_bf16 v[84:87], v[136:139], v[164:167], v[84:87]
  buffer_load_dwordx4 v228, s[20:23], s41 offen lds
  s_add_u32 s41, s41, 65536
  s_xor_b32 s43, s43, 0x10000
  v_add_f32 v16, v16, v236
  v_mfma_f32_16x16x32_bf16 v[92:95], v[140:143], v[164:167], v[92:95]
  buffer_load_dwordx4 v[216:219], v233, s[24:27], s42 offen offset:0 sc1
  v_add_f32 v17, v17, v237
  v_mfma_f32_16x16x32_bf16 v[88:91], v[140:143], v[160:163], v[88:91]
  buffer_load_dwordx4 v[220:223], v233, s[24:27], s42 offen offset:1024 sc1
  s_add_u32 s42, s42, 4096
  v_add_f32 v20, v20, v236
  v_add_f32 v21, v21, v237
  s_waitcnt vmcnt(14)
  s_barrier
  s_waitcnt lgkmcnt(6)
  v_mfma_f32_16x16x32_bf16 v[64:67], v[144:147], v[168:171], v[64:67]
  ds_read_b64_tr_b16 v[128:129], v224 offset:16384
  ds_read_b64_tr_b16 v[130:131], v224 offset:20480
  v_lshlrev_b32 v236, 16, v117
  v_mfma_f32_16x16x32_bf16 v[68:71], v[144:147], v[172:175], v[68:71]
  ds_read_b64_tr_b16 v[132:133], v225 offset:16384
  ds_read_b64_tr_b16 v[134:135], v225 offset:20480
  v_and_b32 v237, 0xffff0000, v117
  s_waitcnt lgkmcnt(8)
  v_mfma_f32_16x16x32_bf16 v[76:79], v[148:151], v[172:175], v[76:79]
  ds_read_b64_tr_b16 v[136:137], v226 offset:16384
  ds_read_b64_tr_b16 v[138:139], v226 offset:20480
  v_add_f32 v18, v18, v236
  v_mfma_f32_16x16x32_bf16 v[72:75], v[148:151], v[168:171], v[72:75]
  ds_read_b64_tr_b16 v[140:141], v227 offset:16384
  ds_read_b64_tr_b16 v[142:143], v227 offset:20480
  s_mov_b32 s43, s48
  s_mov_b32 s41, 458752
  v_add_f32 v19, v19, v237
  v_add_f32 v22, v22, v236
  s_waitcnt lgkmcnt(8)
  v_mfma_f32_16x16x32_bf16 v[80:83], v[152:155], v[168:171], v[80:83]
  s_add_u32 m0, s43, 58368
  v_add_f32 v23, v23, v237
  v_mfma_f32_16x16x32_bf16 v[84:87], v[152:155], v[172:175], v[84:87]
  buffer_load_dwordx4 v229, s[20:23], s41 offen lds
  s_add_u32 s41, s41, 65536
  s_xor_b32 s43, s43, 0x10000
  v_lshlrev_b32 v236, 16, v118
  v_mfma_f32_16x16x32_bf16 v[92:95], v[156:159], v[172:175], v[92:95]
  buffer_load_dwordx4 v[160:163], v233, s[24:27], s42 offen offset:0 sc1
  v_and_b32 v237, 0xffff0000, v118
  v_mfma_f32_16x16x32_bf16 v[88:91], v[156:159], v[168:171], v[88:91]
  buffer_load_dwordx4 v[164:167], v233, s[24:27], s42 offen offset:1024 sc1
  s_add_u32 s42, s42, 4096
  v_add_f32 v24, v24, v236
  v_add_f32 v25, v25, v237
  s_waitcnt lgkmcnt(6)
  v_mfma_f32_16x16x32_bf16 v[64:67], v[128:131], v[176:179], v[64:67]
  ds_read_b64_tr_b16 v[144:145], v224 offset:24576
  ds_read_b64_tr_b16 v[146:147], v224 offset:28672
  v_add_f32 v28, v28, v236
  v_mfma_f32_16x16x32_bf16 v[68:71], v[128:131], v[180:183], v[68:71]
  ds_read_b64_tr_b16 v[148:149], v225 offset:24576
  ds_read_b64_tr_b16 v[150:151], v225 offset:28672
  v_add_f32 v29, v29, v237
  s_waitcnt lgkmcnt(8)
  v_mfma_f32_16x16x32_bf16 v[76:79], v[132:135], v[180:183], v[76:79]
  ds_read_b64_tr_b16 v[152:153], v226 offset:24576
  ds_read_b64_tr_b16 v[154:155], v226 offset:28672
  v_lshlrev_b32 v236, 16, v119
  v_mfma_f32_16x16x32_bf16 v[72:75], v[132:135], v[176:179], v[72:75]
  ds_read_b64_tr_b16 v[156:157], v227 offset:24576
  ds_read_b64_tr_b16 v[158:159], v227 offset:28672
  v_and_b32 v237, 0xffff0000, v119
  v_add_f32 v26, v26, v236
  s_waitcnt lgkmcnt(8)
  v_mfma_f32_16x16x32_bf16 v[80:83], v[136:139], v[176:179], v[80:83]
  s_add_u32 m0, s43, 1024
  v_add_f32 v27, v27, v237
  v_mfma_f32_16x16x32_bf16 v[84:87], v[136:139], v[180:183], v[84:87]
  buffer_load_dwordx4 v229, s[20:23], s41 offen lds
  s_add_u32 s41, s41, 65536
  v_add_f32 v30, v30, v236
  v_mfma_f32_16x16x32_bf16 v[92:95], v[140:143], v[180:183], v[92:95]
  buffer_load_dwordx4 v[168:171], v233, s[24:27], s42 offen offset:0 sc1
  v_add_f32 v31, v31, v237
  v_mfma_f32_16x16x32_bf16 v[88:91], v[140:143], v[176:179], v[88:91]
  buffer_load_dwordx4 v[172:175], v233, s[24:27], s42 offen offset:1024 sc1
  s_add_u32 s42, s42, 4096
  buffer_load_dword v231, v232, s[84:87], s75 offen sc1
  v_lshlrev_b32 v32, 16, v240
  v_and_b32 v33, 0xffff0000, v240
  s_waitcnt vmcnt(15)
  s_barrier
  s_waitcnt lgkmcnt(6)
  v_mfma_f32_16x16x32_bf16 v[64:67], v[144:147], v[184:187], v[64:67]
  ds_read_b64_tr_b16 v[128:129], v224 offset:32768
  ds_read_b64_tr_b16 v[130:131], v224 offset:36864
  v_lshlrev_b32 v34, 16, v241
  v_mfma_f32_16x16x32_bf16 v[68:71], v[144:147], v[188:191], v[68:71]
  ds_read_b64_tr_b16 v[132:133], v225 offset:32768
  ds_read_b64_tr_b16 v[134:135], v225 offset:36864
  v_and_b32 v35, 0xffff0000, v241
  s_waitcnt lgkmcnt(8)
  v_mfma_f32_16x16x32_bf16 v[76:79], v[148:151], v[188:191], v[76:79]
  ds_read_b64_tr_b16 v[136:137], v226 offset:32768
  ds_read_b64_tr_b16 v[138:139], v226 offset:36864
  v_lshlrev_b32 v36, 16, v242
  v_mfma_f32_16x16x32_bf16 v[72:75], v[148:151], v[184:187], v[72:75]
  ds_read_b64_tr_b16 v[140:141], v227 offset:32768
  ds_read_b64_tr_b16 v[142:143], v227 offset:36864
  v_and_b32 v37, 0xffff0000, v242
  v_lshlrev_b32 v38, 16, v243
  s_waitcnt lgkmcnt(8)
  v_mfma_f32_16x16x32_bf16 v[80:83], v[152:155], v[184:187], v[80:83]
  s_add_u32 m0, s43, 9216
  v_and_b32 v39, 0xffff0000, v243
  v_mfma_f32_16x16x32_bf16 v[84:87], v[152:155], v[188:191], v[84:87]
  buffer_load_dwordx4 v229, s[20:23], s41 offen lds
  s_add_u32 s41, s41, 65536
  v_lshlrev_b32 v40, 16, v244
  v_mfma_f32_16x16x32_bf16 v[92:95], v[156:159], v[188:191], v[92:95]
  buffer_load_dwordx4 v[176:179], v233, s[24:27], s42 offen offset:0 sc1
  v_and_b32 v41, 0xffff0000, v244
  v_mfma_f32_16x16x32_bf16 v[88:91], v[156:159], v[184:187], v[88:91]
  buffer_load_dwordx4 v[180:183], v233, s[24:27], s42 offen offset:1024 sc1
  s_add_u32 s42, s42, 4096
  v_lshlrev_b32 v42, 16, v245
  v_and_b32 v43, 0xffff0000, v245
  s_waitcnt lgkmcnt(6)
  v_mfma_f32_16x16x32_bf16 v[64:67], v[128:131], v[192:195], v[64:67]
  ds_read_b64_tr_b16 v[144:145], v224 offset:40960
  ds_read_b64_tr_b16 v[146:147], v224 offset:45056
  v_lshlrev_b32 v44, 16, v246
  v_mfma_f32_16x16x32_bf16 v[68:71], v[128:131], v[196:199], v[68:71]
  ds_read_b64_tr_b16 v[148:149], v225 offset:40960
  ds_read_b64_tr_b16 v[150:151], v225 offset:45056
  v_and_b32 v45, 0xffff0000, v246
  s_waitcnt lgkmcnt(8)
  v_mfma_f32_16x16x32_bf16 v[76:79], v[132:135], v[196:199], v[76:79]
  ds_read_b64_tr_b16 v[152:153], v226 offset:40960
  ds_read_b64_tr_b16 v[154:155], v226 offset:45056
  v_lshlrev_b32 v46, 16, v247
  v_mfma_f32_16x16x32_bf16 v[72:75], v[132:135], v[192:195], v[72:75]
  ds_read_b64_tr_b16 v[156:157], v227 offset:40960
  ds_read_b64_tr_b16 v[158:159], v227 offset:45056
  v_and_b32 v47, 0xffff0000, v247
  v_lshlrev_b32 v48, 16, v248
  s_waitcnt lgkmcnt(8)
  v_mfma_f32_16x16x32_bf16 v[80:83], v[136:139], v[192:195], v[80:83]
  s_add_u32 m0, s43, 17408
  v_and_b32 v49, 0xffff0000, v248
  v_mfma_f32_16x16x32_bf16 v[84:87], v[136:139], v[196:199], v[84:87]
  buffer_load_dwordx4 v229, s[20:23], s41 offen lds
  s_add_u32 s41, s41, 65536
  v_lshlrev_b32 v50, 16, v249
  v_mfma_f32_16x16x32_bf16 v[92:95], v[140:143], v[196:199], v[92:95]
  buffer_load_dwordx4 v[184:187], v233, s[24:27], s42 offen offset:0 sc1
  v_and_b32 v51, 0xffff0000, v249
  v_mfma_f32_16x16x32_bf16 v[88:91], v[140:143], v[192:195], v[88:91]
  buffer_load_dwordx4 v[188:191], v233, s[24:27], s42 offen offset:1024 sc1
  s_add_u32 s42, s42, 4096
  v_lshlrev_b32 v52, 16, v250
  v_and_b32 v53, 0xffff0000, v250
  s_waitcnt vmcnt(15)
  s_barrier
  s_waitcnt lgkmcnt(6)
  v_mfma_f32_16x16x32_bf16 v[64:67], v[144:147], v[200:203], v[64:67]
  ds_read_b64_tr_b16 v[128:129], v224 offset:49152
  ds_read_b64_tr_b16 v[130:131], v224 offset:53248
  v_lshlrev_b32 v54, 16, v251
  v_mfma_f32_16x16x32_bf16 v[68:71], v[144:147], v[204:207], v[68:71]
  ds_read_b64_tr_b16 v[132:133], v225 offset:49152
  ds_read_b64_tr_b16 v[134:135], v225 offset:53248
  v_and_b32 v55, 0xffff0000, v251
  s_waitcnt lgkmcnt(8)
  v_mfma_f32_16x16x32_bf16 v[76:79], v[148:151], v[204:207], v[76:79]
  ds_read_b64_tr_b16 v[136:137], v226 offset:49152
  ds_read_b64_tr_b16 v[138:139], v226 offset:53248
  v_lshlrev_b32 v56, 16, v252
  v_mfma_f32_16x16x32_bf16 v[72:75], v[148:151], v[200:203], v[72:75]
  ds_read_b64_tr_b16 v[140:141], v227 offset:49152
  ds_read_b64_tr_b16 v[142:143], v227 offset:53248
  v_and_b32 v57, 0xffff0000, v252
  v_lshlrev_b32 v58, 16, v253
  s_waitcnt lgkmcnt(8)
  v_mfma_f32_16x16x32_bf16 v[80:83], v[152:155], v[200:203], v[80:83]
  s_add_u32 m0, s43, 25600
  v_and_b32 v59, 0xffff0000, v253
  v_mfma_f32_16x16x32_bf16 v[84:87], v[152:155], v[204:207], v[84:87]
  buffer_load_dwordx4 v229, s[20:23], s41 offen lds
  s_add_u32 s41, s41, 65536
  v_lshlrev_b32 v60, 16, v254
  v_mfma_f32_16x16x32_bf16 v[92:95], v[156:159], v[204:207], v[92:95]
  buffer_load_dwordx4 v[192:195], v233, s[24:27], s42 offen offset:0 sc1
  v_and_b32 v61, 0xffff0000, v254
  v_mfma_f32_16x16x32_bf16 v[88:91], v[156:159], v[200:203], v[88:91]
  buffer_load_dwordx4 v[196:199], v233, s[24:27], s42 offen offset:1024 sc1
  s_add_u32 s42, s42, 4096
  v_lshlrev_b32 v62, 16, v255
  v_and_b32 v63, 0xffff0000, v255
  s_waitcnt vmcnt(9)
  v_cmp_ne_u32 vcc, s3, v231
  s_nop 1
  s_and_b64 vcc, vcc, -1
  s_cbranch_scc1 G2_pspin
G2_pgo:
  s_waitcnt lgkmcnt(6)
  v_mfma_f32_16x16x32_bf16 v[64:67], v[128:131], v[208:211], v[64:67]
  ds_read_b64_tr_b16 v[144:145], v224 offset:57344
  ds_read_b64_tr_b16 v[146:147], v224 offset:61440
  v_mfma_f32_16x16x32_bf16 v[68:71], v[128:131], v[212:215], v[68:71]
  ds_read_b64_tr_b16 v[148:149], v225 offset:57344
  ds_read_b64_tr_b16 v[150:151], v225 offset:61440
  s_waitcnt lgkmcnt(8)
  v_mfma_f32_16x16x32_bf16 v[76:79], v[132:135], v[212:215], v[76:79]
  ds_read_b64_tr_b16 v[152:153], v226 offset:57344
  ds_read_b64_tr_b16 v[154:155], v226 offset:61440
  v_mfma_f32_16x16x32_bf16 v[72:75], v[132:135], v[208:211], v[72:75]
  ds_read_b64_tr_b16 v[156:157], v227 offset:57344
  ds_read_b64_tr_b16 v[158:159], v227 offset:61440
  buffer_load_dwordx4 v[112:115], v233, s[84:87], s81 offen offset:0 sc1
  s_waitcnt lgkmcnt(8)
  v_mfma_f32_16x16x32_bf16 v[80:83], v[136:139], v[208:211], v[80:83]
  v_xor_b32 v224, 0x10000, v224
  s_add_u32 m0, s43, 33792
  buffer_load_dwordx4 v[116:119], v233, s[84:87], s81 offen offset:1024 sc1
  v_mfma_f32_16x16x32_bf16 v[84:87], v[136:139], v[212:215], v[84:87]
  v_xor_b32 v225, 0x10000, v225
  buffer_load_dwordx4 v229, s[20:23], s41 offen lds
  s_add_u32 s41, s41, 65536
  v_mfma_f32_16x16x32_bf16 v[92:95], v[140:143], v[212:215], v[92:95]
  v_xor_b32 v226, 0x10000, v226
  buffer_load_dwordx4 v[200:203], v233, s[24:27], s42 offen offset:0 sc1
  v_mfma_f32_16x16x32_bf16 v[88:91], v[140:143], v[208:211], v[88:91]
  v_xor_b32 v227, 0x10000, v227
  buffer_load_dwordx4 v[204:207], v233, s[24:27], s42 offen offset:1024 sc1
  s_add_u32 s42, s42, 4096
  s_waitcnt vmcnt(18)
  s_waitcnt lgkmcnt(6)
  v_mfma_f32_16x16x32_bf16 v[64:67], v[144:147], v[216:219], v[64:67]
  ds_read_b64_tr_b16 v[128:129], v224 offset:1024
  ds_read_b64_tr_b16 v[130:131], v224 offset:5120
  v_mfma_f32_16x16x32_bf16 v[68:71], v[144:147], v[220:223], v[68:71]
  ds_read_b64_tr_b16 v[132:133], v225 offset:1024
  ds_read_b64_tr_b16 v[134:135], v225 offset:5120
  s_waitcnt lgkmcnt(8)
  v_mfma_f32_16x16x32_bf16 v[76:79], v[148:151], v[220:223], v[76:79]
  ds_read_b64_tr_b16 v[136:137], v226 offset:1024
  ds_read_b64_tr_b16 v[138:139], v226 offset:5120
  v_mfma_f32_16x16x32_bf16 v[72:75], v[148:151], v[216:219], v[72:75]
  ds_read_b64_tr_b16 v[140:141], v227 offset:1024
  ds_read_b64_tr_b16 v[142:143], v227 offset:5120
  buffer_load_dwordx4 v[120:123], v233, s[84:87], s81 offen offset:2048 sc1
  s_waitcnt lgkmcnt(8)
  v_mfma_f32_16x16x32_bf16 v[80:83], v[152:155], v[216:219], v[80:83]
  s_add_u32 m0, s43, 41984
  buffer_load_dwordx4 v[124:127], v233, s[84:87], s81 offen offset:3072 sc1
  v_mfma_f32_16x16x32_bf16 v[84:87], v[152:155], v[220:223], v[84:87]
  buffer_load_dwordx4 v229, s[20:23], s41 offen lds
  s_add_u32 s41, s41, 65536
  v_mfma_f32_16x16x32_bf16 v[92:95], v[156:159], v[220:223], v[92:95]
  buffer_load_dwordx4 v[208:211], v233, s[24:27], s42 offen offset:0 sc1
  v_mfma_f32_16x16x32_bf16 v[88:91], v[156:159], v[216:219], v[88:91]
  buffer_load_dwordx4 v[212:215], v233, s[24:27], s42 offen offset:1024 sc1
  s_add_u32 s42, s42, 4096
  s_waitcnt lgkmcnt(6)
  v_mfma_f32_16x16x32_bf16 v[64:67], v[128:131], v[160:163], v[64:67]
  ds_read_b64_tr_b16 v[144:145], v224 offset:9216
  ds_read_b64_tr_b16 v[146:147], v224 offset:13312
  v_mfma_f32_16x16x32_bf16 v[68:71], v[128:131], v[164:167], v[68:71]
  ds_read_b64_tr_b16 v[148:149], v225 offset:9216
  ds_read_b64_tr_b16 v[150:151], v225 offset:13312
  s_waitcnt lgkmcnt(8)
  v_mfma_f32_16x16x32_bf16 v[76:79], v[132:135], v[164:167], v[76:79]
  ds_read_b64_tr_b16 v[152:153], v226 offset:9216
  ds_read_b64_tr_b16 v[154:155], v226 offset:13312
  v_mfma_f32_16x16x32_bf16 v[72:75], v[132:135], v[160:163], v[72:75]
  ds_read_b64_tr_b16 v[156:157], v227 offset:9216
  ds_read_b64_tr_b16 v[158:159], v227 offset:13312
  s_waitcnt lgkmcnt(8)
  v_mfma_f32_16x16x32_bf16 v[80:83], v[136:139], v[160:163], v[80:83]
  s_add_u32 m0, s43, 50176
  v_mfma_f32_16x16x32_bf16 v[84:87], v[136:139], v[164:167], v[84:87]
  buffer_load_dwordx4 v229, s[20:23], s41 offen lds
  s_add_u32 s41, s41, 65536
  v_mfma_f32_16x16x32_bf16 v[92:95], v[140:143], v[164:167], v[92:95]
  buffer_load_dwordx4 v[216:219], v233, s[24:27], s42 offen offset:0 sc1
  v_mfma_f32_16x16x32_bf16 v[88:91], v[140:143], v[160:163], v[88:91]
  buffer_load_dwordx4 v[220:223], v233, s[24:27], s42 offen offset:1024 sc1
  s_add_u32 s42, s42, 4096
  s_waitcnt vmcnt(19)
  s_waitcnt lgkmcnt(6)
  v_mfma_f32_16x16x32_bf16 v[64:67], v[144:147], v[168:171], v[64:67]
  ds_read_b64_tr_b16 v[128:129], v224 offset:17408
  ds_read_b64_tr_b16 v[130:131], v224 offset:21504
  v_mfma_f32_16x16x32_bf16 v[68:71], v[144:147], v[172:175], v[68:71]
  ds_read_b64_tr_b16 v[132:133], v225 offset:17408
  ds_read_b64_tr_b16 v[134:135], v225 offset:21504
  s_waitcnt lgkmcnt(8)
  v_mfma_f32_16x16x32_bf16 v[76:79], v[148:151], v[172:175], v[76:79]
  ds_read_b64_tr_b16 v[136:137], v226 offset:17408
  ds_read_b64_tr_b16 v[138:139], v226 offset:21504
  v_mfma_f32_16x16x32_bf16 v[72:75], v[148:151], v[168:171], v[72:75]
  ds_read_b64_tr_b16 v[140:141], v227 offset:17408
  ds_read_b64_tr_b16 v[142:143], v227 offset:21504
  s_waitcnt lgkmcnt(8)
  v_mfma_f32_16x16x32_bf16 v[80:83], v[152:155], v[168:171], v[80:83]
  s_add_u32 m0, s43, 58368
  v_mfma_f32_16x16x32_bf16 v[84:87], v[152:155], v[172:175], v[84:87]
  buffer_load_dwordx4 v229, s[20:23], s41 offen lds
  s_add_u32 s41, s41, 65536
  s_xor_b32 s43, s43, 0x10000
  v_mfma_f32_16x16x32_bf16 v[92:95], v[156:159], v[172:175], v[92:95]
  buffer_load_dwordx4 v[160:163], v233, s[24:27], s42 offen offset:0 sc1
  v_mfma_f32_16x16x32_bf16 v[88:91], v[156:159], v[168:171], v[88:91]
  buffer_load_dwordx4 v[164:167], v233, s[24:27], s42 offen offset:1024 sc1
  s_add_u32 s42, s42, 4096
  s_waitcnt lgkmcnt(6)
  v_mfma_f32_16x16x32_bf16 v[64:67], v[128:131], v[176:179], v[64:67]
  ds_read_b64_tr_b16 v[144:145], v224 offset:25600
  ds_read_b64_tr_b16 v[146:147], v224 offset:29696
  v_mfma_f32_16x16x32_bf16 v[68:71], v[128:131], v[180:183], v[68:71]
  ds_read_b64_tr_b16 v[148:149], v225 offset:25600
  ds_read_b64_tr_b16 v[150:151], v225 offset:29696
  s_waitcnt lgkmcnt(8)
  v_mfma_f32_16x16x32_bf16 v[76:79], v[132:135], v[180:183], v[76:79]
  ds_read_b64_tr_b16 v[152:153], v226 offset:25600
  ds_read_b64_tr_b16 v[154:155], v226 offset:29696
  v_mfma_f32_16x16x32_bf16 v[72:75], v[132:135], v[176:179], v[72:75]
  ds_read_b64_tr_b16 v[156:157], v227 offset:25600
  ds_read_b64_tr_b16 v[158:159], v227 offset:29696
  s_waitcnt lgkmcnt(8)
  v_mfma_f32_16x16x32_bf16 v[80:83], v[136:139], v[176:179], v[80:83]
  v_mfma_f32_16x16x32_bf16 v[84:87], v[136:139], v[180:183], v[84:87]
  v_mfma_f32_16x16x32_bf16 v[92:95], v[140:143], v[180:183], v[92:95]
  buffer_load_dwordx4 v[168:171], v233, s[24:27], s42 offen offset:0 sc1
  v_mfma_f32_16x16x32_bf16 v[88:91], v[140:143], v[176:179], v[88:91]
  buffer_load_dwordx4 v[172:175], v233, s[24:27], s42 offen offset:1024 sc1
  s_add_u32 s42, s42, 4096
  s_waitcnt vmcnt(18)
  s_waitcnt lgkmcnt(6)
  v_mfma_f32_16x16x32_bf16 v[64:67], v[144:147], v[184:187], v[64:67]
  ds_read_b64_tr_b16 v[128:129], v224 offset:33792
  ds_read_b64_tr_b16 v[130:131], v224 offset:37888
  s_waitcnt vmcnt(17)
  v_lshlrev_b32 v96, 16, v112
  v_and_b32 v97, 0xffff0000, v112
  v_mfma_f32_16x16x32_bf16 v[68:71], v[144:147], v[188:191], v[68:71]
  ds_read_b64_tr_b16 v[132:133], v225 offset:33792
  ds_read_b64_tr_b16 v[134:135], v225 offset:37888
  v_lshlrev_b32 v98, 16, v113
  v_and_b32 v99, 0xffff0000, v113
  v_lshlrev_b32 v100, 16, v114
  v_and_b32 v101, 0xffff0000, v114
  s_waitcnt lgkmcnt(8)
  v_mfma_f32_16x16x32_bf16 v[76:79], v[148:151], v[188:191], v[76:79]
  ds_read_b64_tr_b16 v[136:137], v226 offset:33792
  ds_read_b64_tr_b16 v[138:139], v226 offset:37888
  v_lshlrev_b32 v102, 16, v115
  v_and_b32 v103, 0xffff0000, v115
  v_add_f32 v0, v0, v96
  v_add_f32 v1, v1, v97
  v_mfma_f32_16x16x32_bf16 v[72:75], v[148:151], v[184:187], v[72:75]
  ds_read_b64_tr_b16 v[140:141], v227 offset:33792
  ds_read_b64_tr_b16 v[142:143], v227 offset:37888
  v_add_f32 v2, v2, v98
  v_add_f32 v3, v3, v99
  v_add_f32 v4, v4, v100
  v_add_f32 v5, v5, v101
  s_waitcnt lgkmcnt(8)
  v_mfma_f32_16x16x32_bf16 v[80:83], v[152:155], v[184:187], v[80:83]
  v_add_f32 v6, v6, v102
  v_add_f32 v7, v7, v103
  v_mul_f32 v96, s72, v0
  v_mfma_f32_16x16x32_bf16 v[84:87], v[152:155], v[188:191], v[84:87]
  v_mul_f32 v97, s72, v1
  v_mul_f32 v98, s72, v2
  v_mul_f32 v99, s72, v3
  v_mul_f32 v100, s72, v4
  v_mfma_f32_16x16x32_bf16 v[92:95], v[156:159], v[188:191], v[92:95]
  buffer_load_dwordx4 v[176:179], v233, s[24:27], s42 offen offset:0 sc1
  v_mul_f32 v101, s72, v5
  v_mul_f32 v102, s72, v6
  v_mul_f32 v103, s72, v7
  v_exp_f32 v96, v96
  v_mfma_f32_16x16x32_bf16 v[88:91], v[156:159], v[184:187], v[88:91]
  buffer_load_dwordx4 v[180:183], v233, s[24:27], s42 offen offset:1024 sc1
  s_add_u32 s42, s42, 4096
  v_exp_f32 v97, v97
  v_exp_f32 v98, v98
  v_exp_f32 v99, v99
  v_exp_f32 v100, v100
  s_waitcnt lgkmcnt(6)
  v_mfma_f32_16x16x32_bf16 v[64:67], v[128:131], v[192:195], v[64:67]
  ds_read_b64_tr_b16 v[144:145], v224 offset:41984
  ds_read_b64_tr_b16 v[146:147], v224 offset:46080
  v_exp_f32 v101, v101
  v_exp_f32 v102, v102
  v_exp_f32 v103, v103
  v_mfma_f32_16x16x32_bf16 v[68:71], v[128:131], v[196:199], v[68:71]
  ds_read_b64_tr_b16 v[148:149], v225 offset:41984
  ds_read_b64_tr_b16 v[150:151], v225 offset:46080
  v_add_f32 v96, 1.0, v96
  v_add_f32 v97, 1.0, v97
  v_add_f32 v98, 1.0, v98
  v_add_f32 v99, 1.0, v99
  s_waitcnt lgkmcnt(8)
  v_mfma_f32_16x16x32_bf16 v[76:79], v[132:135], v[196:199], v[76:79]
  ds_read_b64_tr_b16 v[152:153], v226 offset:41984
  ds_read_b64_tr_b16 v[154:155], v226 offset:46080
  v_add_f32 v100, 1.0, v100
  v_add_f32 v101, 1.0, v101
  v_add_f32 v102, 1.0, v102
  v_add_f32 v103, 1.0, v103
  v_mfma_f32_16x16x32_bf16 v[72:75], v[132:135], v[192:195], v[72:75]
  ds_read_b64_tr_b16 v[156:157], v227 offset:41984
  ds_read_b64_tr_b16 v[158:159], v227 offset:46080
  v_rcp_f32 v96, v96
  v_rcp_f32 v97, v97
  v_rcp_f32 v98, v98
  v_rcp_f32 v99, v99
  s_waitcnt lgkmcnt(8)
  v_mfma_f32_16x16x32_bf16 v[80:83], v[136:139], v[192:195], v[80:83]
  v_rcp_f32 v100, v100
  v_rcp_f32 v101, v101
  v_rcp_f32 v102, v102
  v_mfma_f32_16x16x32_bf16 v[84:87], v[136:139], v[196:199], v[84:87]
  v_rcp_f32 v103, v103
  v_mul_f32 v0, v0, v96
  v_mul_f32 v1, v1, v97
  v_mul_f32 v2, v2, v98
  v_mfma_f32_16x16x32_bf16 v[92:95], v[140:143], v[196:199], v[92:95]
  buffer_load_dwordx4 v[184:187], v233, s[24:27], s42 offen offset:0 sc1
  v_mul_f32 v3, v3, v99
  v_mul_f32 v4, v4, v100
  v_mul_f32 v5, v5, v101
  v_mul_f32 v6, v6, v102
  v_mfma_f32_16x16x32_bf16 v[88:91], v[140:143], v[192:195], v[88:91]
  buffer_load_dwordx4 v[188:191], v233, s[24:27], s42 offen offset:1024 sc1
  s_add_u32 s42, s42, 4096
  v_mul_f32 v7, v7, v103
  s_waitcnt vmcnt(20)
  v_lshlrev_b32 v104, 16, v116
  v_and_b32 v105, 0xffff0000, v116
  s_waitcnt vmcnt(8)
  s_barrier
  s_waitcnt lgkmcnt(6)
  v_mfma_f32_16x16x32_bf16 v[64:67], v[144:147], v[200:203], v[64:67]
  ds_read_b64_tr_b16 v[128:129], v224 offset:50176
  ds_read_b64_tr_b16 v[130:131], v224 offset:54272
  v_lshlrev_b32 v106, 16, v117
  v_and_b32 v107, 0xffff0000, v117
  v_lshlrev_b32 v108, 16, v118
  v_mfma_f32_16x16x32_bf16 v[68:71], v[144:147], v[204:207], v[68:71]
  ds_read_b64_tr_b16 v[132:133], v225 offset:50176
  ds_read_b64_tr_b16 v[134:135], v225 offset:54272
  v_and_b32 v109, 0xffff0000, v118
  v_lshlrev_b32 v110, 16, v119
  v_and_b32 v111, 0xffff0000, v119
  v_add_f32 v8, v8, v104
  s_waitcnt lgkmcnt(8)
  v_mfma_f32_16x16x32_bf16 v[76:79], v[148:151], v[204:207], v[76:79]
  ds_read_b64_tr_b16 v[136:137], v226 offset:50176
  ds_read_b64_tr_b16 v[138:139], v226 offset:54272
  v_add_f32 v9, v9, v105
  v_add_f32 v10, v10, v106
  v_add_f32 v11, v11, v107
  v_add_f32 v12, v12, v108
  v_mfma_f32_16x16x32_bf16 v[72:75], v[148:151], v[200:203], v[72:75]
  ds_read_b64_tr_b16 v[140:141], v227 offset:50176
  ds_read_b64_tr_b16 v[142:143], v227 offset:54272
  v_add_f32 v13, v13, v109
  v_add_f32 v14, v14, v110
  v_add_f32 v15, v15, v111
  v_mul_f32 v104, s72, v8
  s_waitcnt lgkmcnt(8)
  v_mfma_f32_16x16x32_bf16 v[80:83], v[152:155], v[200:203], v[80:83]
  v_mul_f32 v105, s72, v9
  v_mul_f32 v106, s72, v10
  v_mul_f32 v107, s72, v11
  v_mfma_f32_16x16x32_bf16 v[84:87], v[152:155], v[204:207], v[84:87]
  v_mul_f32 v108, s72, v12
  v_mul_f32 v109, s72, v13
  v_mul_f32 v110, s72, v14
  v_mul_f32 v111, s72, v15
  v_mfma_f32_16x16x32_bf16 v[92:95], v[156:159], v[204:207], v[92:95]
  buffer_load_dwordx4 v[192:195], v233, s[24:27], s42 offen offset:0 sc1
  v_exp_f32 v104, v104
  v_exp_f32 v105, v105
  v_exp_f32 v106, v106
  v_exp_f32 v107, v107
  v_mfma_f32_16x16x32_bf16 v[88:91], v[156:159], v[200:203], v[88:91]
  buffer_load_dwordx4 v[196:199], v233, s[24:27], s42 offen offset:1024 sc1
  s_add_u32 s42, s42, 4096
  v_exp_f32 v108, v108
  v_exp_f32 v109, v109
  v_exp_f32 v110, v110
  v_exp_f32 v111, v111
  s_waitcnt lgkmcnt(6)
  v_mfma_f32_16x16x32_bf16 v[64:67], v[128:131], v[208:211], v[64:67]
  ds_read_b64_tr_b16 v[144:145], v224 offset:58368
  ds_read_b64_tr_b16 v[146:147], v224 offset:62464
  v_add_f32 v104, 1.0, v104
  v_add_f32 v105, 1.0, v105
  v_add_f32 v106, 1.0, v106
  v_mfma_f32_16x16x32_bf16 v[68:71], v[128:131], v[212:215], v[68:71]
  ds_read_b64_tr_b16 v[148:149], v225 offset:58368
  ds_read_b64_tr_b16 v[150:151], v225 offset:62464
  v_add_f32 v107, 1.0, v107
  v_add_f32 v108, 1.0, v108
  v_add_f32 v109, 1.0, v109
  v_add_f32 v110, 1.0, v110
  s_waitcnt lgkmcnt(8)
  v_mfma_f32_16x16x32_bf16 v[76:79], v[132:135], v[212:215], v[76:79]
  ds_read_b64_tr_b16 v[152:153], v226 offset:58368
  ds_read_b64_tr_b16 v[154:155], v226 offset:62464
  v_add_f32 v111, 1.0, v111
  v_rcp_f32 v104, v104
  v_rcp_f32 v105, v105
  v_rcp_f32 v106, v106
  v_mfma_f32_16x16x32_bf16 v[72:75], v[132:135], v[208:211], v[72:75]
  ds_read_b64_tr_b16 v[156:157], v227 offset:58368
  ds_read_b64_tr_b16 v[158:159], v227 offset:62464
  v_rcp_f32 v107, v107
  v_rcp_f32 v108, v108
  v_rcp_f32 v109, v109
  v_rcp_f32 v110, v110
  s_waitcnt lgkmcnt(8)
  v_mfma_f32_16x16x32_bf16 v[80:83], v[136:139], v[208:211], v[80:83]
  v_xor_b32 v224, 0x10000, v224
  v_rcp_f32 v111, v111
  v_mul_f32 v8, v8, v104
  v_mul_f32 v9, v9, v105
  v_mfma_f32_16x16x32_bf16 v[84:87], v[136:139], v[212:215], v[84:87]
  v_xor_b32 v225, 0x10000, v225
  v_mul_f32 v10, v10, v106
  v_mul_f32 v11, v11, v107
  v_mul_f32 v12, v12, v108
  v_mul_f32 v13, v13, v109
  v_mfma_f32_16x16x32_bf16 v[92:95], v[140:143], v[212:215], v[92:95]
  v_xor_b32 v226, 0x10000, v226
  buffer_load_dwordx4 v[200:203], v233, s[24:27], s42 offen offset:0 sc1
  v_mul_f32 v14, v14, v110
  v_mul_f32 v15, v15, v111
  s_waitcnt vmcnt(19)
  v_lshlrev_b32 v112, 16, v120
  v_mfma_f32_16x16x32_bf16 v[88:91], v[140:143], v[208:211], v[88:91]
  v_xor_b32 v227, 0x10000, v227
  buffer_load_dwordx4 v[204:207], v233, s[24:27], s42 offen offset:1024 sc1
  s_add_u32 s42, s42, 4096
  v_and_b32 v113, 0xffff0000, v120
  v_lshlrev_b32 v114, 16, v121
  v_and_b32 v115, 0xffff0000, v121
  v_lshlrev_b32 v116, 16, v122
  s_waitcnt vmcnt(10)
  s_waitcnt lgkmcnt(6)
  v_mfma_f32_16x16x32_bf16 v[64:67], v[144:147], v[216:219], v[64:67]
  ds_read_b64_tr_b16 v[128:129], v224 offset:1024
  ds_read_b64_tr_b16 v[130:131], v224 offset:5120
  v_and_b32 v117, 0xffff0000, v122
  v_lshlrev_b32 v118, 16, v123
  v_and_b32 v119, 0xffff0000, v123
  v_mfma_f32_16x16x32_bf16 v[68:71], v[144:147], v[220:223], v[68:71]
  ds_read_b64_tr_b16 v[132:133], v225 offset:1024
  ds_read_b64_tr_b16 v[134:135], v225 offset:5120
  v_add_f32 v16, v16, v112
  v_add_f32 v17, v17, v113
  v_add_f32 v18, v18, v114
  v_add_f32 v19, v19, v115
  s_waitcnt lgkmcnt(8)
  v_mfma_f32_16x16x32_bf16 v[76:79], v[148:151], v[220:223], v[76:79]
  ds_read_b64_tr_b16 v[136:137], v226 offset:1024
  ds_read_b64_tr_b16 v[138:139], v226 offset:5120
  v_add_f32 v20, v20, v116
  v_add_f32 v21, v21, v117
  v_add_f32 v22, v22, v118
  v_add_f32 v23, v23, v119
  v_mfma_f32_16x16x32_bf16 v[72:75], v[148:151], v[216:219], v[72:75]
  ds_read_b64_tr_b16 v[140:141], v227 offset:1024
  ds_read_b64_tr_b16 v[142:143], v227 offset:5120
  v_mul_f32 v112, s72, v16
  v_mul_f32 v113, s72, v17
  v_mul_f32 v114, s72, v18
  v_mul_f32 v115, s72, v19
  s_waitcnt lgkmcnt(8)
  v_mfma_f32_16x16x32_bf16 v[80:83], v[152:155], v[216:219], v[80:83]
  v_mul_f32 v116, s72, v20
  v_mul_f32 v117, s72, v21
  v_mul_f32 v118, s72, v22
  v_mfma_f32_16x16x32_bf16 v[84:87], v[152:155], v[220:223], v[84:87]
  v_mul_f32 v119, s72, v23
  v_exp_f32 v112, v112
  v_exp_f32 v113, v113
  v_exp_f32 v114, v114
  v_mfma_f32_16x16x32_bf16 v[92:95], v[156:159], v[220:223], v[92:95]
  buffer_load_dwordx4 v[208:211], v233, s[24:27], s42 offen offset:0 sc1
  v_exp_f32 v115, v115
  v_exp_f32 v116, v116
  v_exp_f32 v117, v117
  v_exp_f32 v118, v118
  v_mfma_f32_16x16x32_bf16 v[88:91], v[156:159], v[216:219], v[88:91]
  buffer_load_dwordx4 v[212:215], v233, s[24:27], s42 offen offset:1024 sc1
  s_add_u32 s42, s42, 4096
  v_exp_f32 v119, v119
  v_add_f32 v112, 1.0, v112
  v_add_f32 v113, 1.0, v113
  v_add_f32 v114, 1.0, v114
  s_waitcnt lgkmcnt(6)
  v_mfma_f32_16x16x32_bf16 v[64:67], v[128:131], v[160:163], v[64:67]
  ds_read_b64_tr_b16 v[144:145], v224 offset:9216
  ds_read_b64_tr_b16 v[146:147], v224 offset:13312
  v_add_f32 v115, 1.0, v115
  v_add_f32 v116, 1.0, v116
  v_add_f32 v117, 1.0, v117
  v_mfma_f32_16x16x32_bf16 v[68:71], v[128:131], v[164:167], v[68:71]
  ds_read_b64_tr_b16 v[148:149], v225 offset:9216
  ds_read_b64_tr_b16 v[150:151], v225 offset:13312
  v_add_f32 v118, 1.0, v118
  v_add_f32 v119, 1.0, v119
  v_rcp_f32 v112, v112
  v_rcp_f32 v113, v113
  s_waitcnt lgkmcnt(8)
  v_mfma_f32_16x16x32_bf16 v[76:79], v[132:135], v[164:167], v[76:79]
  ds_read_b64_tr_b16 v[152:153], v226 offset:9216
  ds_read_b64_tr_b16 v[154:155], v226 offset:13312
  v_rcp_f32 v114, v114
  v_rcp_f32 v115, v115
  v_rcp_f32 v116, v116
  v_rcp_f32 v117, v117
  v_mfma_f32_16x16x32_bf16 v[72:75], v[132:135], v[160:163], v[72:75]
  ds_read_b64_tr_b16 v[156:157], v227 offset:9216
  ds_read_b64_tr_b16 v[158:159], v227 offset:13312
  v_rcp_f32 v118, v118
  v_rcp_f32 v119, v119
  v_mul_f32 v16, v16, v112
  v_mul_f32 v17, v17, v113
  s_waitcnt lgkmcnt(8)
  v_mfma_f32_16x16x32_bf16 v[80:83], v[136:139], v[160:163], v[80:83]
  v_mul_f32 v18, v18, v114
  v_mul_f32 v19, v19, v115
  v_mul_f32 v20, v20, v116
  v_mfma_f32_16x16x32_bf16 v[84:87], v[136:139], v[164:167], v[84:87]
  v_mul_f32 v21, v21, v117
  v_mul_f32 v22, v22, v118
  v_mul_f32 v23, v23, v119
  s_waitcnt vmcnt(21)
  v_mfma_f32_16x16x32_bf16 v[92:95], v[140:143], v[164:167], v[92:95]
  buffer_load_dwordx4 v[216:219], v233, s[24:27], s42 offen offset:0 sc1
  v_lshlrev_b32 v120, 16, v124
  v_and_b32 v121, 0xffff0000, v124
  v_lshlrev_b32 v122, 16, v125
  v_and_b32 v123, 0xffff0000, v125
  v_mfma_f32_16x16x32_bf16 v[88:91], v[140:143], v[160:163], v[88:91]
  buffer_load_dwordx4 v[220:223], v233, s[24:27], s42 offen offset:1024 sc1
  s_add_u32 s42, s42, 4096
  v_lshlrev_b32 v124, 16, v126
  v_and_b32 v125, 0xffff0000, v126
  v_lshlrev_b32 v126, 16, v127
  v_and_b32 v127, 0xffff0000, v127
  s_waitcnt vmcnt(10)
  s_waitcnt lgkmcnt(6)
  v_mfma_f32_16x16x32_bf16 v[64:67], v[144:147], v[168:171], v[64:67]
  ds_read_b64_tr_b16 v[128:129], v224 offset:17408
  ds_read_b64_tr_b16 v[130:131], v224 offset:21504
  v_add_f32 v24, v24, v120
  v_add_f32 v25, v25, v121
  v_add_f32 v26, v26, v122
  v_mfma_f32_16x16x32_bf16 v[68:71], v[144:147], v[172:175], v[68:71]
  ds_read_b64_tr_b16 v[132:133], v225 offset:17408
  ds_read_b64_tr_b16 v[134:135], v225 offset:21504
  v_add_f32 v27, v27, v123
  v_add_f32 v28, v28, v124
  v_add_f32 v29, v29, v125
  v_add_f32 v30, v30, v126
  s_waitcnt lgkmcnt(8)
  v_mfma_f32_16x16x32_bf16 v[76:79], v[148:151], v[172:175], v[76:79]
  ds_read_b64_tr_b16 v[136:137], v226 offset:17408
  ds_read_b64_tr_b16 v[138:139], v226 offset:21504
  v_add_f32 v31, v31, v127
  v_mul_f32 v120, s72, v24
  v_mul_f32 v121, s72, v25
  v_mul_f32 v122, s72, v26
  v_mfma_f32_16x16x32_bf16 v[72:75], v[148:151], v[168:171], v[72:75]
  ds_read_b64_tr_b16 v[140:141], v227 offset:17408
  ds_read_b64_tr_b16 v[142:143], v227 offset:21504
  v_mul_f32 v123, s72, v27
  v_mul_f32 v124, s72, v28
  v_mul_f32 v125, s72, v29
  v_mul_f32 v126, s72, v30
  s_waitcnt lgkmcnt(8)
  v_mfma_f32_16x16x32_bf16 v[80:83], v[152:155], v[168:171], v[80:83]
  v_mul_f32 v127, s72, v31
  v_exp_f32 v120, v120
  v_exp_f32 v121, v121
  v_mfma_f32_16x16x32_bf16 v[84:87], v[152:155], v[172:175], v[84:87]
  v_exp_f32 v122, v122
  v_exp_f32 v123, v123
  v_exp_f32 v124, v124
  v_exp_f32 v125, v125
  v_mfma_f32_16x16x32_bf16 v[92:95], v[156:159], v[172:175], v[92:95]
  v_exp_f32 v126, v126
  v_exp_f32 v127, v127
  v_add_f32 v120, 1.0, v120
  v_add_f32 v121, 1.0, v121
  v_mfma_f32_16x16x32_bf16 v[88:91], v[156:159], v[168:171], v[88:91]
  v_add_f32 v122, 1.0, v122
  v_add_f32 v123, 1.0, v123
  v_add_f32 v124, 1.0, v124
  v_add_f32 v125, 1.0, v125
  s_waitcnt lgkmcnt(6)
  v_mfma_f32_16x16x32_bf16 v[64:67], v[128:131], v[176:179], v[64:67]
  ds_read_b64_tr_b16 v[144:145], v224 offset:25600
  ds_read_b64_tr_b16 v[146:147], v224 offset:29696
  v_add_f32 v126, 1.0, v126
  v_add_f32 v127, 1.0, v127
  v_mfma_f32_16x16x32_bf16 v[68:71], v[128:131], v[180:183], v[68:71]
  ds_read_b64_tr_b16 v[148:149], v225 offset:25600
  ds_read_b64_tr_b16 v[150:151], v225 offset:29696
  v_rcp_f32 v120, v120
  v_rcp_f32 v121, v121
  s_waitcnt lgkmcnt(8)
  v_mfma_f32_16x16x32_bf16 v[76:79], v[132:135], v[180:183], v[76:79]
  ds_read_b64_tr_b16 v[152:153], v226 offset:25600
  ds_read_b64_tr_b16 v[154:155], v226 offset:29696
  v_rcp_f32 v122, v122
  v_rcp_f32 v123, v123
  v_mfma_f32_16x16x32_bf16 v[72:75], v[132:135], v[176:179], v[72:75]
  ds_read_b64_tr_b16 v[156:157], v227 offset:25600
  ds_read_b64_tr_b16 v[158:159], v227 offset:29696
  v_rcp_f32 v124, v124
  v_rcp_f32 v125, v125
  v_rcp_f32 v126, v126
  s_waitcnt lgkmcnt(8)
  v_mfma_f32_16x16x32_bf16 v[80:83], v[136:139], v[176:179], v[80:83]
  v_rcp_f32 v127, v127
  v_mul_f32 v24, v24, v120
  v_mfma_f32_16x16x32_bf16 v[84:87], v[136:139], v[180:183], v[84:87]
  v_mul_f32 v25, v25, v121
  v_mul_f32 v26, v26, v122
  v_mfma_f32_16x16x32_bf16 v[92:95], v[140:143], v[180:183], v[92:95]
  v_mul_f32 v27, v27, v123
  v_mul_f32 v28, v28, v124
  v_mfma_f32_16x16x32_bf16 v[88:91], v[140:143], v[176:179], v[88:91]
  v_mul_f32 v29, v29, v125
  v_mul_f32 v30, v30, v126
  v_mul_f32 v31, v31, v127
  s_waitcnt vmcnt(6)
  s_waitcnt lgkmcnt(6)
  v_mfma_f32_16x16x32_bf16 v[64:67], v[144:147], v[184:187], v[64:67]
  ds_read_b64_tr_b16 v[128:129], v224 offset:33792
  ds_read_b64_tr_b16 v[130:131], v224 offset:37888
  v_mfma_f32_16x16x32_bf16 v[68:71], v[144:147], v[188:191], v[68:71]
  ds_read_b64_tr_b16 v[132:133], v225 offset:33792
  ds_read_b64_tr_b16 v[134:135], v225 offset:37888
  s_waitcnt lgkmcnt(8)
  v_mfma_f32_16x16x32_bf16 v[76:79], v[148:151], v[188:191], v[76:79]
  ds_read_b64_tr_b16 v[136:137], v226 offset:33792
  ds_read_b64_tr_b16 v[138:139], v226 offset:37888
  v_mfma_f32_16x16x32_bf16 v[72:75], v[148:151], v[184:187], v[72:75]
  ds_read_b64_tr_b16 v[140:141], v227 offset:33792
  ds_read_b64_tr_b16 v[142:143], v227 offset:37888
  s_waitcnt lgkmcnt(8)
  v_mfma_f32_16x16x32_bf16 v[80:83], v[152:155], v[184:187], v[80:83]
  v_mfma_f32_16x16x32_bf16 v[84:87], v[152:155], v[188:191], v[84:87]
  v_mfma_f32_16x16x32_bf16 v[92:95], v[156:159], v[188:191], v[92:95]
  v_mfma_f32_16x16x32_bf16 v[88:91], v[156:159], v[184:187], v[88:91]
  s_waitcnt lgkmcnt(6)
  v_mfma_f32_16x16x32_bf16 v[64:67], v[128:131], v[192:195], v[64:67]
  ds_read_b64_tr_b16 v[144:145], v224 offset:41984
  ds_read_b64_tr_b16 v[146:147], v224 offset:46080
  v_mfma_f32_16x16x32_bf16 v[68:71], v[128:131], v[196:199], v[68:71]
  ds_read_b64_tr_b16 v[148:149], v225 offset:41984
  ds_read_b64_tr_b16 v[150:151], v225 offset:46080
  s_waitcnt lgkmcnt(8)
  v_mfma_f32_16x16x32_bf16 v[76:79], v[132:135], v[196:199], v[76:79]
  ds_read_b64_tr_b16 v[152:153], v226 offset:41984
  ds_read_b64_tr_b16 v[154:155], v226 offset:46080
  v_mfma_f32_16x16x32_bf16 v[72:75], v[132:135], v[192:195], v[72:75]
  ds_read_b64_tr_b16 v[156:157], v227 offset:41984
  ds_read_b64_tr_b16 v[158:159], v227 offset:46080
  s_waitcnt lgkmcnt(8)
  v_mfma_f32_16x16x32_bf16 v[80:83], v[136:139], v[192:195], v[80:83]
  v_mfma_f32_16x16x32_bf16 v[84:87], v[136:139], v[196:199], v[84:87]
  v_mfma_f32_16x16x32_bf16 v[92:95], v[140:143], v[196:199], v[92:95]
  v_mfma_f32_16x16x32_bf16 v[88:91], v[140:143], v[192:195], v[88:91]
  s_waitcnt vmcnt(2)
  s_waitcnt lgkmcnt(6)
  v_mfma_f32_16x16x32_bf16 v[64:67], v[144:147], v[200:203], v[64:67]
  ds_read_b64_tr_b16 v[128:129], v224 offset:50176
  ds_read_b64_tr_b16 v[130:131], v224 offset:54272
  v_mfma_f32_16x16x32_bf16 v[68:71], v[144:147], v[204:207], v[68:71]
  ds_read_b64_tr_b16 v[132:133], v225 offset:50176
  ds_read_b64_tr_b16 v[134:135], v225 offset:54272
  s_waitcnt lgkmcnt(8)
  v_mfma_f32_16x16x32_bf16 v[76:79], v[148:151], v[204:207], v[76:79]
  ds_read_b64_tr_b16 v[136:137], v226 offset:50176
  ds_read_b64_tr_b16 v[138:139], v226 offset:54272
  v_mfma_f32_16x16x32_bf16 v[72:75], v[148:151], v[200:203], v[72:75]
  ds_read_b64_tr_b16 v[140:141], v227 offset:50176
  ds_read_b64_tr_b16 v[142:143], v227 offset:54272
  s_waitcnt lgkmcnt(8)
  v_mfma_f32_16x16x32_bf16 v[80:83], v[152:155], v[200:203], v[80:83]
  v_mfma_f32_16x16x32_bf16 v[84:87], v[152:155], v[204:207], v[84:87]
  v_mfma_f32_16x16x32_bf16 v[92:95], v[156:159], v[204:207], v[92:95]
  v_mfma_f32_16x16x32_bf16 v[88:91], v[156:159], v[200:203], v[88:91]
  s_waitcnt lgkmcnt(6)
  v_mfma_f32_16x16x32_bf16 v[64:67], v[128:131], v[208:211], v[64:67]
  ds_read_b64_tr_b16 v[144:145], v224 offset:58368
  ds_read_b64_tr_b16 v[146:147], v224 offset:62464
  v_mfma_f32_16x16x32_bf16 v[68:71], v[128:131], v[212:215], v[68:71]
  ds_read_b64_tr_b16 v[148:149], v225 offset:58368
  ds_read_b64_tr_b16 v[150:151], v225 offset:62464
  s_waitcnt lgkmcnt(8)
  v_mfma_f32_16x16x32_bf16 v[76:79], v[132:135], v[212:215], v[76:79]
  ds_read_b64_tr_b16 v[152:153], v226 offset:58368
  ds_read_b64_tr_b16 v[154:155], v226 offset:62464
  v_mfma_f32_16x16x32_bf16 v[72:75], v[132:135], v[208:211], v[72:75]
  ds_read_b64_tr_b16 v[156:157], v227 offset:58368
  ds_read_b64_tr_b16 v[158:159], v227 offset:62464
  s_waitcnt lgkmcnt(8)
  v_mfma_f32_16x16x32_bf16 v[80:83], v[136:139], v[208:211], v[80:83]
  v_xor_b32 v224, 0x10000, v224
  v_mfma_f32_16x16x32_bf16 v[84:87], v[136:139], v[212:215], v[84:87]
  v_xor_b32 v225, 0x10000, v225
  v_mfma_f32_16x16x32_bf16 v[92:95], v[140:143], v[212:215], v[92:95]
  v_xor_b32 v226, 0x10000, v226
  v_mfma_f32_16x16x32_bf16 v[88:91], v[140:143], v[208:211], v[88:91]
  v_xor_b32 v227, 0x10000, v227
  s_waitcnt vmcnt(0)
  s_waitcnt lgkmcnt(6)
  v_mfma_f32_16x16x32_bf16 v[64:67], v[144:147], v[216:219], v[64:67]
  v_mfma_f32_16x16x32_bf16 v[68:71], v[144:147], v[220:223], v[68:71]
  s_waitcnt lgkmcnt(4)
  v_mfma_f32_16x16x32_bf16 v[76:79], v[148:151], v[220:223], v[76:79]
  v_mfma_f32_16x16x32_bf16 v[72:75], v[148:151], v[216:219], v[72:75]
  s_waitcnt lgkmcnt(0)
  v_mfma_f32_16x16x32_bf16 v[80:83], v[152:155], v[216:219], v[80:83]
  v_mfma_f32_16x16x32_bf16 v[84:87], v[152:155], v[220:223], v[84:87]
  v_mfma_f32_16x16x32_bf16 v[92:95], v[156:159], v[220:223], v[92:95]
  v_mfma_f32_16x16x32_bf16 v[88:91], v[156:159], v[216:219], v[88:91]
  s_nop 1
  v_fmac_f32 v32, v0, v64
  v_fmac_f32 v33, v1, v65
  v_fmac_f32 v34, v2, v66
  v_fmac_f32 v35, v3, v67
  v_fmac_f32 v36, v4, v68
  v_fmac_f32 v37, v5, v69
  v_fmac_f32 v38, v6, v70
  v_fmac_f32 v39, v7, v71
  v_cvt_pk_bf16_f32 v240, v32, v33
  v_cvt_pk_bf16_f32 v241, v34, v35
  v_cvt_pk_bf16_f32 v242, v36, v37
  v_cvt_pk_bf16_f32 v243, v38, v39
  v_xor_b32 v239, 0, v235
  ds_write_b64 v239, v[240:241] offset:0
  ds_write_b64 v239, v[242:243] offset:2048
  v_fmac_f32 v40, v8, v72
  v_fmac_f32 v41, v9, v73
  v_fmac_f32 v42, v10, v74
  v_fmac_f32 v43, v11, v75
  v_fmac_f32 v44, v12, v76
  v_fmac_f32 v45, v13, v77
  v_fmac_f32 v46, v14, v78
  v_fmac_f32 v47, v15, v79
  v_cvt_pk_bf16_f32 v244, v40, v41
  v_cvt_pk_bf16_f32 v245, v42, v43
  v_cvt_pk_bf16_f32 v246, v44, v45
  v_cvt_pk_bf16_f32 v247, v46, v47
  v_xor_b32 v239, 32, v235
  ds_write_b64 v239, v[244:245] offset:0
  ds_write_b64 v239, v[246:247] offset:2048
  v_fmac_f32 v48, v16, v80
  v_fmac_f32 v49, v17, v81
  v_fmac_f32 v50, v18, v82
  v_fmac_f32 v51, v19, v83
  v_fmac_f32 v52, v20, v84
  v_fmac_f32 v53, v21, v85
  v_fmac_f32 v54, v22, v86
  v_fmac_f32 v55, v23, v87
  v_cvt_pk_bf16_f32 v248, v48, v49
  v_cvt_pk_bf16_f32 v249, v50, v51
  v_cvt_pk_bf16_f32 v250, v52, v53
  v_cvt_pk_bf16_f32 v251, v54, v55
  v_xor_b32 v239, 64, v235
  ds_write_b64 v239, v[248:249] offset:0
  ds_write_b64 v239, v[250:251] offset:2048
  v_fmac_f32 v56, v24, v88
  v_fmac_f32 v57, v25, v89
  v_fmac_f32 v58, v26, v90
  v_fmac_f32 v59, v27, v91
  v_fmac_f32 v60, v28, v92
  v_fmac_f32 v61, v29, v93
  v_fmac_f32 v62, v30, v94
  v_fmac_f32 v63, v31, v95
  v_cvt_pk_bf16_f32 v252, v56, v57
  v_cvt_pk_bf16_f32 v253, v58, v59
  v_cvt_pk_bf16_f32 v254, v60, v61
  v_cvt_pk_bf16_f32 v255, v62, v63
  v_xor_b32 v239, 96, v235
  ds_write_b64 v239, v[252:253] offset:0
  ds_write_b64 v239, v[254:255] offset:2048
  v_add_u32 v236, s45, v233
  s_waitcnt lgkmcnt(0)
  ds_read_b128 v[0:3], v236 offset:0
  ds_read_b128 v[4:7], v236 offset:1024
  ds_read_b128 v[8:11], v236 offset:2048
  ds_read_b128 v[12:15], v236 offset:3072
  s_add_u32 s57, s39, 0
  s_waitcnt lgkmcnt(3)
  buffer_store_dwordx4 v[0:3], v230, s[32:35], s57 offen sc1
  s_add_u32 s57, s39, 16384
  s_waitcnt lgkmcnt(2)
  buffer_store_dwordx4 v[4:7], v230, s[32:35], s57 offen sc1
  s_add_u32 s57, s39, 32768
  s_waitcnt lgkmcnt(1)
  buffer_store_dwordx4 v[8:11], v230, s[32:35], s57 offen sc1
  s_add_u32 s57, s39, 49152
  s_waitcnt lgkmcnt(0)
  buffer_store_dwordx4 v[12:15], v230, s[32:35], s57 offen sc1
  s_endpgm
G2_oph_end:
G2_pspin:
  s_mov_b32 s98, 0
G2_pspin_l:
  s_sleep 2
  buffer_load_dword v231, v232, s[84:87], s75 offen sc1
  s_add_u32 s98, s98, 1
  s_cmp_gt_u32 s98, 400000
  s_cbranch_scc1 G2_pgo
  s_waitcnt vmcnt(0)
  v_cmp_ne_u32 vcc, s3, v231
  s_nop 1
  s_and_b64 vcc, vcc, -1
  s_cbranch_scc1 G2_pspin_l
  s_branch G2_pgo
G2_hspin:
  s_mov_b32 s98, 0
G2_hspin_l:
  s_sleep 2
  buffer_load_dword v231, v232, s[84:87], s76 offen sc1
  s_add_u32 s98, s98, 1
  s_cmp_gt_u32 s98, 400000
  s_cbranch_scc1 G2_hgo
  s_waitcnt vmcnt(0)
  v_cmp_ne_u32 vcc, s3, v231
  s_nop 1
  s_and_b64 vcc, vcc, 0xffff
  s_cbranch_scc1 G2_hspin_l
  s_branch G2_hgo
G2_h6:
  s_cmp_lg_u32 s44, s79
  s_cbranch_scc1 G2_h6a
  buffer_load_dword v231, v232, s[84:87], s50 offen sc1
G2_h6a:
  s_cmp_lg_u32 s40, 0
  s_cbranch_scc1 G2_h6_ret
  s_cmp_lg_u32 s44, 0
  s_cbranch_scc1 G2_h6b
  v_mov_b32 v236, s3
  s_mov_b64 exec, 1
  buffer_store_dword v236, v232, s[84:87], s74 offen sc1
  s_mov_b64 exec, -1
G2_h6b:
  s_cmp_lg_u32 s44, 3
  s_cbranch_scc1 G2_h6_ret
  s_getpc_b64 s[14:15]
CP1:
  s_add_u32 s14, s14, G2_oph-CP1
  s_addc_u32 s15, s15, (G2_oph-CP1)>>32
  v_lshlrev_b32 v239, 7, v255
  v_min_u32 v239, G2_oph_end-G2_oph-4, v239
  global_load_dword v239, v239, s[14:15]
  s_branch G2_h6_ret
G2_h1:
  s_cmp_eq_u32 s44, s78
  s_cbranch_scc1 G2_osw
  s_mov_b32 s64, 851968
  s_mov_b32 s65, 851968
  s_mov_b32 s66, 851968
  s_mov_b32 s67, 851968
  s_mul_i32 s41, s46, 7340032
  s_add_u32 s41, s41, 786432
  s_cmp_eq_u32 s46, 0
  s_cbranch_scc1 G2_h1_ret
  s_sub_u32 s79, s77, 2
  s_mov_b32 s50, s63
  s_waitcnt vmcnt(12)
  v_cmp_ne_u32 vcc, s3, v231
  s_nop 1
  s_and_b64 vcc, vcc, 0xffff
  s_cbranch_scc0 G2_h1_ret
G2_kspin:
  s_mov_b32 s98, 0
G2_kspin_l:
  s_sleep 2
  buffer_load_dword v231, v232, s[84:87], s76 offen sc1
  s_add_u32 s98, s98, 1
  s_cmp_gt_u32 s98, 400000
  s_cbranch_scc1 G2_h1_ret
  s_waitcnt vmcnt(0)
  v_cmp_ne_u32 vcc, s3, v231
  s_nop 1
  s_and_b64 vcc, vcc, 0xffff
  s_cbranch_scc1 G2_kspin_l
  s_branch G2_h1_ret
G2_osw:
  s_mov_b32 s20, s6
  s_and_b32 s21, s7, 0xffff
  s_mov_b32 s22, 0x200000
  s_mov_b32 s23, 0x20000
  s_mov_b32 s41, 0
  s_mov_b32 s64, 65536
  s_mov_b32 s65, 65536
  s_mov_b32 s66, 65536
  s_mov_b32 s67, 65536
  s_mov_b32 s42, 458752
  v_add_u32 v229, 0x100000, v228
  s_waitcnt vmcnt(12)
  v_cmp_ne_u32 vcc, s3, v231
  s_nop 1
  s_and_b64 vcc, vcc, 0xffff
  s_cbranch_scc0 G2_h1_ret
G2_ospin:
  s_mov_b32 s98, 0
G2_ospin_l:
  s_sleep 2
  buffer_load_dword v231, v232, s[84:87], s63 offen sc1
  s_add_u32 s98, s98, 1
  s_cmp_gt_u32 s98, 400000
  s_cbranch_scc1 G2_h1_ret
  s_waitcnt vmcnt(0)
  v_cmp_ne_u32 vcc, s3, v231
  s_nop 1
  s_and_b64 vcc, vcc, 0xffff
  s_cbranch_scc1 G2_ospin_l
  s_branch G2_h1_ret
MG_hot_end:
W1_spin:
  s_mov_b32 s98, 0
W1_spin_l:
  s_sleep 2
  buffer_load_dword v231, v232, s[84:87], s99 offen sc1
  s_add_u32 s98, s98, 1
  s_cmp_gt_u32 s98, 400000
  s_cbranch_scc1 W1_go
  s_waitcnt vmcnt(0)
  v_cmp_ne_u32 vcc, s3, v231
  s_nop 1
  s_and_b64 vcc, vcc, 0xffff
  s_cbranch_scc1 W1_spin_l
  s_branch W1_go
AT_qa:
  s_mov_b32 s98, 0
AT_qa_l:
  s_sleep 2
  buffer_load_dword v3, v2, s[84:87], s99 offen sc1
  s_add_u32 s98, s98, 1
  s_cmp_gt_u32 s98, 400000
  s_cbranch_scc1 AT_qa_go
  s_waitcnt vmcnt(0)
  v_cmp_ne_u32 vcc, s3, v3
  s_nop 1
  s_and_b64 vcc, vcc, s[96:97]
  s_cbranch_scc1 AT_qa_l
  s_branch AT_qa_go
AT_qa_go:
  s_add_u32 m0, s94, 0
  s_add_u32 s93, s83, 8372224
  buffer_load_dwordx4 v1, s[84:87], s93 offen offset:0 sc1 lds
  buffer_load_dwordx4 v1, s[84:87], s93 offen offset:1024 sc1 lds
  s_add_u32 m0, s94, 6144
  s_nop 0
  buffer_load_dwordx4 v1, s[84:87], s93 offen offset:2048 sc1 lds
  buffer_load_dwordx4 v1, s[84:87], s93 offen offset:3072 sc1 lds
  s_add_u32 m0, s94, 32768
  s_add_u32 s93, s83, 12566528
  buffer_load_dwordx4 v1, s[84:87], s93 offen offset:0 sc1 lds
  buffer_load_dwordx4 v1, s[84:87], s93 offen offset:1024 sc1 lds
  s_add_u32 m0, s94, 38912
  s_nop 0
  buffer_load_dwordx4 v1, s[84:87], s93 offen offset:2048 sc1 lds
  buffer_load_dwordx4 v1, s[84:87], s93 offen offset:3072 sc1 lds
  s_waitcnt vmcnt(0)
  s_branch AT_qa_ret
AT_qb:
  v_mov_b32 v2, 2048
AT_qbs:
  s_mov_b32 s98, 0
AT_qbs_l:
  s_sleep 2
  buffer_load_dword v0, v2, s[84:87], s99 offen sc1
  s_add_u32 s98, s98, 1
  s_cmp_gt_u32 s98, 400000
  s_cbranch_scc1 AT_qb_ret
  s_waitcnt vmcnt(0)
  v_cmp_ne_u32 vcc, s3, v0
  s_nop 1
  s_and_b64 vcc, vcc, s[96:97]
  s_cbranch_scc1 AT_qbs_l
  s_branch AT_qb_ret
AT_inv9:
  s_nop 3
  v_mov_b32 v104, v6
  v_mov_b32 v105, v6
  v_mov_b32 v106, v6
  v_mov_b32 v107, v6
  v_mov_b32 v108, v6
  v_mov_b32 v109, v6
  v_mov_b32 v110, v6
  v_mov_b32 v111, v6
  s_branch AT_inv9_ret
AT_inv10:
  s_nop 3
  v_mov_b32 v104, v6
  v_mov_b32 v105, v6
  v_mov_b32 v106, v6
  v_mov_b32 v107, v6
  v_mov_b32 v108, v6
  v_mov_b32 v109, v6
  v_mov_b32 v110, v6
  v_mov_b32 v111, v6
  s_branch AT_inv10_ret
AT_inv11:
  s_nop 3
  v_mov_b32 v104, v6
  v_mov_b32 v105, v6
  v_mov_b32 v106, v6
  v_mov_b32 v107, v6
  v_mov_b32 v108, v6
  v_mov_b32 v109, v6
  v_mov_b32 v110, v6
  v_mov_b32 v111, v6
  s_branch AT_inv11_ret
AT_inv12:
  s_nop 3
  v_mov_b32 v104, v6
  v_mov_b32 v105, v6
  v_mov_b32 v106, v6
  v_mov_b32 v107, v6
  v_mov_b32 v108, v6
  v_mov_b32 v109, v6
  v_mov_b32 v110, v6
  v_mov_b32 v111, v6
  v_mov_b32 v128, v6
  v_mov_b32 v129, v6
  v_mov_b32 v130, v6
  v_mov_b32 v131, v6
  v_mov_b32 v132, v6
  v_mov_b32 v133, v6
  v_mov_b32 v134, v6
  v_mov_b32 v135, v6
  s_branch AT_inv12_ret
AT_inv13:
  s_nop 3
  v_mov_b32 v216, v6
  v_mov_b32 v217, v6
  v_mov_b32 v218, v6
  v_mov_b32 v219, v6
  v_mov_b32 v220, v6
  v_mov_b32 v221, v6
  v_mov_b32 v222, v6
  v_mov_b32 v223, v6
  s_branch AT_inv13_ret
AT_inv14:
  s_nop 3
  v_mov_b32 v216, v6
  v_mov_b32 v217, v6
  v_mov_b32 v218, v6
  v_mov_b32 v219, v6
  v_mov_b32 v220, v6
  v_mov_b32 v221, v6
  v_mov_b32 v222, v6
  v_mov_b32 v223, v6
  s_branch AT_inv14_ret
AT_inv15:
  s_nop 3
  v_mov_b32 v216, v6
  v_mov_b32 v217, v6
  v_mov_b32 v218, v6
  v_mov_b32 v219, v6
  v_mov_b32 v220, v6
  v_mov_b32 v221, v6
  v_mov_b32 v222, v6
  v_mov_b32 v223, v6
  s_branch AT_inv15_ret
AT_inv16:
  s_nop 3
  v_mov_b32 v216, v6
  v_mov_b32 v217, v6
  v_mov_b32 v218, v6
  v_mov_b32 v219, v6
  v_mov_b32 v220, v6
  v_mov_b32 v221, v6
  v_mov_b32 v222, v6
  v_mov_b32 v223, v6
  v_mov_b32 v128, v6
  v_mov_b32 v129, v6
  v_mov_b32 v130, v6
  v_mov_b32 v131, v6
  v_mov_b32 v132, v6
  v_mov_b32 v133, v6
  v_mov_b32 v134, v6
  v_mov_b32 v135, v6
  s_branch AT_inv16_ret
AT_inv18:
  s_nop 3
  v_mov_b32 v104, v6
  v_mov_b32 v105, v6
  v_mov_b32 v106, v6
  v_mov_b32 v107, v6
  v_mov_b32 v108, v6
  v_mov_b32 v109, v6
  v_mov_b32 v110, v6
  v_mov_b32 v111, v6
  s_branch AT_inv18_ret
AT_inv19:
  s_nop 3
  v_mov_b32 v104, v6
  v_mov_b32 v105, v6
  v_mov_b32 v106, v6
  v_mov_b32 v107, v6
  v_mov_b32 v108, v6
  v_mov_b32 v109, v6
  v_mov_b32 v110, v6
  v_mov_b32 v111, v6
  s_branch AT_inv19_ret
AT_inv20:
  s_nop 3
  v_mov_b32 v104, v6
  v_mov_b32 v105, v6
  v_mov_b32 v106, v6
  v_mov_b32 v107, v6
  v_mov_b32 v108, v6
  v_mov_b32 v109, v6
  v_mov_b32 v110, v6
  v_mov_b32 v111, v6
  s_branch AT_inv20_ret
AT_inv21:
  s_nop 3
  v_mov_b32 v104, v6
  v_mov_b32 v105, v6
  v_mov_b32 v106, v6
  v_mov_b32 v107, v6
  v_mov_b32 v108, v6
  v_mov_b32 v109, v6
  v_mov_b32 v110, v6
  v_mov_b32 v111, v6
  s_branch AT_inv21_ret
AT_inv22:
  s_nop 3
  v_mov_b32 v104, v6
  v_mov_b32 v105, v6
  v_mov_b32 v106, v6
  v_mov_b32 v107, v6
  v_mov_b32 v108, v6
  v_mov_b32 v109, v6
  v_mov_b32 v110, v6
  v_mov_b32 v111, v6
  s_branch AT_inv22_ret
AT_inv23:
  s_nop 3
  v_mov_b32 v104, v6
  v_mov_b32 v105, v6
  v_mov_b32 v106, v6
  v_mov_b32 v107, v6
  v_mov_b32 v108, v6
  v_mov_b32 v109, v6
  v_mov_b32 v110, v6
  v_mov_b32 v111, v6
  s_branch AT_inv23_ret
AT_inv24:
  s_nop 3
  v_mov_b32 v104, v6
  v_mov_b32 v105, v6
  v_mov_b32 v106, v6
  v_mov_b32 v107, v6
  v_mov_b32 v108, v6
  v_mov_b32 v109, v6
  v_mov_b32 v110, v6
  v_mov_b32 v111, v6
  s_branch AT_inv24_ret
AT_inv25:
  s_nop 3
  v_mov_b32 v104, v6
  v_mov_b32 v105, v6
  v_mov_b32 v106, v6
  v_mov_b32 v107, v6
  v_mov_b32 v108, v6
  v_mov_b32 v109, v6
  v_mov_b32 v110, v6
  v_mov_b32 v111, v6
  v_mov_b32 v128, v6
  v_mov_b32 v129, v6
  v_mov_b32 v130, v6
  v_mov_b32 v131, v6
  v_mov_b32 v132, v6
  v_mov_b32 v133, v6
  v_mov_b32 v134, v6
  v_mov_b32 v135, v6
  s_branch AT_inv25_ret
AT_inv27:
  s_nop 3
  v_mov_b32 v216, v6
  v_mov_b32 v217, v6
  v_mov_b32 v218, v6
  v_mov_b32 v219, v6
  v_mov_b32 v220, v6
  v_mov_b32 v221, v6
  v_mov_b32 v222, v6
  v_mov_b32 v223, v6
  s_branch AT_inv27_ret
AT_inv28:
  s_nop 3
  v_mov_b32 v216, v6
  v_mov_b32 v217, v6
  v_mov_b32 v218, v6
  v_mov_b32 v219, v6
  v_mov_b32 v220, v6
  v_mov_b32 v221, v6
  v_mov_b32 v222, v6
  v_mov_b32 v223, v6
  s_branch AT_inv28_ret
AT_inv29:
  s_nop 3
  v_mov_b32 v216, v6
  v_mov_b32 v217, v6
  v_mov_b32 v218, v6
  v_mov_b32 v219, v6
  v_mov_b32 v220, v6
  v_mov_b32 v221, v6
  v_mov_b32 v222, v6
  v_mov_b32 v223, v6
  s_branch AT_inv29_ret
AT_inv30:
  s_nop 3
  v_mov_b32 v216, v6
  v_mov_b32 v217, v6
  v_mov_b32 v218, v6
  v_mov_b32 v219, v6
  v_mov_b32 v220, v6
  v_mov_b32 v221, v6
  v_mov_b32 v222, v6
  v_mov_b32 v223, v6
  s_branch AT_inv30_ret
AT_inv31:
  s_nop 3
  v_mov_b32 v216, v6
  v_mov_b32 v217, v6
  v_mov_b32 v218, v6
  v_mov_b32 v219, v6
  v_mov_b32 v220, v6
  v_mov_b32 v221, v6
  v_mov_b32 v222, v6
  v_mov_b32 v223, v6
  s_branch AT_inv31_ret
AT_inv32:
  s_nop 3
  v_mov_b32 v216, v6
  v_mov_b32 v217, v6
  v_mov_b32 v218, v6
  v_mov_b32 v219, v6
  v_mov_b32 v220, v6
  v_mov_b32 v221, v6
  v_mov_b32 v222, v6
  v_mov_b32 v223, v6
  s_branch AT_inv32_ret
AT_inv33:
  s_nop 3
  v_mov_b32 v216, v6
  v_mov_b32 v217, v6
  v_mov_b32 v218, v6
  v_mov_b32 v219, v6
  v_mov_b32 v220, v6
  v_mov_b32 v221, v6
  v_mov_b32 v222, v6
  v_mov_b32 v223, v6
  s_branch AT_inv33_ret
AT_inv34:
  s_nop 3
  v_mov_b32 v216, v6
  v_mov_b32 v217, v6
  v_mov_b32 v218, v6
  v_mov_b32 v219, v6
  v_mov_b32 v220, v6
  v_mov_b32 v221, v6
  v_mov_b32 v222, v6
  v_mov_b32 v223, v6
  v_mov_b32 v128, v6
  v_mov_b32 v129, v6
  v_mov_b32 v130, v6
  v_mov_b32 v131, v6
  v_mov_b32 v132, v6
  v_mov_b32 v133, v6
  v_mov_b32 v134, v6
  v_mov_b32 v135, v6
  s_branch AT_inv34_ret
AT_slow:
  s_mov_b32 s50, 0
AS_task:
  v_accvgpr_mov_b32 a44, a64
  v_accvgpr_mov_b32 a45, a65
  v_accvgpr_mov_b32 a46, a66
  v_accvgpr_mov_b32 a47, a67
  v_accvgpr_mov_b32 a48, a68
  v_accvgpr_mov_b32 a49, a69
  v_accvgpr_mov_b32 a50, a70
  v_accvgpr_mov_b32 a51, a71
  v_accvgpr_mov_b32 a64, a72
  v_accvgpr_mov_b32 a65, a73
  v_accvgpr_mov_b32 a66, a74
  v_accvgpr_mov_b32 a67, a75
  v_accvgpr_mov_b32 a68, a76
  v_accvgpr_mov_b32 a69, a77
  v_accvgpr_mov_b32 a70, a78
  v_accvgpr_mov_b32 a71, a79
  v_accvgpr_mov_b32 a72, a80
  v_accvgpr_mov_b32 a73, a81
  v_accvgpr_mov_b32 a74, a82
  v_accvgpr_mov_b32 a75, a83
  v_accvgpr_mov_b32 a76, a84
  v_accvgpr_mov_b32 a77, a85
  v_accvgpr_mov_b32 a78, a86
  v_accvgpr_mov_b32 a79, a87
  v_accvgpr_mov_b32 a80, a88
  v_accvgpr_mov_b32 a81, a89
  v_accvgpr_mov_b32 a82, a90
  v_accvgpr_mov_b32 a83, a91
  v_accvgpr_mov_b32 a84, a92
  v_accvgpr_mov_b32 a85, a93
  v_accvgpr_mov_b32 a86, a94
  v_accvgpr_mov_b32 a87, a95
  s_lshr_b32 s54, s50, 1
  s_and_b32 s55, s50, 1
  s_lshl_b32 s51, s88, 1
  s_add_u32 s51, s51, s54
  s_lshl_b32 s51, s51, 17
  s_lshl_b32 s56, s55, 2
  s_add_u32 s52, s92, s56
  s_add_u32 s56, s56, s40
  s_lshl_b32 s57, s89, 3
  s_add_u32 s56, s56, s57
  s_lshl_b32 s54, s54, 12
  s_lshl_b32 s55, s55, 11
  s_add_u32 s53, s90, s54
  s_add_u32 s53, s53, s55
  v_mov_b32 v40, 0
  v_mov_b32 v44, v100
  v_mov_b32 v41, 0
  v_mov_b32 v45, v101
  v_mov_b32 v42, 0
  v_mov_b32 v46, v102
  v_mov_b32 v43, 0
  v_mov_b32 v47, v103
  v_mov_b32 v236, v6
  v_mov_b32 v237, v6
  s_cmp_le_u32 s52, 0
  s_cbranch_scc1 AS_end0
  s_sub_u32 s57, s56, 0
  s_lshr_b32 s58, s57, 3
  s_lshl_b32 s58, s58, 14
  s_and_b32 s59, s57, 3
  s_lshl_b32 s59, s59, 12
  s_add_u32 s58, s58, s59
  s_bfe_u32 s59, s57, 0x10002
  s_lshl_b32 s59, s59, 11
  s_add_u32 s58, s58, s59
  s_add_u32 s58, s58, s51
  s_add_u32 s54, s58, 8388608
  s_add_u32 s55, s58, 12582912
  buffer_load_dwordx4 a[0:3], v1, s[84:87], s54 offen offset:0 sc1
  buffer_load_dwordx4 a[4:7], v1, s[84:87], s54 offen offset:1024 sc1
  s_waitcnt vmcnt(0)
  v_mfma_f32_16x16x32_bf16 v[8:11], a[0:3], a[44:47], v[96:99]
  v_mfma_f32_16x16x32_bf16 v[16:19], a[0:3], a[48:51], v[40:43]
  v_mfma_f32_16x16x32_bf16 v[20:23], a[4:7], a[48:51], v[96:99]
  s_nop 7
  v_max3_f32 v236, v236, v8, v9
  v_max3_f32 v236, v236, v10, v11
  v_max3_f32 v237, v237, v16, v17
  v_max3_f32 v237, v237, v18, v19
  v_max3_f32 v237, v237, v20, v21
  v_max3_f32 v237, v237, v22, v23
  s_cmp_le_u32 s52, 1
  s_cbranch_scc1 AS_end0
  s_sub_u32 s57, s56, 1
  s_lshr_b32 s58, s57, 3
  s_lshl_b32 s58, s58, 14
  s_and_b32 s59, s57, 3
  s_lshl_b32 s59, s59, 12
  s_add_u32 s58, s58, s59
  s_bfe_u32 s59, s57, 0x10002
  s_lshl_b32 s59, s59, 11
  s_add_u32 s58, s58, s59
  s_add_u32 s58, s58, s51
  s_add_u32 s54, s58, 8388608
  s_add_u32 s55, s58, 12582912
  buffer_load_dwordx4 a[0:3], v1, s[84:87], s54 offen offset:0 sc1
  buffer_load_dwordx4 a[4:7], v1, s[84:87], s54 offen offset:1024 sc1
  s_waitcnt vmcnt(0)
  v_mfma_f32_16x16x32_bf16 v[8:11], a[0:3], a[44:47], v[40:43]
  v_mfma_f32_16x16x32_bf16 v[12:15], a[4:7], a[44:47], v[40:43]
  v_mfma_f32_16x16x32_bf16 v[16:19], a[0:3], a[48:51], v[40:43]
  v_mfma_f32_16x16x32_bf16 v[20:23], a[4:7], a[48:51], v[40:43]
  s_nop 7
  v_max3_f32 v236, v236, v8, v9
  v_max3_f32 v236, v236, v10, v11
  v_max3_f32 v236, v236, v12, v13
  v_max3_f32 v236, v236, v14, v15
  v_max3_f32 v237, v237, v16, v17
  v_max3_f32 v237, v237, v18, v19
  v_max3_f32 v237, v237, v20, v21
  v_max3_f32 v237, v237, v22, v23
  s_cmp_le_u32 s52, 2
  s_cbranch_scc1 AS_end0
  s_sub_u32 s57, s56, 2
  s_lshr_b32 s58, s57, 3
  s_lshl_b32 s58, s58, 14
  s_and_b32 s59, s57, 3
  s_lshl_b32 s59, s59, 12
  s_add_u32 s58, s58, s59
  s_bfe_u32 s59, s57, 0x10002
  s_lshl_b32 s59, s59, 11
  s_add_u32 s58, s58, s59
  s_add_u32 s58, s58, s51
  s_add_u32 s54, s58, 8388608
  s_add_u32 s55, s58, 12582912
  buffer_load_dwordx4 a[0:3], v1, s[84:87], s54 offen offset:0 sc1
  buffer_load_dwordx4 a[4:7], v1, s[84:87], s54 offen offset:1024 sc1
  s_waitcnt vmcnt(0)
  v_mfma_f32_16x16x32_bf16 v[8:11], a[0:3], a[44:47], v[40:43]
  v_mfma_f32_16x16x32_bf16 v[12:15], a[4:7], a[44:47], v[40:43]
  v_mfma_f32_16x16x32_bf16 v[16:19], a[0:3], a[48:51], v[40:43]
  v_mfma_f32_16x16x32_bf16 v[20:23], a[4:7], a[48:51], v[40:43]
  s_nop 7
  v_max3_f32 v236, v236, v8, v9
  v_max3_f32 v236, v236, v10, v11
  v_max3_f32 v236, v236, v12, v13
  v_max3_f32 v236, v236, v14, v15
  v_max3_f32 v237, v237, v16, v17
  v_max3_f32 v237, v237, v18, v19
  v_max3_f32 v237, v237, v20, v21
  v_max3_f32 v237, v237, v22, v23
  s_cmp_le_u32 s52, 3
  s_cbranch_scc1 AS_end0
  s_sub_u32 s57, s56, 3
  s_lshr_b32 s58, s57, 3
  s_lshl_b32 s58, s58, 14
  s_and_b32 s59, s57, 3
  s_lshl_b32 s59, s59, 12
  s_add_u32 s58, s58, s59
  s_bfe_u32 s59, s57, 0x10002
  s_lshl_b32 s59, s59, 11
  s_add_u32 s58, s58, s59
  s_add_u32 s58, s58, s51
  s_add_u32 s54, s58, 8388608
  s_add_u32 s55, s58, 12582912
  buffer_load_dwordx4 a[0:3], v1, s[84:87], s54 offen offset:0 sc1
  buffer_load_dwordx4 a[4:7], v1, s[84:87], s54 offen offset:1024 sc1
  s_waitcnt vmcnt(0)
  v_mfma_f32_16x16x32_bf16 v[8:11], a[0:3], a[44:47], v[40:43]
  v_mfma_f32_16x16x32_bf16 v[12:15], a[4:7], a[44:47], v[40:43]
  v_mfma_f32_16x16x32_bf16 v[16:19], a[0:3], a[48:51], v[40:43]
  v_mfma_f32_16x16x32_bf16 v[20:23], a[4:7], a[48:51], v[40:43]
  s_nop 7
  v_max3_f32 v236, v236, v8, v9
  v_max3_f32 v236, v236, v10, v11
  v_max3_f32 v236, v236, v12, v13
  v_max3_f32 v236, v236, v14, v15
  v_max3_f32 v237, v237, v16, v17
  v_max3_f32 v237, v237, v18, v19
  v_max3_f32 v237, v237, v20, v21
  v_max3_f32 v237, v237, v22, v23
  s_cmp_le_u32 s52, 4
  s_cbranch_scc1 AS_end0
  s_sub_u32 s57, s56, 4
  s_lshr_b32 s58, s57, 3
  s_lshl_b32 s58, s58, 14
  s_and_b32 s59, s57, 3
  s_lshl_b32 s59, s59, 12
  s_add_u32 s58, s58, s59
  s_bfe_u32 s59, s57, 0x10002
  s_lshl_b32 s59, s59, 11
  s_add_u32 s58, s58, s59
  s_add_u32 s58, s58, s51
  s_add_u32 s54, s58, 8388608
  s_add_u32 s55, s58, 12582912
  buffer_load_dwordx4 a[0:3], v1, s[84:87], s54 offen offset:0 sc1
  buffer_load_dwordx4 a[4:7], v1, s[84:87], s54 offen offset:1024 sc1
  s_waitcnt vmcnt(0)
  v_mfma_f32_16x16x32_bf16 v[8:11], a[0:3], a[44:47], v[40:43]
  v_mfma_f32_16x16x32_bf16 v[12:15], a[4:7], a[44:47], v[40:43]
  v_mfma_f32_16x16x32_bf16 v[16:19], a[0:3], a[48:51], v[40:43]
  v_mfma_f32_16x16x32_bf16 v[20:23], a[4:7], a[48:51], v[40:43]
  s_nop 7
  v_max3_f32 v236, v236, v8, v9
  v_max3_f32 v236, v236, v10, v11
  v_max3_f32 v236, v236, v12, v13
  v_max3_f32 v236, v236, v14, v15
  v_max3_f32 v237, v237, v16, v17
  v_max3_f32 v237, v237, v18, v19
  v_max3_f32 v237, v237, v20, v21
  v_max3_f32 v237, v237, v22, v23
  s_cmp_le_u32 s52, 5
  s_cbranch_scc1 AS_end0
  s_sub_u32 s57, s56, 5
  s_lshr_b32 s58, s57, 3
  s_lshl_b32 s58, s58, 14
  s_and_b32 s59, s57, 3
  s_lshl_b32 s59, s59, 12
  s_add_u32 s58, s58, s59
  s_bfe_u32 s59, s57, 0x10002
  s_lshl_b32 s59, s59, 11
  s_add_u32 s58, s58, s59
  s_add_u32 s58, s58, s51
  s_add_u32 s54, s58, 8388608
  s_add_u32 s55, s58, 12582912
  buffer_load_dwordx4 a[0:3], v1, s[84:87], s54 offen offset:0 sc1
  buffer_load_dwordx4 a[4:7], v1, s[84:87], s54 offen offset:1024 sc1
  s_waitcnt vmcnt(0)
  v_mfma_f32_16x16x32_bf16 v[8:11], a[0:3], a[44:47], v[40:43]
  v_mfma_f32_16x16x32_bf16 v[12:15], a[4:7], a[44:47], v[40:43]
  v_mfma_f32_16x16x32_bf16 v[16:19], a[0:3], a[48:51], v[40:43]
  v_mfma_f32_16x16x32_bf16 v[20:23], a[4:7], a[48:51], v[40:43]
  s_nop 7
  v_max3_f32 v236, v236, v8, v9
  v_max3_f32 v236, v236, v10, v11
  v_max3_f32 v236, v236, v12, v13
  v_max3_f32 v236, v236, v14, v15
  v_max3_f32 v237, v237, v16, v17
  v_max3_f32 v237, v237, v18, v19
  v_max3_f32 v237, v237, v20, v21
  v_max3_f32 v237, v237, v22, v23
  s_cmp_le_u32 s52, 6
  s_cbranch_scc1 AS_end0
  s_sub_u32 s57, s56, 6
  s_lshr_b32 s58, s57, 3
  s_lshl_b32 s58, s58, 14
  s_and_b32 s59, s57, 3
  s_lshl_b32 s59, s59, 12
  s_add_u32 s58, s58, s59
  s_bfe_u32 s59, s57, 0x10002
  s_lshl_b32 s59, s59, 11
  s_add_u32 s58, s58, s59
  s_add_u32 s58, s58, s51
  s_add_u32 s54, s58, 8388608
  s_add_u32 s55, s58, 12582912
  buffer_load_dwordx4 a[0:3], v1, s[84:87], s54 offen offset:0 sc1
  buffer_load_dwordx4 a[4:7], v1, s[84:87], s54 offen offset:1024 sc1
  s_waitcnt vmcnt(0)
  v_mfma_f32_16x16x32_bf16 v[8:11], a[0:3], a[44:47], v[40:43]
  v_mfma_f32_16x16x32_bf16 v[12:15], a[4:7], a[44:47], v[40:43]
  v_mfma_f32_16x16x32_bf16 v[16:19], a[0:3], a[48:51], v[40:43]
  v_mfma_f32_16x16x32_bf16 v[20:23], a[4:7], a[48:51], v[40:43]
  s_nop 7
  v_max3_f32 v236, v236, v8, v9
  v_max3_f32 v236, v236, v10, v11
  v_max3_f32 v236, v236, v12, v13
  v_max3_f32 v236, v236, v14, v15
  v_max3_f32 v237, v237, v16, v17
  v_max3_f32 v237, v237, v18, v19
  v_max3_f32 v237, v237, v20, v21
  v_max3_f32 v237, v237, v22, v23
  s_cmp_le_u32 s52, 7
  s_cbranch_scc1 AS_end0
  s_sub_u32 s57, s56, 7
  s_lshr_b32 s58, s57, 3
  s_lshl_b32 s58, s58, 14
  s_and_b32 s59, s57, 3
  s_lshl_b32 s59, s59, 12
  s_add_u32 s58, s58, s59
  s_bfe_u32 s59, s57, 0x10002
  s_lshl_b32 s59, s59, 11
  s_add_u32 s58, s58, s59
  s_add_u32 s58, s58, s51
  s_add_u32 s54, s58, 8388608
  s_add_u32 s55, s58, 12582912
  buffer_load_dwordx4 a[0:3], v1, s[84:87], s54 offen offset:0 sc1
  buffer_load_dwordx4 a[4:7], v1, s[84:87], s54 offen offset:1024 sc1
  s_waitcnt vmcnt(0)
  v_mfma_f32_16x16x32_bf16 v[8:11], a[0:3], a[44:47], v[40:43]
  v_mfma_f32_16x16x32_bf16 v[12:15], a[4:7], a[44:47], v[40:43]
  v_mfma_f32_16x16x32_bf16 v[16:19], a[0:3], a[48:51], v[40:43]
  v_mfma_f32_16x16x32_bf16 v[20:23], a[4:7], a[48:51], v[40:43]
  s_nop 7
  v_max3_f32 v236, v236, v8, v9
  v_max3_f32 v236, v236, v10, v11
  v_max3_f32 v236, v236, v12, v13
  v_max3_f32 v236, v236, v14, v15
  v_max3_f32 v237, v237, v16, v17
  v_max3_f32 v237, v237, v18, v19
  v_max3_f32 v237, v237, v20, v21
  v_max3_f32 v237, v237, v22, v23
  s_cmp_le_u32 s52, 8
  s_cbranch_scc1 AS_end0
  s_sub_u32 s57, s56, 8
  s_lshr_b32 s58, s57, 3
  s_lshl_b32 s58, s58, 14
  s_and_b32 s59, s57, 3
  s_lshl_b32 s59, s59, 12
  s_add_u32 s58, s58, s59
  s_bfe_u32 s59, s57, 0x10002
  s_lshl_b32 s59, s59, 11
  s_add_u32 s58, s58, s59
  s_add_u32 s58, s58, s51
  s_add_u32 s54, s58, 8388608
  s_add_u32 s55, s58, 12582912
  buffer_load_dwordx4 a[0:3], v1, s[84:87], s54 offen offset:0 sc1
  buffer_load_dwordx4 a[4:7], v1, s[84:87], s54 offen offset:1024 sc1
  s_waitcnt vmcnt(0)
  v_mfma_f32_16x16x32_bf16 v[8:11], a[0:3], a[44:47], v[44:47]
  v_mfma_f32_16x16x32_bf16 v[12:15], a[4:7], a[44:47], v[40:43]
  v_mfma_f32_16x16x32_bf16 v[20:23], a[4:7], a[48:51], v[44:47]
  s_nop 7
  v_max3_f32 v236, v236, v8, v9
  v_max3_f32 v236, v236, v10, v11
  v_max3_f32 v236, v236, v12, v13
  v_max3_f32 v236, v236, v14, v15
  v_max3_f32 v237, v237, v20, v21
  v_max3_f32 v237, v237, v22, v23
AS_end0:
  v_mov_b32 v4, v236
  v_mov_b32 v5, v237
  s_nop 0
  v_permlane16_swap_b32 v236, v4
  v_permlane16_swap_b32 v237, v5
  v_max_f32 v236, v236, v4
  v_max_f32 v237, v237, v5
  v_mov_b32 v4, v236
  v_mov_b32 v5, v237
  s_nop 0
  v_permlane32_swap_b32 v236, v4
  v_permlane32_swap_b32 v237, v5
  v_max_f32 v236, v236, v4
  v_max_f32 v237, v237, v5
  v_sub_f32 v48, v96, v236
  v_sub_f32 v40, v100, v236
  v_sub_f32 v49, v97, v236
  v_sub_f32 v41, v101, v236
  v_sub_f32 v50, v98, v236
  v_sub_f32 v42, v102, v236
  v_sub_f32 v51, v99, v236
  v_sub_f32 v43, v103, v236
  v_sub_f32 v52, v96, v237
  v_sub_f32 v44, v100, v237
  v_sub_f32 v53, v97, v237
  v_sub_f32 v45, v101, v237
  v_sub_f32 v54, v98, v237
  v_sub_f32 v46, v102, v237
  v_sub_f32 v55, v99, v237
  v_sub_f32 v47, v103, v237
  v_sub_f32 v104, 0, v236
  v_sub_f32 v105, 0, v236
  v_sub_f32 v106, 0, v236
  v_sub_f32 v107, 0, v236
  v_sub_f32 v108, 0, v237
  v_sub_f32 v109, 0, v237
  v_sub_f32 v110, 0, v237
  v_sub_f32 v111, 0, v237
  s_cmp_le_u32 s52, 0
  s_cbranch_scc1 AS_end1
  s_sub_u32 s57, s56, 0
  s_lshr_b32 s58, s57, 3
  s_lshl_b32 s58, s58, 14
  s_and_b32 s59, s57, 3
  s_lshl_b32 s59, s59, 12
  s_add_u32 s58, s58, s59
  s_bfe_u32 s59, s57, 0x10002
  s_lshl_b32 s59, s59, 11
  s_add_u32 s58, s58, s59
  s_add_u32 s58, s58, s51
  s_add_u32 s54, s58, 8388608
  s_add_u32 s55, s58, 12582912
  buffer_load_dwordx4 a[0:3], v1, s[84:87], s54 offen offset:0 sc1
  buffer_load_dwordx4 a[16:19], v1, s[84:87], s55 offen offset:0 sc1
  buffer_load_dwordx4 a[4:7], v1, s[84:87], s54 offen offset:1024 sc1
  buffer_load_dwordx4 a[20:23], v1, s[84:87], s55 offen offset:1024 sc1
  s_waitcnt vmcnt(0)
  v_mfma_f32_16x16x32_bf16 v[8:11], a[0:3], a[44:47], v[48:51]
  v_mfma_f32_16x16x32_bf16 v[16:19], a[0:3], a[48:51], v[108:111]
  v_mfma_f32_16x16x32_bf16 v[20:23], a[4:7], a[48:51], v[52:55]
  s_nop 7
  v_exp_f32 v8, v8
  v_exp_f32 v9, v9
  v_exp_f32 v10, v10
  v_exp_f32 v11, v11
  v_exp_f32 v16, v16
  v_exp_f32 v17, v17
  v_exp_f32 v18, v18
  v_exp_f32 v19, v19
  v_exp_f32 v20, v20
  v_exp_f32 v21, v21
  v_exp_f32 v22, v22
  v_exp_f32 v23, v23
  s_nop 0
  v_cvt_pk_bf16_f32 v56, v8, v9
  v_cvt_pk_bf16_f32 v57, v10, v11
  v_mov_b32 v58, 0
  v_mov_b32 v59, 0
  v_cvt_pk_bf16_f32 v60, v16, v17
  v_cvt_pk_bf16_f32 v61, v18, v19
  v_cvt_pk_bf16_f32 v62, v20, v21
  v_cvt_pk_bf16_f32 v63, v22, v23
  s_nop 1
  v_mfma_f32_16x16x32_bf16 v[72:75], a[16:19], v[56:59], 0
  v_mfma_f32_16x16x32_bf16 v[76:79], a[20:23], v[56:59], 0
  v_mfma_f32_16x16x32_bf16 v[80:83], a[32:35], v[56:59], 0
  v_mfma_f32_16x16x32_bf16 v[84:87], a[16:19], v[60:63], 0
  v_mfma_f32_16x16x32_bf16 v[88:91], a[20:23], v[60:63], 0
  v_mfma_f32_16x16x32_bf16 v[92:95], a[32:35], v[60:63], 0
  s_cmp_le_u32 s52, 1
  s_cbranch_scc1 AS_end1
  s_sub_u32 s57, s56, 1
  s_lshr_b32 s58, s57, 3
  s_lshl_b32 s58, s58, 14
  s_and_b32 s59, s57, 3
  s_lshl_b32 s59, s59, 12
  s_add_u32 s58, s58, s59
  s_bfe_u32 s59, s57, 0x10002
  s_lshl_b32 s59, s59, 11
  s_add_u32 s58, s58, s59
  s_add_u32 s58, s58, s51
  s_add_u32 s54, s58, 8388608
  s_add_u32 s55, s58, 12582912
  buffer_load_dwordx4 a[0:3], v1, s[84:87], s54 offen offset:0 sc1
  buffer_load_dwordx4 a[16:19], v1, s[84:87], s55 offen offset:0 sc1
  buffer_load_dwordx4 a[4:7], v1, s[84:87], s54 offen offset:1024 sc1
  buffer_load_dwordx4 a[20:23], v1, s[84:87], s55 offen offset:1024 sc1
  s_waitcnt vmcnt(0)
  v_mfma_f32_16x16x32_bf16 v[8:11], a[0:3], a[44:47], v[104:107]
  v_mfma_f32_16x16x32_bf16 v[12:15], a[4:7], a[44:47], v[104:107]
  v_mfma_f32_16x16x32_bf16 v[16:19], a[0:3], a[48:51], v[108:111]
  v_mfma_f32_16x16x32_bf16 v[20:23], a[4:7], a[48:51], v[108:111]
  s_nop 7
  v_exp_f32 v8, v8
  v_exp_f32 v9, v9
  v_exp_f32 v10, v10
  v_exp_f32 v11, v11
  v_exp_f32 v12, v12
  v_exp_f32 v13, v13
  v_exp_f32 v14, v14
  v_exp_f32 v15, v15
  v_exp_f32 v16, v16
  v_exp_f32 v17, v17
  v_exp_f32 v18, v18
  v_exp_f32 v19, v19
  v_exp_f32 v20, v20
  v_exp_f32 v21, v21
  v_exp_f32 v22, v22
  v_exp_f32 v23, v23
  s_nop 0
  v_cvt_pk_bf16_f32 v56, v8, v9
  v_cvt_pk_bf16_f32 v57, v10, v11
  v_cvt_pk_bf16_f32 v58, v12, v13
  v_cvt_pk_bf16_f32 v59, v14, v15
  v_cvt_pk_bf16_f32 v60, v16, v17
  v_cvt_pk_bf16_f32 v61, v18, v19
  v_cvt_pk_bf16_f32 v62, v20, v21
  v_cvt_pk_bf16_f32 v63, v22, v23
  s_nop 1
  v_mfma_f32_16x16x32_bf16 v[72:75], a[16:19], v[56:59], v[72:75]
  v_mfma_f32_16x16x32_bf16 v[76:79], a[20:23], v[56:59], v[76:79]
  v_mfma_f32_16x16x32_bf16 v[80:83], a[32:35], v[56:59], v[80:83]
  v_mfma_f32_16x16x32_bf16 v[84:87], a[16:19], v[60:63], v[84:87]
  v_mfma_f32_16x16x32_bf16 v[88:91], a[20:23], v[60:63], v[88:91]
  v_mfma_f32_16x16x32_bf16 v[92:95], a[32:35], v[60:63], v[92:95]
  s_cmp_le_u32 s52, 2
  s_cbranch_scc1 AS_end1
  s_sub_u32 s57, s56, 2
  s_lshr_b32 s58, s57, 3
  s_lshl_b32 s58, s58, 14
  s_and_b32 s59, s57, 3
  s_lshl_b32 s59, s59, 12
  s_add_u32 s58, s58, s59
  s_bfe_u32 s59, s57, 0x10002
  s_lshl_b32 s59, s59, 11
  s_add_u32 s58, s58, s59
  s_add_u32 s58, s58, s51
  s_add_u32 s54, s58, 8388608
  s_add_u32 s55, s58, 12582912
  buffer_load_dwordx4 a[0:3], v1, s[84:87], s54 offen offset:0 sc1
  buffer_load_dwordx4 a[16:19], v1, s[84:87], s55 offen offset:0 sc1
  buffer_load_dwordx4 a[4:7], v1, s[84:87], s54 offen offset:1024 sc1
  buffer_load_dwordx4 a[20:23], v1, s[84:87], s55 offen offset:1024 sc1
  s_waitcnt vmcnt(0)
  v_mfma_f32_16x16x32_bf16 v[8:11], a[0:3], a[44:47], v[104:107]
  v_mfma_f32_16x16x32_bf16 v[12:15], a[4:7], a[44:47], v[104:107]
  v_mfma_f32_16x16x32_bf16 v[16:19], a[0:3], a[48:51], v[108:111]
  v_mfma_f32_16x16x32_bf16 v[20:23], a[4:7], a[48:51], v[108:111]
  s_nop 7
  v_exp_f32 v8, v8
  v_exp_f32 v9, v9
  v_exp_f32 v10, v10
  v_exp_f32 v11, v11
  v_exp_f32 v12, v12
  v_exp_f32 v13, v13
  v_exp_f32 v14, v14
  v_exp_f32 v15, v15
  v_exp_f32 v16, v16
  v_exp_f32 v17, v17
  v_exp_f32 v18, v18
  v_exp_f32 v19, v19
  v_exp_f32 v20, v20
  v_exp_f32 v21, v21
  v_exp_f32 v22, v22
  v_exp_f32 v23, v23
  s_nop 0
  v_cvt_pk_bf16_f32 v56, v8, v9
  v_cvt_pk_bf16_f32 v57, v10, v11
  v_cvt_pk_bf16_f32 v58, v12, v13
  v_cvt_pk_bf16_f32 v59, v14, v15
  v_cvt_pk_bf16_f32 v60, v16, v17
  v_cvt_pk_bf16_f32 v61, v18, v19
  v_cvt_pk_bf16_f32 v62, v20, v21
  v_cvt_pk_bf16_f32 v63, v22, v23
  s_nop 1
  v_mfma_f32_16x16x32_bf16 v[72:75], a[16:19], v[56:59], v[72:75]
  v_mfma_f32_16x16x32_bf16 v[76:79], a[20:23], v[56:59], v[76:79]
  v_mfma_f32_16x16x32_bf16 v[80:83], a[32:35], v[56:59], v[80:83]
  v_mfma_f32_16x16x32_bf16 v[84:87], a[16:19], v[60:63], v[84:87]
  v_mfma_f32_16x16x32_bf16 v[88:91], a[20:23], v[60:63], v[88:91]
  v_mfma_f32_16x16x32_bf16 v[92:95], a[32:35], v[60:63], v[92:95]
  s_cmp_le_u32 s52, 3
  s_cbranch_scc1 AS_end1
  s_sub_u32 s57, s56, 3
  s_lshr_b32 s58, s57, 3
  s_lshl_b32 s58, s58, 14
  s_and_b32 s59, s57, 3
  s_lshl_b32 s59, s59, 12
  s_add_u32 s58, s58, s59
  s_bfe_u32 s59, s57, 0x10002
  s_lshl_b32 s59, s59, 11
  s_add_u32 s58, s58, s59
  s_add_u32 s58, s58, s51
  s_add_u32 s54, s58, 8388608
  s_add_u32 s55, s58, 12582912
  buffer_load_dwordx4 a[0:3], v1, s[84:87], s54 offen offset:0 sc1
  buffer_load_dwordx4 a[16:19], v1, s[84:87], s55 offen offset:0 sc1
  buffer_load_dwordx4 a[4:7], v1, s[84:87], s54 offen offset:1024 sc1
  buffer_load_dwordx4 a[20:23], v1, s[84:87], s55 offen offset:1024 sc1
  s_waitcnt vmcnt(0)
  v_mfma_f32_16x16x32_bf16 v[8:11], a[0:3], a[44:47], v[104:107]
  v_mfma_f32_16x16x32_bf16 v[12:15], a[4:7], a[44:47], v[104:107]
  v_mfma_f32_16x16x32_bf16 v[16:19], a[0:3], a[48:51], v[108:111]
  v_mfma_f32_16x16x32_bf16 v[20:23], a[4:7], a[48:51], v[108:111]
  s_nop 7
  v_exp_f32 v8, v8
  v_exp_f32 v9, v9
  v_exp_f32 v10, v10
  v_exp_f32 v11, v11
  v_exp_f32 v12, v12
  v_exp_f32 v13, v13
  v_exp_f32 v14, v14
  v_exp_f32 v15, v15
  v_exp_f32 v16, v16
  v_exp_f32 v17, v17
  v_exp_f32 v18, v18
  v_exp_f32 v19, v19
  v_exp_f32 v20, v20
  v_exp_f32 v21, v21
  v_exp_f32 v22, v22
  v_exp_f32 v23, v23
  s_nop 0
  v_cvt_pk_bf16_f32 v56, v8, v9
  v_cvt_pk_bf16_f32 v57, v10, v11
  v_cvt_pk_bf16_f32 v58, v12, v13
  v_cvt_pk_bf16_f32 v59, v14, v15
  v_cvt_pk_bf16_f32 v60, v16, v17
  v_cvt_pk_bf16_f32 v61, v18, v19
  v_cvt_pk_bf16_f32 v62, v20, v21
  v_cvt_pk_bf16_f32 v63, v22, v23
  s_nop 1
  v_mfma_f32_16x16x32_bf16 v[72:75], a[16:19], v[56:59], v[72:75]
  v_mfma_f32_16x16x32_bf16 v[76:79], a[20:23], v[56:59], v[76:79]
  v_mfma_f32_16x16x32_bf16 v[80:83], a[32:35], v[56:59], v[80:83]
  v_mfma_f32_16x16x32_bf16 v[84:87], a[16:19], v[60:63], v[84:87]
  v_mfma_f32_16x16x32_bf16 v[88:91], a[20:23], v[60:63], v[88:91]
  v_mfma_f32_16x16x32_bf16 v[92:95], a[32:35], v[60:63], v[92:95]
  s_cmp_le_u32 s52, 4
  s_cbranch_scc1 AS_end1
  s_sub_u32 s57, s56, 4
  s_lshr_b32 s58, s57, 3
  s_lshl_b32 s58, s58, 14
  s_and_b32 s59, s57, 3
  s_lshl_b32 s59, s59, 12
  s_add_u32 s58, s58, s59
  s_bfe_u32 s59, s57, 0x10002
  s_lshl_b32 s59, s59, 11
  s_add_u32 s58, s58, s59
  s_add_u32 s58, s58, s51
  s_add_u32 s54, s58, 8388608
  s_add_u32 s55, s58, 12582912
  buffer_load_dwordx4 a[0:3], v1, s[84:87], s54 offen offset:0 sc1
  buffer_load_dwordx4 a[16:19], v1, s[84:87], s55 offen offset:0 sc1
  buffer_load_dwordx4 a[4:7], v1, s[84:87], s54 offen offset:1024 sc1
  buffer_load_dwordx4 a[20:23], v1, s[84:87], s55 offen offset:1024 sc1
  s_waitcnt vmcnt(0)
  v_mfma_f32_16x16x32_bf16 v[8:11], a[0:3], a[44:47], v[104:107]
  v_mfma_f32_16x16x32_bf16 v[12:15], a[4:7], a[44:47], v[104:107]
  v_mfma_f32_16x16x32_bf16 v[16:19], a[0:3], a[48:51], v[108:111]
  v_mfma_f32_16x16x32_bf16 v[20:23], a[4:7], a[48:51], v[108:111]
  s_nop 7
  v_exp_f32 v8, v8
  v_exp_f32 v9, v9
  v_exp_f32 v10, v10
  v_exp_f32 v11, v11
  v_exp_f32 v12, v12
  v_exp_f32 v13, v13
  v_exp_f32 v14, v14
  v_exp_f32 v15, v15
  v_exp_f32 v16, v16
  v_exp_f32 v17, v17
  v_exp_f32 v18, v18
  v_exp_f32 v19, v19
  v_exp_f32 v20, v20
  v_exp_f32 v21, v21
  v_exp_f32 v22, v22
  v_exp_f32 v23, v23
  s_nop 0
  v_cvt_pk_bf16_f32 v56, v8, v9
  v_cvt_pk_bf16_f32 v57, v10, v11
  v_cvt_pk_bf16_f32 v58, v12, v13
  v_cvt_pk_bf16_f32 v59, v14, v15
  v_cvt_pk_bf16_f32 v60, v16, v17
  v_cvt_pk_bf16_f32 v61, v18, v19
  v_cvt_pk_bf16_f32 v62, v20, v21
  v_cvt_pk_bf16_f32 v63, v22, v23
  s_nop 1
  v_mfma_f32_16x16x32_bf16 v[72:75], a[16:19], v[56:59], v[72:75]
  v_mfma_f32_16x16x32_bf16 v[76:79], a[20:23], v[56:59], v[76:79]
  v_mfma_f32_16x16x32_bf16 v[80:83], a[32:35], v[56:59], v[80:83]
  v_mfma_f32_16x16x32_bf16 v[84:87], a[16:19], v[60:63], v[84:87]
  v_mfma_f32_16x16x32_bf16 v[88:91], a[20:23], v[60:63], v[88:91]
  v_mfma_f32_16x16x32_bf16 v[92:95], a[32:35], v[60:63], v[92:95]
  s_cmp_le_u32 s52, 5
  s_cbranch_scc1 AS_end1
  s_sub_u32 s57, s56, 5
  s_lshr_b32 s58, s57, 3
  s_lshl_b32 s58, s58, 14
  s_and_b32 s59, s57, 3
  s_lshl_b32 s59, s59, 12
  s_add_u32 s58, s58, s59
  s_bfe_u32 s59, s57, 0x10002
  s_lshl_b32 s59, s59, 11
  s_add_u32 s58, s58, s59
  s_add_u32 s58, s58, s51
  s_add_u32 s54, s58, 8388608
  s_add_u32 s55, s58, 12582912
  buffer_load_dwordx4 a[0:3], v1, s[84:87], s54 offen offset:0 sc1
  buffer_load_dwordx4 a[16:19], v1, s[84:87], s55 offen offset:0 sc1
  buffer_load_dwordx4 a[4:7], v1, s[84:87], s54 offen offset:1024 sc1
  buffer_load_dwordx4 a[20:23], v1, s[84:87], s55 offen offset:1024 sc1
  s_waitcnt vmcnt(0)
  v_mfma_f32_16x16x32_bf16 v[8:11], a[0:3], a[44:47], v[104:107]
  v_mfma_f32_16x16x32_bf16 v[12:15], a[4:7], a[44:47], v[104:107]
  v_mfma_f32_16x16x32_bf16 v[16:19], a[0:3], a[48:51], v[108:111]
  v_mfma_f32_16x16x32_bf16 v[20:23], a[4:7], a[48:51], v[108:111]
  s_nop 7
  v_exp_f32 v8, v8
  v_exp_f32 v9, v9
  v_exp_f32 v10, v10
  v_exp_f32 v11, v11
  v_exp_f32 v12, v12
  v_exp_f32 v13, v13
  v_exp_f32 v14, v14
  v_exp_f32 v15, v15
  v_exp_f32 v16, v16
  v_exp_f32 v17, v17
  v_exp_f32 v18, v18
  v_exp_f32 v19, v19
  v_exp_f32 v20, v20
  v_exp_f32 v21, v21
  v_exp_f32 v22, v22
  v_exp_f32 v23, v23
  s_nop 0
  v_cvt_pk_bf16_f32 v56, v8, v9
  v_cvt_pk_bf16_f32 v57, v10, v11
  v_cvt_pk_bf16_f32 v58, v12, v13
  v_cvt_pk_bf16_f32 v59, v14, v15
  v_cvt_pk_bf16_f32 v60, v16, v17
  v_cvt_pk_bf16_f32 v61, v18, v19
  v_cvt_pk_bf16_f32 v62, v20, v21
  v_cvt_pk_bf16_f32 v63, v22, v23
  s_nop 1
  v_mfma_f32_16x16x32_bf16 v[72:75], a[16:19], v[56:59], v[72:75]
  v_mfma_f32_16x16x32_bf16 v[76:79], a[20:23], v[56:59], v[76:79]
  v_mfma_f32_16x16x32_bf16 v[80:83], a[32:35], v[56:59], v[80:83]
  v_mfma_f32_16x16x32_bf16 v[84:87], a[16:19], v[60:63], v[84:87]
  v_mfma_f32_16x16x32_bf16 v[88:91], a[20:23], v[60:63], v[88:91]
  v_mfma_f32_16x16x32_bf16 v[92:95], a[32:35], v[60:63], v[92:95]
  s_cmp_le_u32 s52, 6
  s_cbranch_scc1 AS_end1
  s_sub_u32 s57, s56, 6
  s_lshr_b32 s58, s57, 3
  s_lshl_b32 s58, s58, 14
  s_and_b32 s59, s57, 3
  s_lshl_b32 s59, s59, 12
  s_add_u32 s58, s58, s59
  s_bfe_u32 s59, s57, 0x10002
  s_lshl_b32 s59, s59, 11
  s_add_u32 s58, s58, s59
  s_add_u32 s58, s58, s51
  s_add_u32 s54, s58, 8388608
  s_add_u32 s55, s58, 12582912
  buffer_load_dwordx4 a[0:3], v1, s[84:87], s54 offen offset:0 sc1
  buffer_load_dwordx4 a[16:19], v1, s[84:87], s55 offen offset:0 sc1
  buffer_load_dwordx4 a[4:7], v1, s[84:87], s54 offen offset:1024 sc1
  buffer_load_dwordx4 a[20:23], v1, s[84:87], s55 offen offset:1024 sc1
  s_waitcnt vmcnt(0)
  v_mfma_f32_16x16x32_bf16 v[8:11], a[0:3], a[44:47], v[104:107]
  v_mfma_f32_16x16x32_bf16 v[12:15], a[4:7], a[44:47], v[104:107]
  v_mfma_f32_16x16x32_bf16 v[16:19], a[0:3], a[48:51], v[108:111]
  v_mfma_f32_16x16x32_bf16 v[20:23], a[4:7], a[48:51], v[108:111]
  s_nop 7
  v_exp_f32 v8, v8
  v_exp_f32 v9, v9
  v_exp_f32 v10, v10
  v_exp_f32 v11, v11
  v_exp_f32 v12, v12
  v_exp_f32 v13, v13
  v_exp_f32 v14, v14
  v_exp_f32 v15, v15
  v_exp_f32 v16, v16
  v_exp_f32 v17, v17
  v_exp_f32 v18, v18
  v_exp_f32 v19, v19
  v_exp_f32 v20, v20
  v_exp_f32 v21, v21
  v_exp_f32 v22, v22
  v_exp_f32 v23, v23
  s_nop 0
  v_cvt_pk_bf16_f32 v56, v8, v9
  v_cvt_pk_bf16_f32 v57, v10, v11
  v_cvt_pk_bf16_f32 v58, v12, v13
  v_cvt_pk_bf16_f32 v59, v14, v15
  v_cvt_pk_bf16_f32 v60, v16, v17
  v_cvt_pk_bf16_f32 v61, v18, v19
  v_cvt_pk_bf16_f32 v62, v20, v21
  v_cvt_pk_bf16_f32 v63, v22, v23
  s_nop 1
  v_mfma_f32_16x16x32_bf16 v[72:75], a[16:19], v[56:59], v[72:75]
  v_mfma_f32_16x16x32_bf16 v[76:79], a[20:23], v[56:59], v[76:79]
  v_mfma_f32_16x16x32_bf16 v[80:83], a[32:35], v[56:59], v[80:83]
  v_mfma_f32_16x16x32_bf16 v[84:87], a[16:19], v[60:63], v[84:87]
  v_mfma_f32_16x16x32_bf16 v[88:91], a[20:23], v[60:63], v[88:91]
  v_mfma_f32_16x16x32_bf16 v[92:95], a[32:35], v[60:63], v[92:95]
  s_cmp_le_u32 s52, 7
  s_cbranch_scc1 AS_end1
  s_sub_u32 s57, s56, 7
  s_lshr_b32 s58, s57, 3
  s_lshl_b32 s58, s58, 14
  s_and_b32 s59, s57, 3
  s_lshl_b32 s59, s59, 12
  s_add_u32 s58, s58, s59
  s_bfe_u32 s59, s57, 0x10002
  s_lshl_b32 s59, s59, 11
  s_add_u32 s58, s58, s59
  s_add_u32 s58, s58, s51
  s_add_u32 s54, s58, 8388608
  s_add_u32 s55, s58, 12582912
  buffer_load_dwordx4 a[0:3], v1, s[84:87], s54 offen offset:0 sc1
  buffer_load_dwordx4 a[16:19], v1, s[84:87], s55 offen offset:0 sc1
  buffer_load_dwordx4 a[4:7], v1, s[84:87], s54 offen offset:1024 sc1
  buffer_load_dwordx4 a[20:23], v1, s[84:87], s55 offen offset:1024 sc1
  s_waitcnt vmcnt(0)
  v_mfma_f32_16x16x32_bf16 v[8:11], a[0:3], a[44:47], v[104:107]
  v_mfma_f32_16x16x32_bf16 v[12:15], a[4:7], a[44:47], v[104:107]
  v_mfma_f32_16x16x32_bf16 v[16:19], a[0:3], a[48:51], v[108:111]
  v_mfma_f32_16x16x32_bf16 v[20:23], a[4:7], a[48:51], v[108:111]
  s_nop 7
  v_exp_f32 v8, v8
  v_exp_f32 v9, v9
  v_exp_f32 v10, v10
  v_exp_f32 v11, v11
  v_exp_f32 v12, v12
  v_exp_f32 v13, v13
  v_exp_f32 v14, v14
  v_exp_f32 v15, v15
  v_exp_f32 v16, v16
  v_exp_f32 v17, v17
  v_exp_f32 v18, v18
  v_exp_f32 v19, v19
  v_exp_f32 v20, v20
  v_exp_f32 v21, v21
  v_exp_f32 v22, v22
  v_exp_f32 v23, v23
  s_nop 0
  v_cvt_pk_bf16_f32 v56, v8, v9
  v_cvt_pk_bf16_f32 v57, v10, v11
  v_cvt_pk_bf16_f32 v58, v12, v13
  v_cvt_pk_bf16_f32 v59, v14, v15
  v_cvt_pk_bf16_f32 v60, v16, v17
  v_cvt_pk_bf16_f32 v61, v18, v19
  v_cvt_pk_bf16_f32 v62, v20, v21
  v_cvt_pk_bf16_f32 v63, v22, v23
  s_nop 1
  v_mfma_f32_16x16x32_bf16 v[72:75], a[16:19], v[56:59], v[72:75]
  v_mfma_f32_16x16x32_bf16 v[76:79], a[20:23], v[56:59], v[76:79]
  v_mfma_f32_16x16x32_bf16 v[80:83], a[32:35], v[56:59], v[80:83]
  v_mfma_f32_16x16x32_bf16 v[84:87], a[16:19], v[60:63], v[84:87]
  v_mfma_f32_16x16x32_bf16 v[88:91], a[20:23], v[60:63], v[88:91]
  v_mfma_f32_16x16x32_bf16 v[92:95], a[32:35], v[60:63], v[92:95]
  s_cmp_le_u32 s52, 8
  s_cbranch_scc1 AS_end1
  s_sub_u32 s57, s56, 8
  s_lshr_b32 s58, s57, 3
  s_lshl_b32 s58, s58, 14
  s_and_b32 s59, s57, 3
  s_lshl_b32 s59, s59, 12
  s_add_u32 s58, s58, s59
  s_bfe_u32 s59, s57, 0x10002
  s_lshl_b32 s59, s59, 11
  s_add_u32 s58, s58, s59
  s_add_u32 s58, s58, s51
  s_add_u32 s54, s58, 8388608
  s_add_u32 s55, s58, 12582912
  buffer_load_dwordx4 a[0:3], v1, s[84:87], s54 offen offset:0 sc1
  buffer_load_dwordx4 a[16:19], v1, s[84:87], s55 offen offset:0 sc1
  buffer_load_dwordx4 a[4:7], v1, s[84:87], s54 offen offset:1024 sc1
  buffer_load_dwordx4 a[20:23], v1, s[84:87], s55 offen offset:1024 sc1
  s_waitcnt vmcnt(0)
  v_mfma_f32_16x16x32_bf16 v[8:11], a[0:3], a[44:47], v[40:43]
  v_mfma_f32_16x16x32_bf16 v[12:15], a[4:7], a[44:47], v[104:107]
  v_mfma_f32_16x16x32_bf16 v[20:23], a[4:7], a[48:51], v[44:47]
  s_nop 7
  v_exp_f32 v8, v8
  v_exp_f32 v9, v9
  v_exp_f32 v10, v10
  v_exp_f32 v11, v11
  v_exp_f32 v12, v12
  v_exp_f32 v13, v13
  v_exp_f32 v14, v14
  v_exp_f32 v15, v15
  v_exp_f32 v20, v20
  v_exp_f32 v21, v21
  v_exp_f32 v22, v22
  v_exp_f32 v23, v23
  s_nop 0
  v_cvt_pk_bf16_f32 v56, v8, v9
  v_cvt_pk_bf16_f32 v57, v10, v11
  v_cvt_pk_bf16_f32 v58, v12, v13
  v_cvt_pk_bf16_f32 v59, v14, v15
  v_mov_b32 v60, 0
  v_mov_b32 v61, 0
  v_cvt_pk_bf16_f32 v62, v20, v21
  v_cvt_pk_bf16_f32 v63, v22, v23
  s_nop 1
  v_mfma_f32_16x16x32_bf16 v[72:75], a[16:19], v[56:59], v[72:75]
  v_mfma_f32_16x16x32_bf16 v[76:79], a[20:23], v[56:59], v[76:79]
  v_mfma_f32_16x16x32_bf16 v[80:83], a[32:35], v[56:59], v[80:83]
  v_mfma_f32_16x16x32_bf16 v[84:87], a[16:19], v[60:63], v[84:87]
  v_mfma_f32_16x16x32_bf16 v[88:91], a[20:23], v[60:63], v[88:91]
  v_mfma_f32_16x16x32_bf16 v[92:95], a[32:35], v[60:63], v[92:95]
AS_end1:
  s_nop 7
  v_rcp_f32 v4, v80
  v_rcp_f32 v5, v92
  v_mul_f32 v72, v72, v4
  v_mul_f32 v73, v73, v4
  v_mul_f32 v74, v74, v4
  v_mul_f32 v75, v75, v4
  v_mul_f32 v76, v76, v4
  v_mul_f32 v77, v77, v4
  v_mul_f32 v78, v78, v4
  v_mul_f32 v79, v79, v4
  v_cvt_pk_bf16_f32 v72, v72, v73
  v_cvt_pk_bf16_f32 v73, v74, v75
  v_cvt_pk_bf16_f32 v74, v76, v77
  v_cvt_pk_bf16_f32 v75, v78, v79
  buffer_store_dwordx4 v[72:75], v1, s[84:87], s53 offen offset:0 sc1
  v_mul_f32 v84, v84, v5
  v_mul_f32 v85, v85, v5
  v_mul_f32 v86, v86, v5
  v_mul_f32 v87, v87, v5
  v_mul_f32 v88, v88, v5
  v_mul_f32 v89, v89, v5
  v_mul_f32 v90, v90, v5
  v_mul_f32 v91, v91, v5
  v_cvt_pk_bf16_f32 v84, v84, v85
  v_cvt_pk_bf16_f32 v85, v86, v87
  v_cvt_pk_bf16_f32 v86, v88, v89
  v_cvt_pk_bf16_f32 v87, v90, v91
  buffer_store_dwordx4 v[84:87], v1, s[84:87], s53 offen offset:1024 sc1
  s_add_u32 s50, s50, 1
  s_cmp_lt_u32 s50, 4
  s_cbranch_scc1 AS_task
  s_branch AT_done
MG_code_end:
  s_endpgm
.section .rodata,"a"
.p2align 6
.amdhsa_kernel recurrent_scan__sliding_block__dense_activation_squared_relu__prompt_kernel
  .amdhsa_next_free_vgpr 512
  .amdhsa_next_free_sgpr 102
  .amdhsa_accum_offset 256
  .amdhsa_group_segment_fixed_size 0
  .amdhsa_kernarg_size 88
  .amdhsa_user_sgpr_count 2
  .amdhsa_user_sgpr_kernarg_segment_ptr 1
  .amdhsa_system_sgpr_workgroup_id_x 1
.end_amdhsa_kernel
```
